```python
import torch

def _softmax(x, axis=-1):
    return torch.softmax(x, dim=axis)
def _gelu(x):
    return torch.nn.functional.gelu(x, approximate="tanh")
def _silu(x):
    return torch.nn.functional.silu(x)
def _sigmoid(x):
    return torch.sigmoid(x)
def _layernorm(x, axis=-1, eps=1e-5):
    m = x.mean(dim=axis, keepdim=True)
    v = x.var(dim=axis, keepdim=True, unbiased=False)
    return (x - m) / torch.sqrt(v + eps)
def _scatter_add(tgt, idx, src, axis=0):
    return tgt.clone().index_add_(axis, idx, src)
def _segment_sum(src, seg, n):
    out = torch.zeros((n,) + src.shape[1:], dtype=src.dtype)
    return out.index_add_(0, seg, src)
def _pad(x, pw):
    flat = tuple(v for pair in reversed(pw) for v in pair)
    return torch.nn.functional.pad(x, flat)

kernel_name = 'concat_heads__mha_block_cached__gqa_block_cached__near_ridge'

def setup_inputs():

    _w = (lambda a: (lambda t: t.to(torch.bfloat16) if t.is_floating_point() else t)(torch.as_tensor(a)))
    def _A_setup():
        B, Sq, D = 8, 144, 512
        H, Sk, Dh = 32, 1024, 128
        return {
            "x": _w((lambda *s: torch.randn(*s, dtype=torch.bfloat16) * 0.8)(B, Sq, D)),
            "k_cache": _w((lambda *s: torch.randn(*s, dtype=torch.bfloat16) * 0.8)(B, H, Sk, Dh)),
            "v_cache": _w((lambda *s: torch.randn(*s, dtype=torch.bfloat16) * 0.05)(B, H, Sk, Dh)),
            "wq": _w((lambda *s: torch.randn(*s, dtype=torch.bfloat16) * 0.8)(D, H * Dh) * (D ** -0.5)),
            "wo": _w((lambda *s: torch.randn(*s, dtype=torch.bfloat16) * 0.05)(H * Dh, D) * ((H * Dh) ** -0.5)),
        }
    _A_in = _A_setup()

    def _B_setup():
        B, Sq, D = 8, 144, 512
        Hq, Hkv, Sk, Dh = 32, 32, 1024, 128
        assert Hq % Hkv == 0, (Hq, Hkv)
        return {
            "x": _w((lambda *s: torch.randn(*s, dtype=torch.bfloat16) * 0.8)(B, Sq, D)),
            "k_cache": _w((lambda *s: torch.randn(*s, dtype=torch.bfloat16) * 0.8)(B, Hkv, Sk, Dh)),
            "v_cache": _w((lambda *s: torch.randn(*s, dtype=torch.bfloat16) * 0.05)(B, Hkv, Sk, Dh)),
            "wq": _w((lambda *s: torch.randn(*s, dtype=torch.bfloat16) * 0.8)(D, Hq * Dh) * (D ** -0.5)),
            "wo": _w((lambda *s: torch.randn(*s, dtype=torch.bfloat16) * 0.05)(Hq * Dh, D) * ((Hq * Dh) ** -0.5)),
        }
    _B_in = _B_setup()

    return {
        "A_x": _A_in["x"],
        "A_k_cache": _A_in["k_cache"],
        "A_v_cache": _A_in["v_cache"],
        "A_wq": _A_in["wq"],
        "A_wo": _A_in["wo"],
        "B_x": _B_in["x"],
        "B_k_cache": _B_in["k_cache"],
        "B_v_cache": _B_in["v_cache"],
        "B_wq": _B_in["wq"],
        "B_wo": _B_in["wo"],
    }

def reference(A_x, A_k_cache, A_v_cache, A_wq, A_wo, B_x, B_k_cache, B_v_cache, B_wq, B_wo):
    def _A_ref(x, k_cache, v_cache, wq, wo):
        B, Sq, D = x.shape
        H, Dh = 32, 128
        q = (lambda x, *d: x.permute(*d))((x @ wq).reshape(B, Sq, H, Dh), 0, 2, 1, 3)
        scores = torch.einsum("bhqd,bhkd->bhqk", q, k_cache) * (Dh ** -0.5)
        p = _softmax(scores, axis=-1)
        o = torch.einsum("bhqk,bhkd->bhqd", p, v_cache)
        return (lambda x, *d: x.permute(*d))(o, 0, 2, 1, 3).reshape(B, Sq, H * Dh) @ wo

    def _B_ref(x, k_cache, v_cache, wq, wo):
        B, Sq, D = x.shape
        Hq, Dh = 32, 128
        Hkv = k_cache.shape[1]
        rep = Hq // Hkv
        q = (lambda x, *d: x.permute(*d))((x @ wq).reshape(B, Sq, Hq, Dh), 0, 2, 1, 3)
        k = (lambda x, n, axis: torch.repeat_interleave(x, n, dim=axis))(k_cache, rep, axis=1)
        v = (lambda x, n, axis: torch.repeat_interleave(x, n, dim=axis))(v_cache, rep, axis=1)
        scores = torch.einsum("bhqd,bhkd->bhqk", q, k) * (Dh ** -0.5)
        p = _softmax(scores, axis=-1)
        o = torch.einsum("bhqk,bhkd->bhqd", p, v)
        return (lambda x, *d: x.permute(*d))(o, 0, 2, 1, 3).reshape(B, Sq, Hq * Dh) @ wo

    a = _A_ref(A_x, A_k_cache, A_v_cache, A_wq, A_wo)
    b = _B_ref(B_x, B_k_cache, B_v_cache, B_wq, B_wo)
    return torch.concatenate([a, b], axis=-1)
```

```asm
; @launch grid=(256,1,1) block=(512,1,1) lds=163840
.amdgcn_target "amdgcn-amd-amdhsa--gfx950"
.text
.globl concat_heads__mha_block_cached__gqa_block_cached__near_ridge_kernel
.p2align 8
.type concat_heads__mha_block_cached__gqa_block_cached__near_ridge_kernel,@function
concat_heads__mha_block_cached__gqa_block_cached__near_ridge_kernel:
    s_cmp_ge_u32 s2, 256
    s_cbranch_scc1 L_end
    s_and_b32 s42, s2, 7
    s_lshr_b32 s43, s2, 3
    s_lshr_b32 s39, s42, 2
    s_mul_i32 s44, s39, 40
    s_add_u32 s4, s0, s44
    s_addc_u32 s5, s1, 0
    s_nop 0
    s_load_dwordx8 s[80:87], s[4:5], 0
    s_load_dwordx2 s[88:89], s[4:5], 32
    s_load_dwordx4 s[96:99], s[0:1], 80
    s_load_dwordx2 s[92:93], s[0:1], 96
    s_lshr_b32 s94, s43, 4
    s_lshl_b32 s44, s42, 1
    s_add_u32 s94, s94, s44
    s_and_b32 s95, s43, 15
    s_and_b32 s41, s43, 3
    s_and_b32 s38, s42, 3
    s_lshl_b32 s38, s38, 2
    s_add_u32 s38, s38, s41
    s_lshr_b32 s40, s43, 2
    s_lshl_b32 s41, s41, 1
    s_add_u32 s41, s41, s40
    s_lshl_b32 s37, s39, 3
    s_add_u32 s37, s37, s40
    v_lshrrev_b32 v12, 6, v0
    s_nop 0
    v_readfirstlane_b32 s36, v12
    s_mul_i32 s62, s40, 147456
    v_and_b32 v12, 63, v0
    v_lshrrev_b32 v13, 4, v12
    v_and_b32_e64 v14, 15, v12
    v_bfe_u32 v15, v12, 2, 2
    s_and_b32 s60, s36, 3
    v_and_b32 v248, 3, v12
    v_lshlrev_b32_e64 v248, 4, v248
    v_lshl_add_u32 v224, v13, 6, v248
    v_lshl_add_u32 v128, v15, 8, v224
    v_lshl_add_u32 v224, v15, 13, v224
    s_lshl_b32 s42, s60, 17
    s_lshl_b32 s43, s38, 9
    s_add_u32 s42, s42, s43
    v_add_u32 v224, s42, v224
    v_add_u32 v225, 31744, v224
    v_add_u32 v226, 63488, v224
    v_xor_b32_e64 v226, 32, v226
    v_add_u32 v227, 31744, v226
    s_lshl_b32 s63, s60, 12
    s_mul_i32 s61, s60, 5
    s_min_u32 s61, s61, 14
    v_and_b32 v231, 1, v13
    v_lshl_add_u32 v4, v231, 6, v248
    v_lshl_add_u32 v248, v15, 10, v4
    v_lshrrev_b32_e64 v231, 5, v12
    v_lshl_add_u32 v8, v231, 12, v248
    s_lshl_b32 s42, s61, 13
    s_and_b32 s43, s61, 1
    s_lshl_b32 s43, s43, 5
    v_add_u32 v248, s42, v8
    v_xor_b32_e64 v248, s43, v248
    v_add_u32 v249, 7168, v248
    v_xor_b32_e64 v249, 32, v249
    v_add_u32 v250, 14336, v248
    v_add_u32 v251, 14336, v249
    v_add_u32 v252, 32768, v248
    s_lshl_b32 s61, s61, 10
    s_waitcnt lgkmcnt(0)
    s_mov_b32 s8, s86
    s_mov_b32 s9, s87
    s_mov_b32 s10, 4194304
    s_mov_b32 s11, 0x20000
    s_add_u32 s80, s80, s62
    s_addc_u32 s81, s81, 0
    s_mov_b32 s12, s80
    s_mov_b32 s13, s81
    s_mov_b32 s14, 147456
    s_mov_b32 s15, 0x20000
    s_cmp_lt_u32 s36, 4
    s_cbranch_scc1 L_arole
    s_add_u32 s46, s41, 0
    s_and_b32 s46, s46, 7
    s_lshl_b32 s47, s46, 19
    s_nop 0
    s_add_u32 m0, s63, 32768
    s_nop 0
    s_nop 0
    buffer_load_dwordx4 v224, s[8:11], s47 offen offset:0 lds
    buffer_load_dwordx4 v225, s[8:11], s47 offen offset:1024 lds
    buffer_load_dwordx4 v226, s[8:11], s47 offen offset:2048 lds
    buffer_load_dwordx4 v227, s[8:11], s47 offen offset:3072 lds
    s_add_u32 m0, s61, 98304
    s_lshl_b32 s47, s46, 7
    s_nop 0
    buffer_load_dwordx4 v248, s[12:15], s47 offen offset:0 lds
    buffer_load_dwordx4 v249, s[12:15], s47 offen offset:1024 lds
    buffer_load_dwordx4 v250, s[12:15], s47 offen offset:2048 lds
    buffer_load_dwordx4 v251, s[12:15], s47 offen offset:3072 lds
    s_cmp_ge_u32 s36, 6
    s_cbranch_scc1 L_auxrole
    s_branch L_brole
L_arole:
    s_getpc_b64 s[90:91]
L_pf:
    s_lshr_b32 s42, s2, 3
    s_and_b32 s42, s42, 3
    s_min_u32 s42, s42, 2
    s_lshl_b32 s42, s42, 15
    v_lshlrev_b32 v240, 7, v0
    v_add_u32 v240, s42, v240
    v_min_u32 v240, L_end-L_pf, v240
    global_load_dword v253, v240, s[90:91]
    s_mul_i32 s42, s37, 1180672
    s_add_u32 s42, s42, 1024
    s_add_u32 s90, s92, s42
    s_addc_u32 s91, s93, 0
    s_mov_b32 s16, s90
    s_mov_b32 s17, s91
    s_mov_b32 s18, 1179648
    s_mov_b32 s19, 0x20000
    s_cmp_eq_u32 s36, 6
    s_cselect_b32 s82, s82, s84
    s_cselect_b32 s83, s83, s85
    s_lshl_b32 s42, s40, 4
    s_add_u32 s42, s42, s38
    s_lshl_b32 s42, s42, 19
    s_add_u32 s82, s82, s42
    s_addc_u32 s83, s83, 0
    s_mov_b32 s20, s82
    s_mov_b32 s21, s83
    s_mov_b32 s22, 524288
    s_mov_b32 s23, 0x20000
    s_mov_b32 s24, s88
    s_mov_b32 s25, s89
    s_mov_b32 s26, 4194304
    s_mov_b32 s27, 0x20000
    s_mov_b32 s28, s96
    s_mov_b32 s29, s97
    s_mov_b32 s30, 2359296
    s_mov_b32 s31, 0x20000
    s_mov_b32 s32, s98
    s_mov_b32 s33, s99
    s_mov_b32 s34, 256
    s_mov_b32 s35, 0x20000
    s_lshl_b32 s42, s37, 12
    s_nop 0
    s_add_u32 s42, s42, 0x2000000
    s_add_u32 s90, s92, s42
    s_addc_u32 s91, s93, 0
    s_mov_b32 s4, s90
    s_mov_b32 s5, s91
    s_mov_b32 s6, 2048
    s_mov_b32 s7, 0x20000
    s_mov_b32 s100, s92
    s_mov_b32 s101, s93
    s_and_b32 s59, s36, 1
    s_lshr_b32 s62, s36, 1
    v_and_b32 v236, 31, v0
    v_lshlrev_b32 v236, 2, v236
    v_add_u32 v236, 163712, v236
    v_mov_b32_e64 v234, 0
    ds_write_b32 v236, v234
    v_and_b32 v231, 3, v12
    v_lshlrev_b32 v231, 3, v231
    v_lshl_add_u32 v231, v15, 6, v231
    v_and_b32_e64 v232, 1, v13
    v_lshl_add_u32 v231, v232, 5, v231
    v_lshl_add_u32 v2, v13, 10, v231
    v_lshl_add_u32 v231, v13, 11, v231
    s_and_b32 s42, s36, 3
    s_lshl_b32 s42, s42, 8
    v_add_u32 v231, s42, v231
    v_xor_b32 v232, 32, v231
    v_lshrrev_b32 v233, 3, v14
    v_lshlrev_b32 v233, 1, v233
    v_xor_b32 v233, v233, v13
    v_lshlrev_b32 v233, 4, v233
    v_and_b32_e64 v236, 3, v14
    v_lshl_add_u32 v233, v236, 6, v233
    v_lshl_add_u32 v233, v15, 9, v233
    s_lshl_b32 s42, s59, 13
    s_nop 0
    s_add_u32 s42, s42, 65536
    v_add_u32_e64 v2, s42, v2
    v_add_u32 v2, 16384, v2
    v_xor_b32 v3, 32, v2
    v_lshlrev_b32 v1, 10, v15
    v_lshl_add_u32 v1, v236, 6, v1
    v_lshrrev_b32 v234, 1, v13
    v_and_b32 v235, 1, v13
    v_lshl_or_b32 v234, v235, 1, v234
    v_lshrrev_b32 v235, 3, v14
    v_xor_b32 v234, v234, v235
    v_lshl_add_u32 v1, v234, 4, v1
    v_add_u32_e64 v1, s42, v1
    v_mov_b32 v8, 0x3f803f80
    v_mov_b32 v9, 0x3f803f80
    v_mov_b32 v10, 0x3f803f80
    v_mov_b32 v11, 0x3f803f80
    v_mov_b32 v238, 0x3e0293ee
    v_mov_b32 v239, 0x3e0293ee
    v_add_u32 v234, 32768, v231
    v_add_u32 v235, 32768, v232
    v_add_u32 v236, 98304, v233
    s_waitcnt lgkmcnt(0)
    s_barrier
    ds_read_b64_tr_b16 v[96:97], v234 offset:0
    ds_read_b64_tr_b16 v[98:99], v234 offset:1024
    ds_read_b128 v[56:59], v236 offset:0
    ds_read_b128 v[60:63], v236 offset:2048
    ds_read_b128 v[64:67], v236 offset:4096
    ds_read_b128 v[68:71], v236 offset:6144
    ds_read_b128 v[72:75], v236 offset:8192
    ds_read_b64_tr_b16 v[100:101], v235 offset:0
    ds_read_b64_tr_b16 v[102:103], v235 offset:1024
    s_waitcnt lgkmcnt(0)
    s_nop 0
    v_mfma_f32_16x16x32_bf16 v[16:19], v[96:99], v[56:59], 0
    ds_read_b64_tr_b16 v[104:105], v234 offset:8192
    ds_read_b64_tr_b16 v[106:107], v234 offset:9216
    v_mfma_f32_16x16x32_bf16 v[24:27], v[96:99], v[60:63], 0
    ds_read_b128 v[76:79], v236 offset:256
    ds_read_b128 v[80:83], v236 offset:2304
    v_mfma_f32_16x16x32_bf16 v[32:35], v[96:99], v[64:67], 0
    ds_read_b128 v[84:87], v236 offset:4352
    ds_read_b128 v[88:91], v236 offset:6400
    v_mfma_f32_16x16x32_bf16 v[40:43], v[96:99], v[68:71], 0
    ds_read_b128 v[92:95], v236 offset:8448
    ds_read_b64_tr_b16 v[108:109], v235 offset:8192
    v_mfma_f32_16x16x32_bf16 v[48:51], v[96:99], v[72:75], 0
    ds_read_b64_tr_b16 v[110:111], v235 offset:9216
    v_mfma_f32_16x16x32_bf16 v[20:23], v[100:103], v[56:59], 0
    v_mfma_f32_16x16x32_bf16 v[28:31], v[100:103], v[60:63], 0
    v_mfma_f32_16x16x32_bf16 v[36:39], v[100:103], v[64:67], 0
    v_mfma_f32_16x16x32_bf16 v[44:47], v[100:103], v[68:71], 0
    v_mfma_f32_16x16x32_bf16 v[52:55], v[100:103], v[72:75], 0
    v_add_u32 v234, 49152, v231
    v_add_u32 v235, 49152, v232
    v_add_u32 v236, 116736, v233
    s_waitcnt lgkmcnt(0)
    s_barrier
    v_mfma_f32_16x16x32_bf16 v[16:19], v[104:107], v[76:79], v[16:19]
    ds_read_b64_tr_b16 v[96:97], v234 offset:0
    ds_read_b64_tr_b16 v[98:99], v234 offset:1024
    v_mfma_f32_16x16x32_bf16 v[24:27], v[104:107], v[80:83], v[24:27]
    ds_read_b128 v[56:59], v236 offset:0
    ds_read_b128 v[60:63], v236 offset:2048
    v_mfma_f32_16x16x32_bf16 v[32:35], v[104:107], v[84:87], v[32:35]
    ds_read_b128 v[64:67], v236 offset:4096
    ds_read_b128 v[68:71], v236 offset:6144
    v_mfma_f32_16x16x32_bf16 v[40:43], v[104:107], v[88:91], v[40:43]
    ds_read_b128 v[72:75], v236 offset:8192
    ds_read_b64_tr_b16 v[100:101], v235 offset:0
    v_mfma_f32_16x16x32_bf16 v[48:51], v[104:107], v[92:95], v[48:51]
    ds_read_b64_tr_b16 v[102:103], v235 offset:1024
    v_mfma_f32_16x16x32_bf16 v[20:23], v[108:111], v[76:79], v[20:23]
    v_mfma_f32_16x16x32_bf16 v[28:31], v[108:111], v[80:83], v[28:31]
    v_mfma_f32_16x16x32_bf16 v[36:39], v[108:111], v[84:87], v[36:39]
    v_mfma_f32_16x16x32_bf16 v[44:47], v[108:111], v[88:91], v[44:47]
    v_mfma_f32_16x16x32_bf16 v[52:55], v[108:111], v[92:95], v[52:55]
    s_waitcnt lgkmcnt(0)
    s_nop 0
    v_mfma_f32_16x16x32_bf16 v[16:19], v[96:99], v[56:59], v[16:19]
    ds_read_b64_tr_b16 v[104:105], v234 offset:8192
    ds_read_b64_tr_b16 v[106:107], v234 offset:9216
    v_mfma_f32_16x16x32_bf16 v[24:27], v[96:99], v[60:63], v[24:27]
    ds_read_b128 v[76:79], v236 offset:256
    ds_read_b128 v[80:83], v236 offset:2304
    v_mfma_f32_16x16x32_bf16 v[32:35], v[96:99], v[64:67], v[32:35]
    ds_read_b128 v[84:87], v236 offset:4352
    ds_read_b128 v[88:91], v236 offset:6400
    v_mfma_f32_16x16x32_bf16 v[40:43], v[96:99], v[68:71], v[40:43]
    ds_read_b128 v[92:95], v236 offset:8448
    ds_read_b64_tr_b16 v[108:109], v235 offset:8192
    v_mfma_f32_16x16x32_bf16 v[48:51], v[96:99], v[72:75], v[48:51]
    ds_read_b64_tr_b16 v[110:111], v235 offset:9216
    v_mfma_f32_16x16x32_bf16 v[20:23], v[100:103], v[56:59], v[20:23]
    v_mfma_f32_16x16x32_bf16 v[28:31], v[100:103], v[60:63], v[28:31]
    v_mfma_f32_16x16x32_bf16 v[36:39], v[100:103], v[64:67], v[36:39]
    v_mfma_f32_16x16x32_bf16 v[44:47], v[100:103], v[68:71], v[44:47]
    v_mfma_f32_16x16x32_bf16 v[52:55], v[100:103], v[72:75], v[52:55]
    v_add_u32 v234, 0, v231
    v_add_u32 v235, 0, v232
    v_add_u32 v236, 135168, v233
    s_waitcnt lgkmcnt(0)
    s_barrier
    v_mfma_f32_16x16x32_bf16 v[16:19], v[104:107], v[76:79], v[16:19]
    ds_read_b64_tr_b16 v[96:97], v234 offset:0
    ds_read_b64_tr_b16 v[98:99], v234 offset:1024
    v_mfma_f32_16x16x32_bf16 v[24:27], v[104:107], v[80:83], v[24:27]
    ds_read_b128 v[56:59], v236 offset:0
    ds_read_b128 v[60:63], v236 offset:2048
    v_mfma_f32_16x16x32_bf16 v[32:35], v[104:107], v[84:87], v[32:35]
    ds_read_b128 v[64:67], v236 offset:4096
    ds_read_b128 v[68:71], v236 offset:6144
    v_mfma_f32_16x16x32_bf16 v[40:43], v[104:107], v[88:91], v[40:43]
    ds_read_b128 v[72:75], v236 offset:8192
    ds_read_b64_tr_b16 v[100:101], v235 offset:0
    v_mfma_f32_16x16x32_bf16 v[48:51], v[104:107], v[92:95], v[48:51]
    ds_read_b64_tr_b16 v[102:103], v235 offset:1024
    v_mfma_f32_16x16x32_bf16 v[20:23], v[108:111], v[76:79], v[20:23]
    v_mfma_f32_16x16x32_bf16 v[28:31], v[108:111], v[80:83], v[28:31]
    v_mfma_f32_16x16x32_bf16 v[36:39], v[108:111], v[84:87], v[36:39]
    v_mfma_f32_16x16x32_bf16 v[44:47], v[108:111], v[88:91], v[44:47]
    v_mfma_f32_16x16x32_bf16 v[52:55], v[108:111], v[92:95], v[52:55]
    s_waitcnt lgkmcnt(0)
    s_nop 0
    v_mfma_f32_16x16x32_bf16 v[16:19], v[96:99], v[56:59], v[16:19]
    ds_read_b64_tr_b16 v[104:105], v234 offset:8192
    ds_read_b64_tr_b16 v[106:107], v234 offset:9216
    v_mfma_f32_16x16x32_bf16 v[24:27], v[96:99], v[60:63], v[24:27]
    ds_read_b128 v[76:79], v236 offset:256
    ds_read_b128 v[80:83], v236 offset:2304
    v_mfma_f32_16x16x32_bf16 v[32:35], v[96:99], v[64:67], v[32:35]
    ds_read_b128 v[84:87], v236 offset:4352
    ds_read_b128 v[88:91], v236 offset:6400
    v_mfma_f32_16x16x32_bf16 v[40:43], v[96:99], v[68:71], v[40:43]
    ds_read_b128 v[92:95], v236 offset:8448
    ds_read_b64_tr_b16 v[108:109], v235 offset:8192
    v_mfma_f32_16x16x32_bf16 v[48:51], v[96:99], v[72:75], v[48:51]
    ds_read_b64_tr_b16 v[110:111], v235 offset:9216
    v_mfma_f32_16x16x32_bf16 v[20:23], v[100:103], v[56:59], v[20:23]
    v_mfma_f32_16x16x32_bf16 v[28:31], v[100:103], v[60:63], v[28:31]
    v_mfma_f32_16x16x32_bf16 v[36:39], v[100:103], v[64:67], v[36:39]
    v_mfma_f32_16x16x32_bf16 v[44:47], v[100:103], v[68:71], v[44:47]
    v_mfma_f32_16x16x32_bf16 v[52:55], v[100:103], v[72:75], v[52:55]
    v_add_u32 v234, 32768, v231
    v_add_u32 v235, 32768, v232
    v_add_u32 v236, 98304, v233
    s_waitcnt lgkmcnt(0)
    s_barrier
    v_mfma_f32_16x16x32_bf16 v[16:19], v[104:107], v[76:79], v[16:19]
    ds_read_b64_tr_b16 v[96:97], v234 offset:0
    ds_read_b64_tr_b16 v[98:99], v234 offset:1024
    v_mfma_f32_16x16x32_bf16 v[24:27], v[104:107], v[80:83], v[24:27]
    ds_read_b128 v[56:59], v236 offset:0
    ds_read_b128 v[60:63], v236 offset:2048
    v_mfma_f32_16x16x32_bf16 v[32:35], v[104:107], v[84:87], v[32:35]
    ds_read_b128 v[64:67], v236 offset:4096
    ds_read_b128 v[68:71], v236 offset:6144
    v_mfma_f32_16x16x32_bf16 v[40:43], v[104:107], v[88:91], v[40:43]
    ds_read_b128 v[72:75], v236 offset:8192
    ds_read_b64_tr_b16 v[100:101], v235 offset:0
    v_mfma_f32_16x16x32_bf16 v[48:51], v[104:107], v[92:95], v[48:51]
    ds_read_b64_tr_b16 v[102:103], v235 offset:1024
    v_mfma_f32_16x16x32_bf16 v[20:23], v[108:111], v[76:79], v[20:23]
    v_mfma_f32_16x16x32_bf16 v[28:31], v[108:111], v[80:83], v[28:31]
    v_mfma_f32_16x16x32_bf16 v[36:39], v[108:111], v[84:87], v[36:39]
    v_mfma_f32_16x16x32_bf16 v[44:47], v[108:111], v[88:91], v[44:47]
    v_mfma_f32_16x16x32_bf16 v[52:55], v[108:111], v[92:95], v[52:55]
    s_waitcnt lgkmcnt(0)
    s_nop 0
    v_mfma_f32_16x16x32_bf16 v[16:19], v[96:99], v[56:59], v[16:19]
    ds_read_b64_tr_b16 v[104:105], v234 offset:8192
    ds_read_b64_tr_b16 v[106:107], v234 offset:9216
    v_mfma_f32_16x16x32_bf16 v[24:27], v[96:99], v[60:63], v[24:27]
    ds_read_b128 v[76:79], v236 offset:256
    ds_read_b128 v[80:83], v236 offset:2304
    v_mfma_f32_16x16x32_bf16 v[32:35], v[96:99], v[64:67], v[32:35]
    ds_read_b128 v[84:87], v236 offset:4352
    ds_read_b128 v[88:91], v236 offset:6400
    v_mfma_f32_16x16x32_bf16 v[40:43], v[96:99], v[68:71], v[40:43]
    ds_read_b128 v[92:95], v236 offset:8448
    ds_read_b64_tr_b16 v[108:109], v235 offset:8192
    v_mfma_f32_16x16x32_bf16 v[48:51], v[96:99], v[72:75], v[48:51]
    ds_read_b64_tr_b16 v[110:111], v235 offset:9216
    v_mfma_f32_16x16x32_bf16 v[20:23], v[100:103], v[56:59], v[20:23]
    v_mfma_f32_16x16x32_bf16 v[28:31], v[100:103], v[60:63], v[28:31]
    v_mfma_f32_16x16x32_bf16 v[36:39], v[100:103], v[64:67], v[36:39]
    v_mfma_f32_16x16x32_bf16 v[44:47], v[100:103], v[68:71], v[44:47]
    v_mfma_f32_16x16x32_bf16 v[52:55], v[100:103], v[72:75], v[52:55]
    v_add_u32 v234, 49152, v231
    v_add_u32 v235, 49152, v232
    v_add_u32 v236, 116736, v233
    s_waitcnt lgkmcnt(0)
    s_barrier
    v_mfma_f32_16x16x32_bf16 v[16:19], v[104:107], v[76:79], v[16:19]
    ds_read_b64_tr_b16 v[96:97], v234 offset:0
    ds_read_b64_tr_b16 v[98:99], v234 offset:1024
    v_mfma_f32_16x16x32_bf16 v[24:27], v[104:107], v[80:83], v[24:27]
    ds_read_b128 v[56:59], v236 offset:0
    ds_read_b128 v[60:63], v236 offset:2048
    v_mfma_f32_16x16x32_bf16 v[32:35], v[104:107], v[84:87], v[32:35]
    ds_read_b128 v[64:67], v236 offset:4096
    ds_read_b128 v[68:71], v236 offset:6144
    v_mfma_f32_16x16x32_bf16 v[40:43], v[104:107], v[88:91], v[40:43]
    ds_read_b128 v[72:75], v236 offset:8192
    ds_read_b64_tr_b16 v[100:101], v235 offset:0
    v_mfma_f32_16x16x32_bf16 v[48:51], v[104:107], v[92:95], v[48:51]
    ds_read_b64_tr_b16 v[102:103], v235 offset:1024
    v_mfma_f32_16x16x32_bf16 v[20:23], v[108:111], v[76:79], v[20:23]
    v_mfma_f32_16x16x32_bf16 v[28:31], v[108:111], v[80:83], v[28:31]
    v_mfma_f32_16x16x32_bf16 v[36:39], v[108:111], v[84:87], v[36:39]
    v_mfma_f32_16x16x32_bf16 v[44:47], v[108:111], v[88:91], v[44:47]
    v_mfma_f32_16x16x32_bf16 v[52:55], v[108:111], v[92:95], v[52:55]
    s_waitcnt lgkmcnt(0)
    s_nop 0
    v_mfma_f32_16x16x32_bf16 v[16:19], v[96:99], v[56:59], v[16:19]
    ds_read_b64_tr_b16 v[104:105], v234 offset:8192
    ds_read_b64_tr_b16 v[106:107], v234 offset:9216
    v_mfma_f32_16x16x32_bf16 v[24:27], v[96:99], v[60:63], v[24:27]
    ds_read_b128 v[76:79], v236 offset:256
    ds_read_b128 v[80:83], v236 offset:2304
    v_mfma_f32_16x16x32_bf16 v[32:35], v[96:99], v[64:67], v[32:35]
    ds_read_b128 v[84:87], v236 offset:4352
    ds_read_b128 v[88:91], v236 offset:6400
    v_mfma_f32_16x16x32_bf16 v[40:43], v[96:99], v[68:71], v[40:43]
    ds_read_b128 v[92:95], v236 offset:8448
    ds_read_b64_tr_b16 v[108:109], v235 offset:8192
    v_mfma_f32_16x16x32_bf16 v[48:51], v[96:99], v[72:75], v[48:51]
    ds_read_b64_tr_b16 v[110:111], v235 offset:9216
    v_mfma_f32_16x16x32_bf16 v[20:23], v[100:103], v[56:59], v[20:23]
    v_mfma_f32_16x16x32_bf16 v[28:31], v[100:103], v[60:63], v[28:31]
    v_mfma_f32_16x16x32_bf16 v[36:39], v[100:103], v[64:67], v[36:39]
    v_mfma_f32_16x16x32_bf16 v[44:47], v[100:103], v[68:71], v[44:47]
    v_mfma_f32_16x16x32_bf16 v[52:55], v[100:103], v[72:75], v[52:55]
    v_add_u32 v234, 0, v231
    v_add_u32 v235, 0, v232
    v_add_u32 v236, 135168, v233
    s_waitcnt lgkmcnt(0)
    s_barrier
    v_mfma_f32_16x16x32_bf16 v[16:19], v[104:107], v[76:79], v[16:19]
    ds_read_b64_tr_b16 v[96:97], v234 offset:0
    ds_read_b64_tr_b16 v[98:99], v234 offset:1024
    v_mfma_f32_16x16x32_bf16 v[24:27], v[104:107], v[80:83], v[24:27]
    ds_read_b128 v[56:59], v236 offset:0
    ds_read_b128 v[60:63], v236 offset:2048
    v_mfma_f32_16x16x32_bf16 v[32:35], v[104:107], v[84:87], v[32:35]
    ds_read_b128 v[64:67], v236 offset:4096
    ds_read_b128 v[68:71], v236 offset:6144
    v_mfma_f32_16x16x32_bf16 v[40:43], v[104:107], v[88:91], v[40:43]
    ds_read_b128 v[72:75], v236 offset:8192
    ds_read_b64_tr_b16 v[100:101], v235 offset:0
    v_mfma_f32_16x16x32_bf16 v[48:51], v[104:107], v[92:95], v[48:51]
    ds_read_b64_tr_b16 v[102:103], v235 offset:1024
    v_mfma_f32_16x16x32_bf16 v[20:23], v[108:111], v[76:79], v[20:23]
    v_mfma_f32_16x16x32_bf16 v[28:31], v[108:111], v[80:83], v[28:31]
    v_mfma_f32_16x16x32_bf16 v[36:39], v[108:111], v[84:87], v[36:39]
    v_mfma_f32_16x16x32_bf16 v[44:47], v[108:111], v[88:91], v[44:47]
    v_mfma_f32_16x16x32_bf16 v[52:55], v[108:111], v[92:95], v[52:55]
    s_waitcnt lgkmcnt(0)
    s_nop 0
    v_mfma_f32_16x16x32_bf16 v[16:19], v[96:99], v[56:59], v[16:19]
    ds_read_b64_tr_b16 v[104:105], v234 offset:8192
    ds_read_b64_tr_b16 v[106:107], v234 offset:9216
    v_mfma_f32_16x16x32_bf16 v[24:27], v[96:99], v[60:63], v[24:27]
    ds_read_b128 v[76:79], v236 offset:256
    ds_read_b128 v[80:83], v236 offset:2304
    v_mfma_f32_16x16x32_bf16 v[32:35], v[96:99], v[64:67], v[32:35]
    ds_read_b128 v[84:87], v236 offset:4352
    ds_read_b128 v[88:91], v236 offset:6400
    v_mfma_f32_16x16x32_bf16 v[40:43], v[96:99], v[68:71], v[40:43]
    ds_read_b128 v[92:95], v236 offset:8448
    ds_read_b64_tr_b16 v[108:109], v235 offset:8192
    v_mfma_f32_16x16x32_bf16 v[48:51], v[96:99], v[72:75], v[48:51]
    ds_read_b64_tr_b16 v[110:111], v235 offset:9216
    v_mfma_f32_16x16x32_bf16 v[20:23], v[100:103], v[56:59], v[20:23]
    v_mfma_f32_16x16x32_bf16 v[28:31], v[100:103], v[60:63], v[28:31]
    v_mfma_f32_16x16x32_bf16 v[36:39], v[100:103], v[64:67], v[36:39]
    v_mfma_f32_16x16x32_bf16 v[44:47], v[100:103], v[68:71], v[44:47]
    v_mfma_f32_16x16x32_bf16 v[52:55], v[100:103], v[72:75], v[52:55]
    v_add_u32 v234, 32768, v231
    v_add_u32 v235, 32768, v232
    v_add_u32 v236, 98304, v233
    s_waitcnt lgkmcnt(0)
    s_barrier
    v_mfma_f32_16x16x32_bf16 v[16:19], v[104:107], v[76:79], v[16:19]
    ds_read_b64_tr_b16 v[96:97], v234 offset:0
    ds_read_b64_tr_b16 v[98:99], v234 offset:1024
    v_mfma_f32_16x16x32_bf16 v[24:27], v[104:107], v[80:83], v[24:27]
    ds_read_b128 v[56:59], v236 offset:0
    ds_read_b128 v[60:63], v236 offset:2048
    v_mfma_f32_16x16x32_bf16 v[32:35], v[104:107], v[84:87], v[32:35]
    ds_read_b128 v[64:67], v236 offset:4096
    ds_read_b128 v[68:71], v236 offset:6144
    v_mfma_f32_16x16x32_bf16 v[40:43], v[104:107], v[88:91], v[40:43]
    ds_read_b128 v[72:75], v236 offset:8192
    ds_read_b64_tr_b16 v[100:101], v235 offset:0
    v_mfma_f32_16x16x32_bf16 v[48:51], v[104:107], v[92:95], v[48:51]
    ds_read_b64_tr_b16 v[102:103], v235 offset:1024
    v_mfma_f32_16x16x32_bf16 v[20:23], v[108:111], v[76:79], v[20:23]
    v_mfma_f32_16x16x32_bf16 v[28:31], v[108:111], v[80:83], v[28:31]
    v_mfma_f32_16x16x32_bf16 v[36:39], v[108:111], v[84:87], v[36:39]
    v_mfma_f32_16x16x32_bf16 v[44:47], v[108:111], v[88:91], v[44:47]
    v_mfma_f32_16x16x32_bf16 v[52:55], v[108:111], v[92:95], v[52:55]
    s_waitcnt lgkmcnt(0)
    s_nop 0
    v_mfma_f32_16x16x32_bf16 v[16:19], v[96:99], v[56:59], v[16:19]
    ds_read_b64_tr_b16 v[104:105], v234 offset:8192
    ds_read_b64_tr_b16 v[106:107], v234 offset:9216
    v_mfma_f32_16x16x32_bf16 v[24:27], v[96:99], v[60:63], v[24:27]
    ds_read_b128 v[76:79], v236 offset:256
    ds_read_b128 v[80:83], v236 offset:2304
    v_mfma_f32_16x16x32_bf16 v[32:35], v[96:99], v[64:67], v[32:35]
    ds_read_b128 v[84:87], v236 offset:4352
    ds_read_b128 v[88:91], v236 offset:6400
    v_mfma_f32_16x16x32_bf16 v[40:43], v[96:99], v[68:71], v[40:43]
    ds_read_b128 v[92:95], v236 offset:8448
    ds_read_b64_tr_b16 v[108:109], v235 offset:8192
    v_mfma_f32_16x16x32_bf16 v[48:51], v[96:99], v[72:75], v[48:51]
    ds_read_b64_tr_b16 v[110:111], v235 offset:9216
    v_mfma_f32_16x16x32_bf16 v[20:23], v[100:103], v[56:59], v[20:23]
    v_mfma_f32_16x16x32_bf16 v[28:31], v[100:103], v[60:63], v[28:31]
    v_mfma_f32_16x16x32_bf16 v[36:39], v[100:103], v[64:67], v[36:39]
    v_mfma_f32_16x16x32_bf16 v[44:47], v[100:103], v[68:71], v[44:47]
    v_mfma_f32_16x16x32_bf16 v[52:55], v[100:103], v[72:75], v[52:55]
    v_add_u32 v234, 49152, v231
    v_add_u32 v235, 49152, v232
    v_add_u32 v236, 116736, v233
    s_waitcnt lgkmcnt(0)
    s_barrier
    v_mfma_f32_16x16x32_bf16 v[16:19], v[104:107], v[76:79], v[16:19]
    ds_read_b64_tr_b16 v[96:97], v234 offset:0
    ds_read_b64_tr_b16 v[98:99], v234 offset:1024
    v_mfma_f32_16x16x32_bf16 v[24:27], v[104:107], v[80:83], v[24:27]
    ds_read_b128 v[56:59], v236 offset:0
    ds_read_b128 v[60:63], v236 offset:2048
    v_mfma_f32_16x16x32_bf16 v[32:35], v[104:107], v[84:87], v[32:35]
    ds_read_b128 v[64:67], v236 offset:4096
    ds_read_b128 v[68:71], v236 offset:6144
    v_mfma_f32_16x16x32_bf16 v[40:43], v[104:107], v[88:91], v[40:43]
    ds_read_b128 v[72:75], v236 offset:8192
    ds_read_b64_tr_b16 v[100:101], v235 offset:0
    v_mfma_f32_16x16x32_bf16 v[48:51], v[104:107], v[92:95], v[48:51]
    ds_read_b64_tr_b16 v[102:103], v235 offset:1024
    v_mfma_f32_16x16x32_bf16 v[20:23], v[108:111], v[76:79], v[20:23]
    v_mfma_f32_16x16x32_bf16 v[28:31], v[108:111], v[80:83], v[28:31]
    v_mfma_f32_16x16x32_bf16 v[36:39], v[108:111], v[84:87], v[36:39]
    v_mfma_f32_16x16x32_bf16 v[44:47], v[108:111], v[88:91], v[44:47]
    v_mfma_f32_16x16x32_bf16 v[52:55], v[108:111], v[92:95], v[52:55]
    s_waitcnt lgkmcnt(0)
    s_nop 0
    v_mfma_f32_16x16x32_bf16 v[16:19], v[96:99], v[56:59], v[16:19]
    ds_read_b64_tr_b16 v[104:105], v234 offset:8192
    ds_read_b64_tr_b16 v[106:107], v234 offset:9216
    v_mfma_f32_16x16x32_bf16 v[24:27], v[96:99], v[60:63], v[24:27]
    ds_read_b128 v[76:79], v236 offset:256
    ds_read_b128 v[80:83], v236 offset:2304
    v_mfma_f32_16x16x32_bf16 v[32:35], v[96:99], v[64:67], v[32:35]
    ds_read_b128 v[84:87], v236 offset:4352
    ds_read_b128 v[88:91], v236 offset:6400
    v_mfma_f32_16x16x32_bf16 v[40:43], v[96:99], v[68:71], v[40:43]
    ds_read_b128 v[92:95], v236 offset:8448
    ds_read_b64_tr_b16 v[108:109], v235 offset:8192
    v_mfma_f32_16x16x32_bf16 v[48:51], v[96:99], v[72:75], v[48:51]
    ds_read_b64_tr_b16 v[110:111], v235 offset:9216
    v_mfma_f32_16x16x32_bf16 v[20:23], v[100:103], v[56:59], v[20:23]
    v_mfma_f32_16x16x32_bf16 v[28:31], v[100:103], v[60:63], v[28:31]
    v_mfma_f32_16x16x32_bf16 v[36:39], v[100:103], v[64:67], v[36:39]
    v_mfma_f32_16x16x32_bf16 v[44:47], v[100:103], v[68:71], v[44:47]
    v_mfma_f32_16x16x32_bf16 v[52:55], v[100:103], v[72:75], v[52:55]
    s_waitcnt lgkmcnt(6)
    s_nop 0
    v_mfma_f32_16x16x32_bf16 v[16:19], v[104:107], v[76:79], v[16:19]
    s_waitcnt lgkmcnt(5)
    s_nop 0
    v_mfma_f32_16x16x32_bf16 v[24:27], v[104:107], v[80:83], v[24:27]
    s_waitcnt lgkmcnt(4)
    s_nop 0
    v_mfma_f32_16x16x32_bf16 v[32:35], v[104:107], v[84:87], v[32:35]
    s_waitcnt lgkmcnt(3)
    s_nop 0
    v_mfma_f32_16x16x32_bf16 v[40:43], v[104:107], v[88:91], v[40:43]
    s_waitcnt lgkmcnt(2)
    s_nop 0
    v_mfma_f32_16x16x32_bf16 v[48:51], v[104:107], v[92:95], v[48:51]
    s_waitcnt lgkmcnt(0)
    s_nop 0
    v_mfma_f32_16x16x32_bf16 v[20:23], v[108:111], v[76:79], v[20:23]
    v_mfma_f32_16x16x32_bf16 v[28:31], v[108:111], v[80:83], v[28:31]
    v_mfma_f32_16x16x32_bf16 v[36:39], v[108:111], v[84:87], v[36:39]
    v_mfma_f32_16x16x32_bf16 v[44:47], v[108:111], v[88:91], v[44:47]
    v_mfma_f32_16x16x32_bf16 v[52:55], v[108:111], v[92:95], v[52:55]
    s_and_b32 s60, s36, 3
    s_lshl_b32 s60, s60, 10
    v_lshlrev_b32 v236, 4, v12
    v_add_u32 v236, s60, v236
    v_add_u32 v234, 135168, v236
    v_add_u32 v235, 32768, v236
    v_pk_mul_f32 v[16:17], v[16:17], v[238:239]
    v_pk_mul_f32 v[18:19], v[18:19], v[238:239]
    v_pk_mul_f32 v[20:21], v[20:21], v[238:239]
    v_pk_mul_f32 v[22:23], v[22:23], v[238:239]
    v_cvt_pk_bf16_f32 v16, v16, v17
    v_cvt_pk_bf16_f32 v17, v18, v19
    v_cvt_pk_bf16_f32 v18, v20, v21
    v_cvt_pk_bf16_f32 v19, v22, v23
    v_pk_mul_f32 v[24:25], v[24:25], v[238:239]
    v_pk_mul_f32 v[26:27], v[26:27], v[238:239]
    v_pk_mul_f32 v[28:29], v[28:29], v[238:239]
    v_pk_mul_f32 v[30:31], v[30:31], v[238:239]
    v_cvt_pk_bf16_f32 v24, v24, v25
    v_cvt_pk_bf16_f32 v25, v26, v27
    v_cvt_pk_bf16_f32 v26, v28, v29
    v_cvt_pk_bf16_f32 v27, v30, v31
    v_pk_mul_f32 v[32:33], v[32:33], v[238:239]
    v_pk_mul_f32 v[34:35], v[34:35], v[238:239]
    v_pk_mul_f32 v[36:37], v[36:37], v[238:239]
    v_pk_mul_f32 v[38:39], v[38:39], v[238:239]
    v_cvt_pk_bf16_f32 v32, v32, v33
    v_cvt_pk_bf16_f32 v33, v34, v35
    v_cvt_pk_bf16_f32 v34, v36, v37
    v_cvt_pk_bf16_f32 v35, v38, v39
    v_pk_mul_f32 v[40:41], v[40:41], v[238:239]
    v_pk_mul_f32 v[42:43], v[42:43], v[238:239]
    v_pk_mul_f32 v[44:45], v[44:45], v[238:239]
    v_pk_mul_f32 v[46:47], v[46:47], v[238:239]
    v_cvt_pk_bf16_f32 v40, v40, v41
    v_cvt_pk_bf16_f32 v41, v42, v43
    v_cvt_pk_bf16_f32 v42, v44, v45
    v_cvt_pk_bf16_f32 v43, v46, v47
    v_pk_mul_f32 v[48:49], v[48:49], v[238:239]
    v_pk_mul_f32 v[50:51], v[50:51], v[238:239]
    v_pk_mul_f32 v[52:53], v[52:53], v[238:239]
    v_pk_mul_f32 v[54:55], v[54:55], v[238:239]
    v_cvt_pk_bf16_f32 v48, v48, v49
    v_cvt_pk_bf16_f32 v49, v50, v51
    v_cvt_pk_bf16_f32 v50, v52, v53
    v_cvt_pk_bf16_f32 v51, v54, v55
    v_permlane16_swap_b32 v16, v18
    v_permlane16_swap_b32 v17, v19
    v_permlane16_swap_b32 v24, v26
    v_permlane16_swap_b32 v25, v27
    v_permlane16_swap_b32 v32, v34
    v_permlane16_swap_b32 v33, v35
    v_permlane16_swap_b32 v40, v42
    v_permlane16_swap_b32 v41, v43
    v_permlane16_swap_b32 v48, v50
    v_permlane16_swap_b32 v49, v51
    ds_write_b128 v234, v[16:19] offset:0
    ds_write_b128 v234, v[24:27] offset:4096
    ds_write_b128 v234, v[32:35] offset:8192
    ds_write_b128 v234, v[40:43] offset:12288
    ds_write_b128 v234, v[48:51] offset:16384
    s_waitcnt lgkmcnt(0)
    s_barrier
    s_branch L_att
.p2align 3
L_brole:
    s_add_u32 m0, s61, 102400
    s_nop 0
    s_nop 0
    buffer_load_dwordx4 v252, s[12:15], s47 offen offset:0 lds
    s_mul_i32 s42, s37, 1180672
    s_add_u32 s42, s42, 1024
    s_add_u32 s90, s92, s42
    s_addc_u32 s91, s93, 0
    s_mov_b32 s16, s90
    s_mov_b32 s17, s91
    s_mov_b32 s18, 1179648
    s_mov_b32 s19, 0x20000
    s_cmp_eq_u32 s36, 6
    s_cselect_b32 s82, s82, s84
    s_cselect_b32 s83, s83, s85
    s_lshl_b32 s42, s40, 4
    s_add_u32 s42, s42, s38
    s_lshl_b32 s42, s42, 19
    s_add_u32 s82, s82, s42
    s_addc_u32 s83, s83, 0
    s_mov_b32 s20, s82
    s_mov_b32 s21, s83
    s_mov_b32 s22, 524288
    s_mov_b32 s23, 0x20000
    s_mov_b32 s24, s88
    s_mov_b32 s25, s89
    s_mov_b32 s26, 4194304
    s_mov_b32 s27, 0x20000
    s_mov_b32 s28, s96
    s_mov_b32 s29, s97
    s_mov_b32 s30, 2359296
    s_mov_b32 s31, 0x20000
    s_mov_b32 s32, s98
    s_mov_b32 s33, s99
    s_mov_b32 s34, 256
    s_mov_b32 s35, 0x20000
    s_lshl_b32 s42, s37, 12
    s_nop 0
    s_add_u32 s42, s42, 0x2000000
    s_add_u32 s90, s92, s42
    s_addc_u32 s91, s93, 0
    s_mov_b32 s4, s90
    s_mov_b32 s5, s91
    s_mov_b32 s6, 2048
    s_mov_b32 s7, 0x20000
    s_mov_b32 s100, s92
    s_mov_b32 s101, s93
    s_and_b32 s59, s36, 1
    s_lshr_b32 s62, s36, 1
    v_and_b32 v236, 31, v0
    v_lshlrev_b32 v236, 2, v236
    v_add_u32 v236, 163712, v236
    v_mov_b32_e64 v234, 0
    ds_write_b32 v236, v234
    v_and_b32 v231, 3, v12
    v_lshlrev_b32 v231, 3, v231
    v_lshl_add_u32 v231, v15, 6, v231
    v_and_b32_e64 v232, 1, v13
    v_lshl_add_u32 v231, v232, 5, v231
    v_lshl_add_u32 v2, v13, 10, v231
    v_lshl_add_u32 v231, v13, 11, v231
    s_and_b32 s42, s36, 3
    s_lshl_b32 s42, s42, 8
    v_add_u32 v231, s42, v231
    v_xor_b32 v232, 32, v231
    v_lshrrev_b32 v233, 3, v14
    v_lshlrev_b32 v233, 1, v233
    v_xor_b32 v233, v233, v13
    v_lshlrev_b32 v233, 4, v233
    v_and_b32_e64 v236, 3, v14
    v_lshl_add_u32 v233, v236, 6, v233
    v_lshl_add_u32 v233, v15, 9, v233
    s_lshl_b32 s42, s59, 13
    s_nop 0
    s_add_u32 s42, s42, 65536
    v_add_u32_e64 v2, s42, v2
    v_add_u32 v2, 16384, v2
    v_xor_b32 v3, 32, v2
    v_lshlrev_b32 v1, 10, v15
    v_lshl_add_u32 v1, v236, 6, v1
    v_lshrrev_b32 v234, 1, v13
    v_and_b32 v235, 1, v13
    v_lshl_or_b32 v234, v235, 1, v234
    v_lshrrev_b32 v235, 3, v14
    v_xor_b32 v234, v234, v235
    v_lshl_add_u32 v1, v234, 4, v1
    v_add_u32_e64 v1, s42, v1
    v_mov_b32 v8, 0x3f803f80
    v_mov_b32 v9, 0x3f803f80
    v_mov_b32 v10, 0x3f803f80
    v_mov_b32 v11, 0x3f803f80
    v_mov_b32 v238, 0x3e0293ee
    v_mov_b32 v239, 0x3e0293ee
    s_add_u32 s46, s41, 1
    s_and_b32 s46, s46, 7
    s_lshl_b32 s47, s46, 19
    s_nop 0
    s_add_u32 m0, s63, 49152
    s_nop 0
    s_nop 0
    buffer_load_dwordx4 v224, s[8:11], s47 offen offset:0 lds
    buffer_load_dwordx4 v225, s[8:11], s47 offen offset:1024 lds
    buffer_load_dwordx4 v226, s[8:11], s47 offen offset:2048 lds
    buffer_load_dwordx4 v227, s[8:11], s47 offen offset:3072 lds
    s_add_u32 m0, s61, 116736
    s_lshl_b32 s47, s46, 7
    s_nop 0
    buffer_load_dwordx4 v248, s[12:15], s47 offen offset:0 lds
    buffer_load_dwordx4 v249, s[12:15], s47 offen offset:1024 lds
    buffer_load_dwordx4 v250, s[12:15], s47 offen offset:2048 lds
    buffer_load_dwordx4 v251, s[12:15], s47 offen offset:3072 lds
    s_add_u32 m0, s61, 120832
    s_nop 0
    s_nop 0
    buffer_load_dwordx4 v252, s[12:15], s47 offen offset:0 lds
    s_setprio 1
    s_waitcnt vmcnt(9)
    v_add_u32 v234, 32768, v231
    v_add_u32 v235, 32768, v232
    v_add_u32 v236, 98304, v233
    s_waitcnt lgkmcnt(0)
    s_barrier
    ds_read_b64_tr_b16 v[96:97], v234 offset:0
    ds_read_b64_tr_b16 v[98:99], v234 offset:1024
    ds_read_b128 v[56:59], v236 offset:10240
    ds_read_b128 v[60:63], v236 offset:12288
    ds_read_b128 v[64:67], v236 offset:14336
    ds_read_b128 v[68:71], v236 offset:16384
    ds_read_b64_tr_b16 v[100:101], v235 offset:0
    ds_read_b64_tr_b16 v[102:103], v235 offset:1024
    s_add_u32 s46, s41, 2
    s_and_b32 s46, s46, 7
    s_lshl_b32 s47, s46, 19
    s_add_u32 m0, s63, 0
    s_nop 0
    s_nop 0
    buffer_load_dwordx4 v224, s[8:11], s47 offen offset:0 lds
    buffer_load_dwordx4 v225, s[8:11], s47 offen offset:1024 lds
    buffer_load_dwordx4 v226, s[8:11], s47 offen offset:2048 lds
    buffer_load_dwordx4 v227, s[8:11], s47 offen offset:3072 lds
    s_add_u32 m0, s61, 135168
    s_lshl_b32 s47, s46, 7
    s_nop 0
    buffer_load_dwordx4 v248, s[12:15], s47 offen offset:0 lds
    s_waitcnt lgkmcnt(0)
    s_nop 0
    v_mfma_f32_16x16x32_bf16 v[16:19], v[96:99], v[56:59], 0
    ds_read_b64_tr_b16 v[104:105], v234 offset:8192
    ds_read_b64_tr_b16 v[106:107], v234 offset:9216
    buffer_load_dwordx4 v249, s[12:15], s47 offen offset:1024 lds
    v_mfma_f32_16x16x32_bf16 v[24:27], v[96:99], v[60:63], 0
    ds_read_b128 v[76:79], v236 offset:10496
    ds_read_b128 v[80:83], v236 offset:12544
    v_mfma_f32_16x16x32_bf16 v[32:35], v[96:99], v[64:67], 0
    ds_read_b128 v[84:87], v236 offset:14592
    ds_read_b128 v[88:91], v236 offset:16640
    buffer_load_dwordx4 v250, s[12:15], s47 offen offset:2048 lds
    v_mfma_f32_16x16x32_bf16 v[40:43], v[96:99], v[68:71], 0
    ds_read_b64_tr_b16 v[108:109], v235 offset:8192
    ds_read_b64_tr_b16 v[110:111], v235 offset:9216
    v_mfma_f32_16x16x32_bf16 v[20:23], v[100:103], v[56:59], 0
    buffer_load_dwordx4 v251, s[12:15], s47 offen offset:3072 lds
    v_mfma_f32_16x16x32_bf16 v[28:31], v[100:103], v[60:63], 0
    v_mfma_f32_16x16x32_bf16 v[36:39], v[100:103], v[64:67], 0
    s_add_u32 m0, s61, 139264
    s_nop 0
    s_nop 0
    buffer_load_dwordx4 v252, s[12:15], s47 offen offset:0 lds
    v_mfma_f32_16x16x32_bf16 v[44:47], v[100:103], v[68:71], 0
    s_waitcnt vmcnt(9)
    s_nop 0
    v_add_u32 v234, 49152, v231
    v_add_u32 v235, 49152, v232
    v_add_u32 v236, 116736, v233
    s_waitcnt lgkmcnt(0)
    s_barrier
    v_mfma_f32_16x16x32_bf16 v[16:19], v[104:107], v[76:79], v[16:19]
    ds_read_b64_tr_b16 v[96:97], v234 offset:0
    ds_read_b64_tr_b16 v[98:99], v234 offset:1024
    s_add_u32 s46, s41, 3
    s_and_b32 s46, s46, 7
    s_lshl_b32 s47, s46, 19
    s_nop 0
    s_add_u32 m0, s63, 32768
    s_nop 0
    s_nop 0
    buffer_load_dwordx4 v224, s[8:11], s47 offen offset:0 lds
    v_mfma_f32_16x16x32_bf16 v[24:27], v[104:107], v[80:83], v[24:27]
    ds_read_b128 v[56:59], v236 offset:10240
    ds_read_b128 v[60:63], v236 offset:12288
    v_mfma_f32_16x16x32_bf16 v[32:35], v[104:107], v[84:87], v[32:35]
    ds_read_b128 v[64:67], v236 offset:14336
    ds_read_b128 v[68:71], v236 offset:16384
    buffer_load_dwordx4 v225, s[8:11], s47 offen offset:1024 lds
    v_mfma_f32_16x16x32_bf16 v[40:43], v[104:107], v[88:91], v[40:43]
    ds_read_b64_tr_b16 v[100:101], v235 offset:0
    ds_read_b64_tr_b16 v[102:103], v235 offset:1024
    v_mfma_f32_16x16x32_bf16 v[20:23], v[108:111], v[76:79], v[20:23]
    buffer_load_dwordx4 v226, s[8:11], s47 offen offset:2048 lds
    v_mfma_f32_16x16x32_bf16 v[28:31], v[108:111], v[80:83], v[28:31]
    buffer_load_dwordx4 v227, s[8:11], s47 offen offset:3072 lds
    v_mfma_f32_16x16x32_bf16 v[36:39], v[108:111], v[84:87], v[36:39]
    v_mfma_f32_16x16x32_bf16 v[44:47], v[108:111], v[88:91], v[44:47]
    s_add_u32 m0, s61, 98304
    s_lshl_b32 s47, s46, 7
    s_nop 0
    buffer_load_dwordx4 v248, s[12:15], s47 offen offset:0 lds
    s_waitcnt lgkmcnt(0)
    s_nop 0
    v_mfma_f32_16x16x32_bf16 v[16:19], v[96:99], v[56:59], v[16:19]
    ds_read_b64_tr_b16 v[104:105], v234 offset:8192
    ds_read_b64_tr_b16 v[106:107], v234 offset:9216
    buffer_load_dwordx4 v249, s[12:15], s47 offen offset:1024 lds
    v_mfma_f32_16x16x32_bf16 v[24:27], v[96:99], v[60:63], v[24:27]
    ds_read_b128 v[76:79], v236 offset:10496
    ds_read_b128 v[80:83], v236 offset:12544
    v_mfma_f32_16x16x32_bf16 v[32:35], v[96:99], v[64:67], v[32:35]
    ds_read_b128 v[84:87], v236 offset:14592
    ds_read_b128 v[88:91], v236 offset:16640
    buffer_load_dwordx4 v250, s[12:15], s47 offen offset:2048 lds
    v_mfma_f32_16x16x32_bf16 v[40:43], v[96:99], v[68:71], v[40:43]
    ds_read_b64_tr_b16 v[108:109], v235 offset:8192
    ds_read_b64_tr_b16 v[110:111], v235 offset:9216
    v_mfma_f32_16x16x32_bf16 v[20:23], v[100:103], v[56:59], v[20:23]
    buffer_load_dwordx4 v251, s[12:15], s47 offen offset:3072 lds
    v_mfma_f32_16x16x32_bf16 v[28:31], v[100:103], v[60:63], v[28:31]
    v_mfma_f32_16x16x32_bf16 v[36:39], v[100:103], v[64:67], v[36:39]
    s_add_u32 m0, s61, 102400
    s_nop 0
    s_nop 0
    buffer_load_dwordx4 v252, s[12:15], s47 offen offset:0 lds
    v_mfma_f32_16x16x32_bf16 v[44:47], v[100:103], v[68:71], v[44:47]
    s_waitcnt vmcnt(9)
    v_add_u32 v234, 0, v231
    v_add_u32_e64 v235, 0, v232
    v_add_u32 v236, 135168, v233
    s_waitcnt lgkmcnt(0)
    s_barrier
    v_mfma_f32_16x16x32_bf16 v[16:19], v[104:107], v[76:79], v[16:19]
    ds_read_b64_tr_b16 v[96:97], v234 offset:0
    ds_read_b64_tr_b16 v[98:99], v234 offset:1024
    s_add_u32 s46, s41, 4
    s_and_b32 s46, s46, 7
    s_lshl_b32 s47, s46, 19
    s_nop 0
    s_add_u32 m0, s63, 49152
    s_nop 0
    s_nop 0
    buffer_load_dwordx4 v224, s[8:11], s47 offen offset:0 lds
    v_mfma_f32_16x16x32_bf16 v[24:27], v[104:107], v[80:83], v[24:27]
    ds_read_b128 v[56:59], v236 offset:10240
    ds_read_b128 v[60:63], v236 offset:12288
    v_mfma_f32_16x16x32_bf16 v[32:35], v[104:107], v[84:87], v[32:35]
    ds_read_b128 v[64:67], v236 offset:14336
    ds_read_b128 v[68:71], v236 offset:16384
    buffer_load_dwordx4 v225, s[8:11], s47 offen offset:1024 lds
    v_mfma_f32_16x16x32_bf16 v[40:43], v[104:107], v[88:91], v[40:43]
    ds_read_b64_tr_b16 v[100:101], v235 offset:0
    ds_read_b64_tr_b16 v[102:103], v235 offset:1024
    v_mfma_f32_16x16x32_bf16 v[20:23], v[108:111], v[76:79], v[20:23]
    buffer_load_dwordx4 v226, s[8:11], s47 offen offset:2048 lds
    v_mfma_f32_16x16x32_bf16 v[28:31], v[108:111], v[80:83], v[28:31]
    buffer_load_dwordx4 v227, s[8:11], s47 offen offset:3072 lds
    v_mfma_f32_16x16x32_bf16 v[36:39], v[108:111], v[84:87], v[36:39]
    v_mfma_f32_16x16x32_bf16 v[44:47], v[108:111], v[88:91], v[44:47]
    s_add_u32 m0, s61, 116736
    s_lshl_b32 s47, s46, 7
    s_nop 0
    buffer_load_dwordx4 v248, s[12:15], s47 offen offset:0 lds
    s_waitcnt lgkmcnt(0)
    s_nop 0
    v_mfma_f32_16x16x32_bf16 v[16:19], v[96:99], v[56:59], v[16:19]
    ds_read_b64_tr_b16 v[104:105], v234 offset:8192
    ds_read_b64_tr_b16 v[106:107], v234 offset:9216
    buffer_load_dwordx4 v249, s[12:15], s47 offen offset:1024 lds
    v_mfma_f32_16x16x32_bf16 v[24:27], v[96:99], v[60:63], v[24:27]
    ds_read_b128 v[76:79], v236 offset:10496
    ds_read_b128 v[80:83], v236 offset:12544
    v_mfma_f32_16x16x32_bf16 v[32:35], v[96:99], v[64:67], v[32:35]
    ds_read_b128 v[84:87], v236 offset:14592
    ds_read_b128 v[88:91], v236 offset:16640
    buffer_load_dwordx4 v250, s[12:15], s47 offen offset:2048 lds
    v_mfma_f32_16x16x32_bf16 v[40:43], v[96:99], v[68:71], v[40:43]
    ds_read_b64_tr_b16 v[108:109], v235 offset:8192
    ds_read_b64_tr_b16 v[110:111], v235 offset:9216
    v_mfma_f32_16x16x32_bf16 v[20:23], v[100:103], v[56:59], v[20:23]
    buffer_load_dwordx4 v251, s[12:15], s47 offen offset:3072 lds
    v_mfma_f32_16x16x32_bf16 v[28:31], v[100:103], v[60:63], v[28:31]
    v_mfma_f32_16x16x32_bf16 v[36:39], v[100:103], v[64:67], v[36:39]
    s_add_u32 m0, s61, 120832
    s_nop 0
    s_nop 0
    buffer_load_dwordx4 v252, s[12:15], s47 offen offset:0 lds
    v_mfma_f32_16x16x32_bf16 v[44:47], v[100:103], v[68:71], v[44:47]
    s_waitcnt vmcnt(9)
    s_nop 0
    v_add_u32 v234, 32768, v231
    v_add_u32 v235, 32768, v232
    v_add_u32 v236, 98304, v233
    s_waitcnt lgkmcnt(0)
    s_barrier
    v_mfma_f32_16x16x32_bf16 v[16:19], v[104:107], v[76:79], v[16:19]
    ds_read_b64_tr_b16 v[96:97], v234 offset:0
    ds_read_b64_tr_b16 v[98:99], v234 offset:1024
    s_add_u32 s46, s41, 5
    s_and_b32 s46, s46, 7
    s_lshl_b32 s47, s46, 19
    s_add_u32 m0, s63, 0
    s_nop 0
    s_nop 0
    buffer_load_dwordx4 v224, s[8:11], s47 offen offset:0 lds
    v_mfma_f32_16x16x32_bf16 v[24:27], v[104:107], v[80:83], v[24:27]
    ds_read_b128 v[56:59], v236 offset:10240
    ds_read_b128 v[60:63], v236 offset:12288
    v_mfma_f32_16x16x32_bf16 v[32:35], v[104:107], v[84:87], v[32:35]
    ds_read_b128 v[64:67], v236 offset:14336
    ds_read_b128 v[68:71], v236 offset:16384
    buffer_load_dwordx4 v225, s[8:11], s47 offen offset:1024 lds
    v_mfma_f32_16x16x32_bf16 v[40:43], v[104:107], v[88:91], v[40:43]
    ds_read_b64_tr_b16 v[100:101], v235 offset:0
    ds_read_b64_tr_b16 v[102:103], v235 offset:1024
    v_mfma_f32_16x16x32_bf16 v[20:23], v[108:111], v[76:79], v[20:23]
    buffer_load_dwordx4 v226, s[8:11], s47 offen offset:2048 lds
    v_mfma_f32_16x16x32_bf16 v[28:31], v[108:111], v[80:83], v[28:31]
    buffer_load_dwordx4 v227, s[8:11], s47 offen offset:3072 lds
    v_mfma_f32_16x16x32_bf16 v[36:39], v[108:111], v[84:87], v[36:39]
    v_mfma_f32_16x16x32_bf16 v[44:47], v[108:111], v[88:91], v[44:47]
    s_add_u32 m0, s61, 135168
    s_lshl_b32 s47, s46, 7
    s_nop 0
    buffer_load_dwordx4 v248, s[12:15], s47 offen offset:0 lds
    s_waitcnt lgkmcnt(0)
    s_nop 0
    v_mfma_f32_16x16x32_bf16 v[16:19], v[96:99], v[56:59], v[16:19]
    ds_read_b64_tr_b16 v[104:105], v234 offset:8192
    ds_read_b64_tr_b16 v[106:107], v234 offset:9216
    buffer_load_dwordx4 v249, s[12:15], s47 offen offset:1024 lds
    v_mfma_f32_16x16x32_bf16 v[24:27], v[96:99], v[60:63], v[24:27]
    ds_read_b128 v[76:79], v236 offset:10496
    ds_read_b128 v[80:83], v236 offset:12544
    v_mfma_f32_16x16x32_bf16 v[32:35], v[96:99], v[64:67], v[32:35]
    ds_read_b128 v[84:87], v236 offset:14592
    ds_read_b128 v[88:91], v236 offset:16640
    buffer_load_dwordx4 v250, s[12:15], s47 offen offset:2048 lds
    v_mfma_f32_16x16x32_bf16 v[40:43], v[96:99], v[68:71], v[40:43]
    ds_read_b64_tr_b16 v[108:109], v235 offset:8192
    ds_read_b64_tr_b16 v[110:111], v235 offset:9216
    v_mfma_f32_16x16x32_bf16 v[20:23], v[100:103], v[56:59], v[20:23]
    buffer_load_dwordx4 v251, s[12:15], s47 offen offset:3072 lds
    v_mfma_f32_16x16x32_bf16 v[28:31], v[100:103], v[60:63], v[28:31]
    v_mfma_f32_16x16x32_bf16 v[36:39], v[100:103], v[64:67], v[36:39]
    s_add_u32 m0, s61, 139264
    s_nop 0
    s_nop 0
    buffer_load_dwordx4 v252, s[12:15], s47 offen offset:0 lds
    v_mfma_f32_16x16x32_bf16 v[44:47], v[100:103], v[68:71], v[44:47]
    s_waitcnt vmcnt(9)
    s_nop 0
    v_add_u32 v234, 49152, v231
    v_add_u32 v235, 49152, v232
    v_add_u32 v236, 116736, v233
    s_waitcnt lgkmcnt(0)
    s_barrier
    v_mfma_f32_16x16x32_bf16 v[16:19], v[104:107], v[76:79], v[16:19]
    ds_read_b64_tr_b16 v[96:97], v234 offset:0
    ds_read_b64_tr_b16 v[98:99], v234 offset:1024
    s_add_u32 s46, s41, 6
    s_and_b32 s46, s46, 7
    s_lshl_b32 s47, s46, 19
    s_nop 0
    s_add_u32 m0, s63, 32768
    s_nop 0
    s_nop 0
    buffer_load_dwordx4 v224, s[8:11], s47 offen offset:0 lds
    v_mfma_f32_16x16x32_bf16 v[24:27], v[104:107], v[80:83], v[24:27]
    ds_read_b128 v[56:59], v236 offset:10240
    ds_read_b128 v[60:63], v236 offset:12288
    v_mfma_f32_16x16x32_bf16 v[32:35], v[104:107], v[84:87], v[32:35]
    ds_read_b128 v[64:67], v236 offset:14336
    ds_read_b128 v[68:71], v236 offset:16384
    buffer_load_dwordx4 v225, s[8:11], s47 offen offset:1024 lds
    v_mfma_f32_16x16x32_bf16 v[40:43], v[104:107], v[88:91], v[40:43]
    ds_read_b64_tr_b16 v[100:101], v235 offset:0
    ds_read_b64_tr_b16 v[102:103], v235 offset:1024
    v_mfma_f32_16x16x32_bf16 v[20:23], v[108:111], v[76:79], v[20:23]
    buffer_load_dwordx4 v226, s[8:11], s47 offen offset:2048 lds
    v_mfma_f32_16x16x32_bf16 v[28:31], v[108:111], v[80:83], v[28:31]
    buffer_load_dwordx4 v227, s[8:11], s47 offen offset:3072 lds
    v_mfma_f32_16x16x32_bf16 v[36:39], v[108:111], v[84:87], v[36:39]
    v_mfma_f32_16x16x32_bf16 v[44:47], v[108:111], v[88:91], v[44:47]
    s_add_u32 m0, s61, 98304
    s_lshl_b32 s47, s46, 7
    s_nop 0
    buffer_load_dwordx4 v248, s[12:15], s47 offen offset:0 lds
    s_waitcnt lgkmcnt(0)
    s_nop 0
    v_mfma_f32_16x16x32_bf16 v[16:19], v[96:99], v[56:59], v[16:19]
    ds_read_b64_tr_b16 v[104:105], v234 offset:8192
    ds_read_b64_tr_b16 v[106:107], v234 offset:9216
    buffer_load_dwordx4 v249, s[12:15], s47 offen offset:1024 lds
    v_mfma_f32_16x16x32_bf16 v[24:27], v[96:99], v[60:63], v[24:27]
    ds_read_b128 v[76:79], v236 offset:10496
    ds_read_b128 v[80:83], v236 offset:12544
    v_mfma_f32_16x16x32_bf16 v[32:35], v[96:99], v[64:67], v[32:35]
    ds_read_b128 v[84:87], v236 offset:14592
    ds_read_b128 v[88:91], v236 offset:16640
    buffer_load_dwordx4 v250, s[12:15], s47 offen offset:2048 lds
    v_mfma_f32_16x16x32_bf16 v[40:43], v[96:99], v[68:71], v[40:43]
    ds_read_b64_tr_b16 v[108:109], v235 offset:8192
    ds_read_b64_tr_b16 v[110:111], v235 offset:9216
    v_mfma_f32_16x16x32_bf16 v[20:23], v[100:103], v[56:59], v[20:23]
    buffer_load_dwordx4 v251, s[12:15], s47 offen offset:3072 lds
    v_mfma_f32_16x16x32_bf16 v[28:31], v[100:103], v[60:63], v[28:31]
    v_mfma_f32_16x16x32_bf16 v[36:39], v[100:103], v[64:67], v[36:39]
    s_add_u32 m0, s61, 102400
    s_nop 0
    s_nop 0
    buffer_load_dwordx4 v252, s[12:15], s47 offen offset:0 lds
    v_mfma_f32_16x16x32_bf16 v[44:47], v[100:103], v[68:71], v[44:47]
    s_waitcnt vmcnt(9)
    v_add_u32 v234, 0, v231
    v_add_u32_e64 v235, 0, v232
    v_add_u32 v236, 135168, v233
    s_waitcnt lgkmcnt(0)
    s_barrier
    v_mfma_f32_16x16x32_bf16 v[16:19], v[104:107], v[76:79], v[16:19]
    ds_read_b64_tr_b16 v[96:97], v234 offset:0
    ds_read_b64_tr_b16 v[98:99], v234 offset:1024
    s_add_u32 s46, s41, 7
    s_and_b32 s46, s46, 7
    s_lshl_b32 s47, s46, 19
    s_nop 0
    s_add_u32 m0, s63, 49152
    s_nop 0
    s_nop 0
    buffer_load_dwordx4 v224, s[8:11], s47 offen offset:0 lds
    v_mfma_f32_16x16x32_bf16 v[24:27], v[104:107], v[80:83], v[24:27]
    ds_read_b128 v[56:59], v236 offset:10240
    ds_read_b128 v[60:63], v236 offset:12288
    v_mfma_f32_16x16x32_bf16 v[32:35], v[104:107], v[84:87], v[32:35]
    ds_read_b128 v[64:67], v236 offset:14336
    ds_read_b128 v[68:71], v236 offset:16384
    buffer_load_dwordx4 v225, s[8:11], s47 offen offset:1024 lds
    v_mfma_f32_16x16x32_bf16 v[40:43], v[104:107], v[88:91], v[40:43]
    ds_read_b64_tr_b16 v[100:101], v235 offset:0
    ds_read_b64_tr_b16 v[102:103], v235 offset:1024
    v_mfma_f32_16x16x32_bf16 v[20:23], v[108:111], v[76:79], v[20:23]
    buffer_load_dwordx4 v226, s[8:11], s47 offen offset:2048 lds
    v_mfma_f32_16x16x32_bf16 v[28:31], v[108:111], v[80:83], v[28:31]
    buffer_load_dwordx4 v227, s[8:11], s47 offen offset:3072 lds
    v_mfma_f32_16x16x32_bf16 v[36:39], v[108:111], v[84:87], v[36:39]
    v_mfma_f32_16x16x32_bf16 v[44:47], v[108:111], v[88:91], v[44:47]
    s_add_u32 m0, s61, 116736
    s_lshl_b32 s47, s46, 7
    s_nop 0
    buffer_load_dwordx4 v248, s[12:15], s47 offen offset:0 lds
    s_waitcnt lgkmcnt(0)
    s_nop 0
    v_mfma_f32_16x16x32_bf16 v[16:19], v[96:99], v[56:59], v[16:19]
    ds_read_b64_tr_b16 v[104:105], v234 offset:8192
    ds_read_b64_tr_b16 v[106:107], v234 offset:9216
    buffer_load_dwordx4 v249, s[12:15], s47 offen offset:1024 lds
    v_mfma_f32_16x16x32_bf16 v[24:27], v[96:99], v[60:63], v[24:27]
    ds_read_b128 v[76:79], v236 offset:10496
    ds_read_b128 v[80:83], v236 offset:12544
    v_mfma_f32_16x16x32_bf16 v[32:35], v[96:99], v[64:67], v[32:35]
    ds_read_b128 v[84:87], v236 offset:14592
    ds_read_b128 v[88:91], v236 offset:16640
    buffer_load_dwordx4 v250, s[12:15], s47 offen offset:2048 lds
    v_mfma_f32_16x16x32_bf16 v[40:43], v[96:99], v[68:71], v[40:43]
    ds_read_b64_tr_b16 v[108:109], v235 offset:8192
    ds_read_b64_tr_b16 v[110:111], v235 offset:9216
    v_mfma_f32_16x16x32_bf16 v[20:23], v[100:103], v[56:59], v[20:23]
    buffer_load_dwordx4 v251, s[12:15], s47 offen offset:3072 lds
    v_mfma_f32_16x16x32_bf16 v[28:31], v[100:103], v[60:63], v[28:31]
    v_mfma_f32_16x16x32_bf16 v[36:39], v[100:103], v[64:67], v[36:39]
    s_add_u32 m0, s61, 120832
    s_nop 0
    s_nop 0
    buffer_load_dwordx4 v252, s[12:15], s47 offen offset:0 lds
    v_mfma_f32_16x16x32_bf16 v[44:47], v[100:103], v[68:71], v[44:47]
    s_waitcnt vmcnt(9)
    s_nop 0
    v_add_u32 v234, 32768, v231
    v_add_u32 v235, 32768, v232
    v_add_u32 v236, 98304, v233
    s_waitcnt lgkmcnt(0)
    s_barrier
    v_mfma_f32_16x16x32_bf16 v[16:19], v[104:107], v[76:79], v[16:19]
    ds_read_b64_tr_b16 v[96:97], v234 offset:0
    ds_read_b64_tr_b16 v[98:99], v234 offset:1024
    v_mfma_f32_16x16x32_bf16 v[24:27], v[104:107], v[80:83], v[24:27]
    ds_read_b128 v[56:59], v236 offset:10240
    ds_read_b128 v[60:63], v236 offset:12288
    v_mfma_f32_16x16x32_bf16 v[32:35], v[104:107], v[84:87], v[32:35]
    ds_read_b128 v[64:67], v236 offset:14336
    ds_read_b128 v[68:71], v236 offset:16384
    v_mfma_f32_16x16x32_bf16 v[40:43], v[104:107], v[88:91], v[40:43]
    ds_read_b64_tr_b16 v[100:101], v235 offset:0
    ds_read_b64_tr_b16 v[102:103], v235 offset:1024
    v_mfma_f32_16x16x32_bf16 v[20:23], v[108:111], v[76:79], v[20:23]
    v_mfma_f32_16x16x32_bf16 v[28:31], v[108:111], v[80:83], v[28:31]
    v_mfma_f32_16x16x32_bf16 v[36:39], v[108:111], v[84:87], v[36:39]
    v_mfma_f32_16x16x32_bf16 v[44:47], v[108:111], v[88:91], v[44:47]
    s_waitcnt lgkmcnt(0)
    s_nop 0
    v_mfma_f32_16x16x32_bf16 v[16:19], v[96:99], v[56:59], v[16:19]
    ds_read_b64_tr_b16 v[104:105], v234 offset:8192
    ds_read_b64_tr_b16 v[106:107], v234 offset:9216
    v_mfma_f32_16x16x32_bf16 v[24:27], v[96:99], v[60:63], v[24:27]
    ds_read_b128 v[76:79], v236 offset:10496
    ds_read_b128 v[80:83], v236 offset:12544
    v_mfma_f32_16x16x32_bf16 v[32:35], v[96:99], v[64:67], v[32:35]
    ds_read_b128 v[84:87], v236 offset:14592
    ds_read_b128 v[88:91], v236 offset:16640
    v_mfma_f32_16x16x32_bf16 v[40:43], v[96:99], v[68:71], v[40:43]
    ds_read_b64_tr_b16 v[108:109], v235 offset:8192
    ds_read_b64_tr_b16 v[110:111], v235 offset:9216
    v_mfma_f32_16x16x32_bf16 v[20:23], v[100:103], v[56:59], v[20:23]
    v_mfma_f32_16x16x32_bf16 v[28:31], v[100:103], v[60:63], v[28:31]
    v_mfma_f32_16x16x32_bf16 v[36:39], v[100:103], v[64:67], v[36:39]
    v_mfma_f32_16x16x32_bf16 v[44:47], v[100:103], v[68:71], v[44:47]
    s_waitcnt vmcnt(0)
    s_nop 0
    v_add_u32 v234, 49152, v231
    v_add_u32 v235, 49152, v232
    v_add_u32 v236, 116736, v233
    s_waitcnt lgkmcnt(0)
    s_barrier
    v_mfma_f32_16x16x32_bf16 v[16:19], v[104:107], v[76:79], v[16:19]
    ds_read_b64_tr_b16 v[96:97], v234 offset:0
    ds_read_b64_tr_b16 v[98:99], v234 offset:1024
    v_mfma_f32_16x16x32_bf16 v[24:27], v[104:107], v[80:83], v[24:27]
    ds_read_b128 v[56:59], v236 offset:10240
    ds_read_b128 v[60:63], v236 offset:12288
    v_mfma_f32_16x16x32_bf16 v[32:35], v[104:107], v[84:87], v[32:35]
    ds_read_b128 v[64:67], v236 offset:14336
    ds_read_b128 v[68:71], v236 offset:16384
    v_mfma_f32_16x16x32_bf16 v[40:43], v[104:107], v[88:91], v[40:43]
    ds_read_b64_tr_b16 v[100:101], v235 offset:0
    ds_read_b64_tr_b16 v[102:103], v235 offset:1024
    v_mfma_f32_16x16x32_bf16 v[20:23], v[108:111], v[76:79], v[20:23]
    v_mfma_f32_16x16x32_bf16 v[28:31], v[108:111], v[80:83], v[28:31]
    v_mfma_f32_16x16x32_bf16 v[36:39], v[108:111], v[84:87], v[36:39]
    v_mfma_f32_16x16x32_bf16 v[44:47], v[108:111], v[88:91], v[44:47]
    s_waitcnt lgkmcnt(0)
    s_nop 0
    v_mfma_f32_16x16x32_bf16 v[16:19], v[96:99], v[56:59], v[16:19]
    ds_read_b64_tr_b16 v[104:105], v234 offset:8192
    ds_read_b64_tr_b16 v[106:107], v234 offset:9216
    v_mfma_f32_16x16x32_bf16 v[24:27], v[96:99], v[60:63], v[24:27]
    ds_read_b128 v[76:79], v236 offset:10496
    ds_read_b128 v[80:83], v236 offset:12544
    v_mfma_f32_16x16x32_bf16 v[32:35], v[96:99], v[64:67], v[32:35]
    ds_read_b128 v[84:87], v236 offset:14592
    ds_read_b128 v[88:91], v236 offset:16640
    v_mfma_f32_16x16x32_bf16 v[40:43], v[96:99], v[68:71], v[40:43]
    ds_read_b64_tr_b16 v[108:109], v235 offset:8192
    ds_read_b64_tr_b16 v[110:111], v235 offset:9216
    v_mfma_f32_16x16x32_bf16 v[20:23], v[100:103], v[56:59], v[20:23]
    v_mfma_f32_16x16x32_bf16 v[28:31], v[100:103], v[60:63], v[28:31]
    v_mfma_f32_16x16x32_bf16 v[36:39], v[100:103], v[64:67], v[36:39]
    v_mfma_f32_16x16x32_bf16 v[44:47], v[100:103], v[68:71], v[44:47]
    s_waitcnt lgkmcnt(5)
    s_nop 0
    v_mfma_f32_16x16x32_bf16 v[16:19], v[104:107], v[76:79], v[16:19]
    s_waitcnt lgkmcnt(4)
    s_nop 0
    v_mfma_f32_16x16x32_bf16 v[24:27], v[104:107], v[80:83], v[24:27]
    s_waitcnt lgkmcnt(3)
    s_nop 0
    v_mfma_f32_16x16x32_bf16 v[32:35], v[104:107], v[84:87], v[32:35]
    s_waitcnt lgkmcnt(2)
    s_nop 0
    v_mfma_f32_16x16x32_bf16 v[40:43], v[104:107], v[88:91], v[40:43]
    s_waitcnt lgkmcnt(0)
    s_nop 0
    v_mfma_f32_16x16x32_bf16 v[20:23], v[108:111], v[76:79], v[20:23]
    v_mfma_f32_16x16x32_bf16 v[28:31], v[108:111], v[80:83], v[28:31]
    v_mfma_f32_16x16x32_bf16 v[36:39], v[108:111], v[84:87], v[36:39]
    v_mfma_f32_16x16x32_bf16 v[44:47], v[108:111], v[88:91], v[44:47]
    s_and_b32 s60, s36, 3
    s_lshl_b32 s60, s60, 10
    v_lshlrev_b32 v236, 4, v12
    v_add_u32 v236, s60, v236
    v_add_u32 v234, 135168, v236
    v_add_u32 v235, 32768, v236
    v_pk_mul_f32 v[16:17], v[16:17], v[238:239]
    v_pk_mul_f32 v[18:19], v[18:19], v[238:239]
    v_pk_mul_f32 v[20:21], v[20:21], v[238:239]
    v_pk_mul_f32 v[22:23], v[22:23], v[238:239]
    v_cvt_pk_bf16_f32 v16, v16, v17
    v_cvt_pk_bf16_f32 v17, v18, v19
    v_cvt_pk_bf16_f32 v18, v20, v21
    v_cvt_pk_bf16_f32 v19, v22, v23
    v_pk_mul_f32 v[24:25], v[24:25], v[238:239]
    v_pk_mul_f32 v[26:27], v[26:27], v[238:239]
    v_pk_mul_f32 v[28:29], v[28:29], v[238:239]
    v_pk_mul_f32 v[30:31], v[30:31], v[238:239]
    v_cvt_pk_bf16_f32 v24, v24, v25
    v_cvt_pk_bf16_f32 v25, v26, v27
    v_cvt_pk_bf16_f32 v26, v28, v29
    v_cvt_pk_bf16_f32 v27, v30, v31
    v_pk_mul_f32 v[32:33], v[32:33], v[238:239]
    v_pk_mul_f32 v[34:35], v[34:35], v[238:239]
    v_pk_mul_f32 v[36:37], v[36:37], v[238:239]
    v_pk_mul_f32 v[38:39], v[38:39], v[238:239]
    v_cvt_pk_bf16_f32 v32, v32, v33
    v_cvt_pk_bf16_f32 v33, v34, v35
    v_cvt_pk_bf16_f32 v34, v36, v37
    v_cvt_pk_bf16_f32 v35, v38, v39
    v_pk_mul_f32 v[40:41], v[40:41], v[238:239]
    v_pk_mul_f32 v[42:43], v[42:43], v[238:239]
    v_pk_mul_f32 v[44:45], v[44:45], v[238:239]
    v_pk_mul_f32 v[46:47], v[46:47], v[238:239]
    v_cvt_pk_bf16_f32 v40, v40, v41
    v_cvt_pk_bf16_f32 v41, v42, v43
    v_cvt_pk_bf16_f32 v42, v44, v45
    v_cvt_pk_bf16_f32 v43, v46, v47
    v_permlane16_swap_b32 v16, v18
    v_permlane16_swap_b32 v17, v19
    v_permlane16_swap_b32 v24, v26
    v_permlane16_swap_b32 v25, v27
    v_permlane16_swap_b32 v32, v34
    v_permlane16_swap_b32 v33, v35
    v_permlane16_swap_b32 v40, v42
    v_permlane16_swap_b32 v41, v43
    ds_write_b128 v234, v[16:19] offset:20480
    ds_write_b128 v235, v[24:27] offset:0
    ds_write_b128 v235, v[32:35] offset:4096
    ds_write_b128 v235, v[40:43] offset:8192
    s_setprio 0
    s_waitcnt lgkmcnt(0)
    s_barrier
L_att:
    s_waitcnt vmcnt(0)
    v_lshlrev_b32_e64 v4, 4, v12
    s_mul_i32 s42, s62, 12288
    s_add_u32 s42, s42, 135168
    s_cmp_eq_u32 s62, 2
    s_nop 0
    s_cselect_b32 s42, 32768, s42
    v_add_u32_e64 v5, s42, v4
    ds_read_b128 v[16:19], v5 offset:0
    ds_read_b128 v[20:23], v5 offset:1024
    ds_read_b128 v[24:27], v5 offset:2048
    ds_read_b128 v[28:31], v5 offset:3072
    ds_read_b128 v[32:35], v5 offset:4096
    ds_read_b128 v[36:39], v5 offset:5120
    ds_read_b128 v[40:43], v5 offset:6144
    ds_read_b128 v[44:47], v5 offset:7168
    ds_read_b128 v[48:51], v5 offset:8192
    ds_read_b128 v[52:55], v5 offset:9216
    ds_read_b128 v[56:59], v5 offset:10240
    ds_read_b128 v[60:63], v5 offset:11264
    s_xor_b32 s57, s36, 1
    s_lshl_b32 s42, s36, 2
    s_add_u32 s42, s42, 163744
    s_lshl_b32 s43, s57, 2
    s_nop 0
    s_add_u32 s43, s43, 163744
    v_mov_b32 v6, s42
    v_mov_b32 v7, s43
    s_mov_b32 s46, 0x40004000
    s_mov_b32 s47, 0x41000000
    s_mov_b32 s50, 0
    s_mov_b32 s52, 0
    s_mov_b32 s48, 2
    s_nop 0
    s_mov_b32 s51, 135168
    s_mul_i32 s53, s62, 12288
    s_add_u32 s53, s53, 98304
    s_mov_b32 s55, 0xffff0000
    s_mov_b32 s56, 32768
    s_lshl_b32 s42, s38, 3
    s_lshl_b32 s43, s59, 1
    s_add_u32 s42, s42, s43
    s_mul_i32 s42, s42, 9
    s_mul_i32 s43, s62, 3
    s_add_u32 s42, s42, s43
    s_lshl_b32 s54, s42, 10
    s_nop 0
    s_add_u32 s54, s54, 36864
L_item:
    s_setprio 0
    s_mov_b32 s45, 0
    s_waitcnt lgkmcnt(0)
    s_barrier
    ds_read_b128 v[240:243], v1 offset:0
    ds_read_b128 v[244:247], v1 offset:256
    ds_read_b128 v[248:251], v1 offset:512
    ds_read_b128 v[252:255], v1 offset:768
    ds_read_b128 v[224:227], v1 offset:4096
    ds_read_b128 v[228:231], v1 offset:4352
    ds_read_b128 v[232:235], v1 offset:4608
    ds_read_b128 v[236:239], v1 offset:4864
    ds_read_b64_tr_b16 v[208:209], v2 offset:0
    ds_read_b64_tr_b16 v[210:211], v2 offset:4096
    ds_read_b64_tr_b16 v[212:213], v3 offset:0
    ds_read_b64_tr_b16 v[214:215], v3 offset:4096
    ds_read_b64_tr_b16 v[216:217], v2 offset:256
    ds_read_b64_tr_b16 v[218:219], v2 offset:4352
    ds_read_b64_tr_b16 v[220:221], v3 offset:256
    ds_read_b64_tr_b16 v[222:223], v3 offset:4352
    v_mov_b64 v[128:129], 0
    v_mov_b64 v[130:131], 0
    v_mov_b64 v[132:133], 0
    v_mov_b64 v[134:135], 0
    v_mov_b64 v[136:137], 0
    v_mov_b64 v[138:139], 0
    v_mov_b64 v[140:141], 0
    v_mov_b64 v[142:143], 0
    v_mov_b64 v[144:145], 0
    v_mov_b64 v[146:147], 0
    v_mov_b64 v[148:149], 0
    v_mov_b64 v[150:151], 0
    v_mov_b64 v[152:153], 0
    v_mov_b64 v[154:155], 0
    v_mov_b64 v[156:157], 0
    v_mov_b64 v[158:159], 0
    v_mov_b64_e64 v[168:169], 0
    v_mov_b64 v[170:171], 0
    s_waitcnt lgkmcnt(12)
    v_mfma_f32_16x16x32_bf16 v[184:187], v[240:243], v[16:19], 0
    v_mfma_f32_16x16x32_bf16 v[184:187], v[244:247], v[20:23], v[184:187]
    v_mfma_f32_16x16x32_bf16 v[184:187], v[248:251], v[24:27], v[184:187]
    v_mfma_f32_16x16x32_bf16 v[184:187], v[252:255], v[28:31], v[184:187]
    s_waitcnt lgkmcnt(8)
    s_add_u32 s48, s48, 1
    v_mfma_f32_16x16x32_bf16 v[188:191], v[224:227], v[16:19], 0
    s_cmp_eq_u32 s48, 3
    s_cselect_b32 s49, s55, s56
    v_mfma_f32_16x16x32_bf16 v[188:191], v[228:231], v[20:23], v[188:191]
    s_cselect_b32 s48, 0, s48
    s_add_u32 s45, s45, 1
    v_mfma_f32_16x16x32_bf16 v[188:191], v[232:235], v[24:27], v[188:191]
    v_mfma_f32_16x16x32_bf16 v[188:191], v[236:239], v[28:31], v[188:191]
    v_mfma_f32_16x16x32_bf16 v[192:195], v[240:243], v[32:35], 0
    v_mfma_f32_16x16x32_bf16 v[192:195], v[244:247], v[36:39], v[192:195]
    v_mfma_f32_16x16x32_bf16 v[192:195], v[248:251], v[40:43], v[192:195]
    v_max3_f32 v12, v184, v185, v186
    s_nop 3
    s_nop 0
    v_max3_f32 v13, v187, v188, v189
    v_max3_f32 v12, v12, v190, v191
    v_max_f32_e64 v12, v12, v13
    v_mfma_f32_16x16x32_bf16 v[192:195], v[252:255], v[44:47], v[192:195]
    v_mov_b32 v13, v12
    s_nop 1
    v_permlane16_swap_b32 v12, v13
    v_max_f32 v12, v12, v13
    v_mfma_f32_16x16x32_bf16 v[196:199], v[224:227], v[32:35], 0
    v_mov_b32 v13, v12
    s_nop 1
    v_permlane32_swap_b32 v12, v13
    v_max_f32 v12, v12, v13
    v_mfma_f32_16x16x32_bf16 v[196:199], v[228:231], v[36:39], v[196:199]
    v_add_f32 v12, s47, v12
    v_sub_f32 v184, v184, v12
    v_sub_f32_e64 v185, v185, v12
    v_mfma_f32_16x16x32_bf16 v[196:199], v[232:235], v[40:43], v[196:199]
    v_sub_f32 v186, v186, v12
    v_sub_f32 v187, v187, v12
    v_sub_f32_e64 v188, v188, v12
    v_mfma_f32_16x16x32_bf16 v[196:199], v[236:239], v[44:47], v[196:199]
    v_sub_f32 v189, v189, v12
    v_sub_f32 v190, v190, v12
    v_sub_f32 v191, v191, v12
    v_sub_f32 v172, 0, v12
    v_mfma_f32_16x16x32_bf16 v[204:207], v[224:227], v[48:51], 0
    ds_read_b64_tr_b16 v[224:225], v2 offset:512
    ds_read_b64_tr_b16 v[226:227], v2 offset:4608
    v_sub_f32 v173, 0, v12
    v_sub_f32 v174, 0, v12
    v_sub_f32_e64 v175, 0, v12
    v_mfma_f32_16x16x32_bf16 v[204:207], v[228:231], v[52:55], v[204:207]
    ds_read_b64_tr_b16 v[228:229], v3 offset:512
    ds_read_b64_tr_b16 v[230:231], v3 offset:4608
    v_exp_f32 v184, v184
    v_exp_f32 v185, v185
    v_exp_f32_e64 v186, v186
    v_mfma_f32_16x16x32_bf16 v[204:207], v[232:235], v[56:59], v[204:207]
    ds_read_b64_tr_b16 v[232:233], v2 offset:768
    ds_read_b64_tr_b16 v[234:235], v2 offset:4864
    v_exp_f32 v187, v187
    v_exp_f32 v188, v188
    v_exp_f32_e64 v189, v189
    v_mfma_f32_16x16x32_bf16 v[204:207], v[236:239], v[60:63], v[204:207]
    ds_read_b64_tr_b16 v[236:237], v3 offset:768
    ds_read_b64_tr_b16 v[238:239], v3 offset:4864
    v_exp_f32 v190, v190
    v_exp_f32 v191, v191
    v_cvt_pk_bf16_f32 v184, v184, v185
    v_mfma_f32_16x16x32_bf16 v[200:203], v[240:243], v[48:51], 0
    v_cvt_pk_bf16_f32 v185, v186, v187
    v_cvt_pk_bf16_f32 v186, v188, v189
    v_cvt_pk_bf16_f32 v187, v190, v191
    v_mfma_f32_16x16x32_bf16 v[200:203], v[244:247], v[52:55], v[200:203]
    v_max3_f32 v12, v192, v193, v194
    v_max3_f32 v13, v195, v196, v197
    v_max3_f32 v12, v12, v198, v199
    v_max_f32_e64 v12, v12, v13
    v_mfma_f32_16x16x32_bf16 v[200:203], v[248:251], v[56:59], v[200:203]
    v_mov_b32 v13, v12
    s_nop 1
    v_permlane16_swap_b32 v12, v13
    v_max_f32 v12, v12, v13
    v_mfma_f32_16x16x32_bf16 v[200:203], v[252:255], v[60:63], v[200:203]
    v_mov_b32_e64 v13, v12
    s_nop 1
    v_permlane32_swap_b32 v12, v13
    v_max_f32 v12, v12, v13
    s_waitcnt lgkmcnt(8)
    v_mfma_f32_16x16x32_bf16 v[64:67], v[208:211], v[184:187], 0
    v_add_f32 v12, s47, v12
    v_sub_f32 v192, v192, v12
    v_sub_f32_e64 v193, v193, v12
    v_mfma_f32_16x16x32_bf16 v[68:71], v[212:215], v[184:187], 0
    v_sub_f32 v194, v194, v12
    v_sub_f32 v195, v195, v12
    v_sub_f32_e64 v196, v196, v12
    v_mfma_f32_16x16x32_bf16 v[72:75], v[216:219], v[184:187], 0
    v_sub_f32 v197, v197, v12
    v_sub_f32 v198, v198, v12
    v_sub_f32 v199, v199, v12
    v_sub_f32 v176, 0, v12
    v_mfma_f32_16x16x32_bf16 v[76:79], v[220:223], v[184:187], 0
    v_sub_f32 v177, 0, v12
    v_sub_f32 v178, 0, v12
    v_sub_f32_e64 v179, 0, v12
    v_mfma_f32_16x16x32_bf16 v[160:163], v[8:11], v[184:187], 0
    v_exp_f32 v192, v192
    v_exp_f32 v193, v193
    v_exp_f32 v194, v194
    s_waitcnt lgkmcnt(0)
    v_mfma_f32_16x16x32_bf16 v[80:83], v[224:227], v[184:187], 0
    v_exp_f32 v195, v195
    v_exp_f32 v196, v196
    v_exp_f32_e64 v197, v197
    v_mfma_f32_16x16x32_bf16 v[84:87], v[228:231], v[184:187], 0
    v_exp_f32 v198, v198
    v_exp_f32 v199, v199
    v_cvt_pk_bf16_f32 v192, v192, v193
    v_mfma_f32_16x16x32_bf16 v[88:91], v[232:235], v[184:187], 0
    v_cvt_pk_bf16_f32 v193, v194, v195
    v_cvt_pk_bf16_f32 v194, v196, v197
    v_cvt_pk_bf16_f32 v195, v198, v199
    v_mfma_f32_16x16x32_bf16 v[92:95], v[236:239], v[184:187], 0
    v_max3_f32 v12, v200, v201, v202
    v_max3_f32 v13, v203, v204, v205
    v_max3_f32 v12, v12, v206, v207
    v_max_f32_e64 v12, v12, v13
    v_mfma_f32_16x16x32_bf16 v[96:99], v[208:211], v[192:195], 0
    v_mov_b32 v13, v12
    s_nop 1
    v_permlane16_swap_b32 v12, v13
    v_max_f32 v12, v12, v13
    v_mfma_f32_16x16x32_bf16 v[100:103], v[212:215], v[192:195], 0
    v_mov_b32 v13, v12
    s_nop 1
    v_permlane32_swap_b32 v12, v13
    v_max_f32 v12, v12, v13
    v_add_f32_e64 v12, s47, v12
    v_mfma_f32_16x16x32_bf16 v[104:107], v[216:219], v[192:195], 0
    v_sub_f32 v200, v200, v12
    v_sub_f32 v201, v201, v12
    v_sub_f32_e64 v202, v202, v12
    v_mfma_f32_16x16x32_bf16 v[108:111], v[220:223], v[192:195], 0
    v_sub_f32 v203, v203, v12
    v_sub_f32 v204, v204, v12
    v_sub_f32 v205, v205, v12
    v_sub_f32 v206, v206, v12
    v_mfma_f32_16x16x32_bf16 v[164:167], v[8:11], v[192:195], 0
    v_sub_f32 v207, v207, v12
    v_sub_f32 v180, 0, v12
    v_sub_f32_e64 v181, 0, v12
    v_mfma_f32_16x16x32_bf16 v[112:115], v[224:227], v[192:195], 0
    v_sub_f32 v182, 0, v12
    v_sub_f32 v183, 0, v12
    v_exp_f32 v200, v200
    v_exp_f32 v201, v201
    v_mfma_f32_16x16x32_bf16 v[116:119], v[228:231], v[192:195], 0
    v_exp_f32 v202, v202
    v_exp_f32 v203, v203
    v_exp_f32_e64 v204, v204
    v_mfma_f32_16x16x32_bf16 v[120:123], v[232:235], v[192:195], 0
    v_exp_f32 v205, v205
    v_exp_f32 v206, v206
    v_exp_f32_e64 v207, v207
    v_cvt_pk_bf16_f32 v200, v200, v201
    v_mfma_f32_16x16x32_bf16 v[124:127], v[236:239], v[192:195], 0
    v_cvt_pk_bf16_f32 v201, v202, v203
    v_cvt_pk_bf16_f32 v202, v204, v205
    v_cvt_pk_bf16_f32 v203, v206, v207
    v_add_u32 v1, s49, v1
    v_add_u32 v2, s49, v2
    v_add_u32 v3, s49, v3
.p2align 6
L_loop:
    s_barrier
    s_nop 0
    ds_read_b128 v[240:243], v1 offset:0
    ds_read_b128 v[244:247], v1 offset:256
    ds_read_b128 v[248:251], v1 offset:512
    ds_read_b128 v[252:255], v1 offset:768
    v_mfma_f32_16x16x32_bf16 v[144:147], v[224:227], v[200:203], v[144:147]
    ds_read_b128 v[224:227], v1 offset:4096
    v_mfma_f32_16x16x32_bf16 v[148:151], v[228:231], v[200:203], v[148:151]
    ds_read_b128 v[228:231], v1 offset:4352
    v_mfma_f32_16x16x32_bf16 v[152:155], v[232:235], v[200:203], v[152:155]
    ds_read_b128 v[232:235], v1 offset:4608
    v_mfma_f32_16x16x32_bf16 v[156:159], v[236:239], v[200:203], v[156:159]
    ds_read_b128 v[236:239], v1 offset:4864
    v_mfma_f32_16x16x32_bf16 v[128:131], v[208:211], v[200:203], v[128:131]
    ds_read_b64_tr_b16 v[208:209], v2 offset:0
    ds_read_b64_tr_b16 v[210:211], v2 offset:4096
    v_mfma_f32_16x16x32_bf16 v[132:135], v[212:215], v[200:203], v[132:135]
    ds_read_b64_tr_b16 v[212:213], v3 offset:0
    ds_read_b64_tr_b16 v[214:215], v3 offset:4096
    v_mfma_f32_16x16x32_bf16 v[136:139], v[216:219], v[200:203], v[136:139]
    ds_read_b64_tr_b16 v[216:217], v2 offset:256
    ds_read_b64_tr_b16 v[218:219], v2 offset:4352
    v_mfma_f32_16x16x32_bf16 v[140:143], v[220:223], v[200:203], v[140:143]
    ds_read_b64_tr_b16 v[220:221], v3 offset:256
    ds_read_b64_tr_b16 v[222:223], v3 offset:4352
    v_mfma_f32_16x16x32_bf16 v[168:171], v[8:11], v[200:203], v[168:171]
    s_waitcnt lgkmcnt(12)
    s_nop 0
    v_mfma_f32_16x16x32_bf16 v[184:187], v[240:243], v[16:19], v[172:175]
    v_mfma_f32_16x16x32_bf16 v[184:187], v[244:247], v[20:23], v[184:187]
    v_mfma_f32_16x16x32_bf16 v[184:187], v[248:251], v[24:27], v[184:187]
    v_mfma_f32_16x16x32_bf16 v[184:187], v[252:255], v[28:31], v[184:187]
    s_waitcnt lgkmcnt(8)
    s_add_u32 s48, s48, 1
    v_mfma_f32_16x16x32_bf16 v[188:191], v[224:227], v[16:19], v[172:175]
    s_cmp_eq_u32 s48, 3
    s_cselect_b32 s49, s55, s56
    v_mfma_f32_16x16x32_bf16 v[188:191], v[228:231], v[20:23], v[188:191]
    s_cselect_b32 s48, 0, s48
    s_add_u32 s45, s45, 1
    v_mfma_f32_16x16x32_bf16 v[188:191], v[232:235], v[24:27], v[188:191]
    v_exp_f32_e64 v184, v184
    v_mfma_f32_16x16x32_bf16 v[188:191], v[236:239], v[28:31], v[188:191]
    v_exp_f32_e64 v185, v185
    v_mfma_f32_16x16x32_bf16 v[192:195], v[240:243], v[32:35], v[176:179]
    v_exp_f32_e64 v186, v186
    v_mfma_f32_16x16x32_bf16 v[192:195], v[244:247], v[36:39], v[192:195]
    v_exp_f32_e64 v187, v187
    v_mfma_f32_16x16x32_bf16 v[192:195], v[248:251], v[40:43], v[192:195]
    v_cvt_pk_bf16_f32 v184, v184, v185
    v_cvt_pk_bf16_f32 v185, v186, v187
    v_mfma_f32_16x16x32_bf16 v[192:195], v[252:255], v[44:47], v[192:195]
    v_exp_f32_e64 v188, v188
    v_mfma_f32_16x16x32_bf16 v[196:199], v[224:227], v[32:35], v[176:179]
    v_exp_f32_e64 v189, v189
    v_mfma_f32_16x16x32_bf16 v[196:199], v[228:231], v[36:39], v[196:199]
    v_exp_f32_e64 v190, v190
    v_mfma_f32_16x16x32_bf16 v[196:199], v[232:235], v[40:43], v[196:199]
    v_exp_f32_e64 v191, v191
    v_mfma_f32_16x16x32_bf16 v[196:199], v[236:239], v[44:47], v[196:199]
    v_cvt_pk_bf16_f32 v186, v188, v189
    v_cvt_pk_bf16_f32 v187, v190, v191
    v_mfma_f32_16x16x32_bf16 v[204:207], v[224:227], v[48:51], v[180:183]
    ds_read_b64_tr_b16 v[224:225], v2 offset:512
    ds_read_b64_tr_b16 v[226:227], v2 offset:4608
    v_or3_b32 v188, v184, v185, v186
    v_bitop3_b32 v188, v188, v187, s46 bitop3:0xa8
    v_mfma_f32_16x16x32_bf16 v[204:207], v[228:231], v[52:55], v[204:207]
    ds_read_b64_tr_b16 v[228:229], v3 offset:512
    ds_read_b64_tr_b16 v[230:231], v3 offset:4608
    v_cmp_ne_u32 vcc, 0, v188
    v_add_u32 v1, s49, v1
    v_mfma_f32_16x16x32_bf16 v[204:207], v[232:235], v[56:59], v[204:207]
    s_cbranch_vccnz L_rare0
L_back0:
    s_nop 0
    ds_read_b64_tr_b16 v[232:233], v2 offset:768
    ds_read_b64_tr_b16 v[234:235], v2 offset:4864
    v_exp_f32_e64 v192, v192
    v_mfma_f32_16x16x32_bf16 v[204:207], v[236:239], v[60:63], v[204:207]
    ds_read_b64_tr_b16 v[236:237], v3 offset:768
    ds_read_b64_tr_b16 v[238:239], v3 offset:4864
    v_exp_f32_e64 v193, v193
    v_mfma_f32_16x16x32_bf16 v[200:203], v[240:243], v[48:51], v[180:183]
    v_exp_f32_e64 v194, v194
    v_mfma_f32_16x16x32_bf16 v[200:203], v[244:247], v[52:55], v[200:203]
    v_exp_f32_e64 v195, v195
    v_mfma_f32_16x16x32_bf16 v[200:203], v[248:251], v[56:59], v[200:203]
    v_cvt_pk_bf16_f32 v192, v192, v193
    v_cvt_pk_bf16_f32 v193, v194, v195
    v_mfma_f32_16x16x32_bf16 v[200:203], v[252:255], v[60:63], v[200:203]
    v_exp_f32 v196, v196
    s_waitcnt lgkmcnt(8)
    v_mfma_f32_16x16x32_bf16 v[64:67], v[208:211], v[184:187], v[64:67]
    v_exp_f32_e64 v197, v197
    v_mfma_f32_16x16x32_bf16 v[68:71], v[212:215], v[184:187], v[68:71]
    v_exp_f32_e64 v198, v198
    v_mfma_f32_16x16x32_bf16 v[72:75], v[216:219], v[184:187], v[72:75]
    v_exp_f32_e64 v199, v199
    v_mfma_f32_16x16x32_bf16 v[76:79], v[220:223], v[184:187], v[76:79]
    v_cvt_pk_bf16_f32 v194, v196, v197
    v_cvt_pk_bf16_f32 v195, v198, v199
    v_mfma_f32_16x16x32_bf16 v[160:163], v[8:11], v[184:187], v[160:163]
    v_or3_b32 v196, v192, v193, v194
    v_bitop3_b32 v196, v196, v195, s46 bitop3:0xa8
    s_waitcnt lgkmcnt(0)
    s_nop 0
    v_mfma_f32_16x16x32_bf16 v[80:83], v[224:227], v[184:187], v[80:83]
    v_cmp_ne_u32 vcc, 0, v196
    v_add_u32 v2, s49, v2
    v_mfma_f32_16x16x32_bf16 v[84:87], v[228:231], v[184:187], v[84:87]
    s_cbranch_vccnz L_rare1
L_back1:
    v_exp_f32 v200, v200
    v_mfma_f32_16x16x32_bf16 v[88:91], v[232:235], v[184:187], v[88:91]
    v_exp_f32_e64 v201, v201
    v_mfma_f32_16x16x32_bf16 v[92:95], v[236:239], v[184:187], v[92:95]
    v_exp_f32_e64 v202, v202
    v_mfma_f32_16x16x32_bf16 v[96:99], v[208:211], v[192:195], v[96:99]
    v_exp_f32_e64 v203, v203
    v_mfma_f32_16x16x32_bf16 v[100:103], v[212:215], v[192:195], v[100:103]
    v_cvt_pk_bf16_f32 v200, v200, v201
    v_cvt_pk_bf16_f32 v201, v202, v203
    v_mfma_f32_16x16x32_bf16 v[104:107], v[216:219], v[192:195], v[104:107]
    v_exp_f32_e64 v204, v204
    v_mfma_f32_16x16x32_bf16 v[108:111], v[220:223], v[192:195], v[108:111]
    v_exp_f32_e64 v205, v205
    v_mfma_f32_16x16x32_bf16 v[164:167], v[8:11], v[192:195], v[164:167]
    v_exp_f32_e64 v206, v206
    v_mfma_f32_16x16x32_bf16 v[112:115], v[224:227], v[192:195], v[112:115]
    v_exp_f32_e64 v207, v207
    v_mfma_f32_16x16x32_bf16 v[116:119], v[228:231], v[192:195], v[116:119]
    v_cvt_pk_bf16_f32 v202, v204, v205
    v_cvt_pk_bf16_f32 v203, v206, v207
    v_mfma_f32_16x16x32_bf16 v[120:123], v[232:235], v[192:195], v[120:123]
    v_or3_b32 v204, v200, v201, v202
    v_bitop3_b32 v204, v204, v203, s46 bitop3:0xa8
    v_mfma_f32_16x16x32_bf16 v[124:127], v[236:239], v[192:195], v[124:127]
    v_cmp_ne_u32_e64 vcc, 0, v204
    v_add_u32 v3, s49, v3
    s_cmp_lt_u32 s45, 16
    s_cbranch_vccnz L_rare2
L_back2:
    s_cbranch_scc1 L_loop
L_bnd:
    s_cmp_lt_u32 s36, 4
    s_cbranch_scc1 L_ypr
    s_setprio 1
L_ypr:
    s_cmp_eq_u32 s50, 0
    s_cbranch_scc0 L_nomx
    s_mov_b64 exec, 1
    v_mov_b32 v14, 163712
    v_mov_b32_e64 v13, 1
    ds_add_u32 v14, v13 offset:20
L_q2w:
    ds_read_b32 v12, v14 offset:24
    s_waitcnt lgkmcnt(0)
    v_readfirstlane_b32 s42, v12
    s_nop 0
    s_cmp_lt_u32 s42, 2
    s_cbranch_scc1 L_q2w
    s_mov_b64 exec, -1
    v_add_u32_e64 v5, s53, v4
    ds_read_b128 v[16:19], v5 offset:0
    ds_read_b128 v[20:23], v5 offset:1024
    ds_read_b128 v[24:27], v5 offset:2048
    ds_read_b128 v[28:31], v5 offset:3072
    ds_read_b128 v[32:35], v5 offset:4096
    ds_read_b128 v[36:39], v5 offset:5120
    ds_read_b128 v[40:43], v5 offset:6144
    ds_read_b128 v[44:47], v5 offset:7168
    ds_read_b128 v[48:51], v5 offset:8192
    ds_read_b128 v[52:55], v5 offset:9216
    ds_read_b128 v[56:59], v5 offset:10240
    ds_read_b128 v[60:63], v5 offset:11264
    s_add_u32 s52, s52, 1
    v_mov_b32 v12, s52
    ds_write_b32 v6, v12
L_nomx:
    s_lshl_b32 s42, s36, 12
    s_add_u32 s42, s42, s51
    v_add_u32_e64 v5, s42, v4
    v_mfma_f32_16x16x32_bf16 v[168:171], v[8:11], v[200:203], v[168:171]
    v_cvt_pk_bf16_f32 v80, v80, v81
    v_cvt_pk_bf16_f32 v81, v82, v83
    v_mfma_f32_16x16x32_bf16 v[144:147], v[224:227], v[200:203], v[144:147]
    v_cvt_pk_bf16_f32 v82, v84, v85
    v_cvt_pk_bf16_f32 v83, v86, v87
    v_mfma_f32_16x16x32_bf16 v[148:151], v[228:231], v[200:203], v[148:151]
    ds_write_b128 v5, v[80:83] offset:0
    v_cvt_pk_bf16_f32 v88, v88, v89
    v_mfma_f32_16x16x32_bf16 v[152:155], v[232:235], v[200:203], v[152:155]
    v_cvt_pk_bf16_f32 v89, v90, v91
    v_cvt_pk_bf16_f32 v90, v92, v93
    v_mfma_f32_16x16x32_bf16 v[156:159], v[236:239], v[200:203], v[156:159]
    v_cvt_pk_bf16_f32 v91, v94, v95
    ds_write_b128 v5, v[88:91] offset:1024
    v_cvt_pk_bf16_f32 v112, v112, v113
    v_mfma_f32_16x16x32_bf16 v[128:131], v[208:211], v[200:203], v[128:131]
    v_cvt_pk_bf16_f32 v113, v114, v115
    v_cvt_pk_bf16_f32 v114, v116, v117
    v_mfma_f32_16x16x32_bf16 v[132:135], v[212:215], v[200:203], v[132:135]
    v_cvt_pk_bf16_f32 v115, v118, v119
    ds_write_b128 v5, v[112:115] offset:2048
    v_mfma_f32_16x16x32_bf16 v[136:139], v[216:219], v[200:203], v[136:139]
    v_cvt_pk_bf16_f32 v120, v120, v121
    v_cvt_pk_bf16_f32 v121, v122, v123
    v_mfma_f32_16x16x32_bf16 v[140:143], v[220:223], v[200:203], v[140:143]
    v_cvt_pk_bf16_f32 v122, v124, v125
    v_cvt_pk_bf16_f32 v123, v126, v127
    ds_write_b128 v5, v[120:123] offset:3072
    v_and_b32 v14, 15, v0
    v_lshlrev_b32 v14, 3, v14
    s_mul_i32 s42, s36, 384
    s_add_u32 s42, s42, 159744
    v_add_u32 v15, s42, v14
    v_mov_b32 v173, v160
    ds_write_b64 v15, v[172:173] offset:0
    v_mov_b32_e64 v177, v164
    ds_write_b64 v15, v[176:177] offset:128
    v_mov_b32_e64 v181, v168
    ds_write_b64 v15, v[180:181] offset:256
    s_lshl_b32 s42, s59, 11
    s_add_u32 s42, s42, s53
    v_add_u32 v5, s42, v4
    s_waitcnt lgkmcnt(0)
L_pw0:
    ds_read_b32 v12, v7
    s_waitcnt lgkmcnt(0)
    v_readfirstlane_b32 s42, v12
    s_nop 0
    s_cmp_ge_u32 s42, s52
    s_cbranch_scc1 L_pw0_ok
    s_waitcnt lgkmcnt(0)
    s_sleep 1
    s_branch L_pw0
L_pw0_ok:
    s_waitcnt lgkmcnt(0)
    s_nop 0
    v_cvt_pk_bf16_f32 v144, v144, v145
    v_cvt_pk_bf16_f32 v145, v146, v147
    v_cvt_pk_bf16_f32 v146, v148, v149
    v_cvt_pk_bf16_f32 v147, v150, v151
    ds_write_b128 v5, v[144:147] offset:0
    v_cvt_pk_bf16_f32 v152, v152, v153
    v_cvt_pk_bf16_f32 v153, v154, v155
    v_cvt_pk_bf16_f32 v154, v156, v157
    v_cvt_pk_bf16_f32 v155, v158, v159
    ds_write_b128 v5, v[152:155] offset:1024
    s_add_u32 s52, s52, 1
    v_mov_b32 v12, s52
    ds_write_b32 v6, v12
    s_mul_i32 s43, s57, 384
    s_add_u32 s43, s43, 159744
    v_add_u32_e64 v15, s43, v14
    v_xor_b32 v5, 2048, v5
    s_lshl_b32 s42, s57, 12
    s_add_u32 s42, s42, s51
    v_add_u32 v14, s42, v4
    s_waitcnt lgkmcnt(0)
L_pw:
    ds_read_b32 v12, v7
    ds_read_b64 v[174:175], v15 offset:0
    ds_read_b64 v[178:179], v15 offset:128
    ds_read_b64 v[182:183], v15 offset:256
    ds_read_b128 v[184:187], v14 offset:0
    ds_read_b128 v[188:191], v14 offset:1024
    ds_read_b128 v[192:195], v14 offset:2048
    ds_read_b128 v[196:199], v14 offset:3072
    ds_read_b128 v[200:203], v5 offset:0
    ds_read_b128 v[204:207], v5 offset:1024
    s_waitcnt lgkmcnt(9)
    v_readfirstlane_b32 s42, v12
    s_nop 0
    s_cmp_ge_u32 s42, s52
    s_cbranch_scc1 L_pw_ok
    s_waitcnt lgkmcnt(0)
    s_sleep 1
    s_branch L_pw
L_pw_ok:
    s_waitcnt lgkmcnt(0)
    v_min_f32 v160, v172, v174
    v_sub_f32 v161, v160, v172
    v_sub_f32 v162, v160, v174
    v_exp_f32 v161, v161
    v_exp_f32 v162, v162
    v_mul_f32_e64 v163, v161, v173
    v_fma_f32 v163, v162, v175, v163
    v_rcp_f32 v160, v163
    s_nop 0
    v_mul_f32 v163, v162, v160
    v_mul_f32 v162, v162, v160
    v_mul_f32 v161, v161, v160
    v_mov_b32 v160, v161
    v_min_f32 v164, v176, v178
    v_sub_f32 v165, v164, v176
    v_sub_f32 v166, v164, v178
    v_exp_f32 v165, v165
    v_exp_f32 v166, v166
    v_mul_f32 v167, v165, v177
    v_fma_f32 v167, v166, v179, v167
    v_rcp_f32 v164, v167
    s_nop 0
    v_mul_f32 v167, v166, v164
    v_mul_f32 v166, v166, v164
    v_mul_f32 v165, v165, v164
    v_mov_b32 v164, v165
    v_min_f32 v168, v180, v182
    v_sub_f32 v169, v168, v180
    v_sub_f32 v170, v168, v182
    v_exp_f32 v169, v169
    v_exp_f32 v170, v170
    v_mul_f32 v171, v169, v181
    v_fma_f32 v171, v170, v183, v171
    v_rcp_f32 v168, v171
    s_nop 0
    v_mul_f32 v171, v170, v168
    v_mul_f32 v170, v170, v168
    v_mul_f32 v169, v169, v168
    v_mov_b32 v168, v169
    s_cmp_eq_u32 s50, 0
    s_cbranch_scc0 L_att_done
    v_lshlrev_b32_e64 v80, 16, v184
    v_and_b32 v81, 0xffff0000, v184
    v_lshlrev_b32_e64 v82, 16, v185
    v_and_b32 v83, 0xffff0000, v185
    v_lshlrev_b32_e64 v84, 16, v186
    v_and_b32 v85, 0xffff0000, v186
    v_lshlrev_b32_e64 v86, 16, v187
    v_and_b32 v87, 0xffff0000, v187
    v_mul_f32 v64, v160, v64
    v_mul_f32 v65, v160, v65
    v_mul_f32 v66, v160, v66
    v_mul_f32 v67, v160, v67
    v_mul_f32 v68, v160, v68
    v_mul_f32 v69, v160, v69
    v_mul_f32 v70, v160, v70
    v_mul_f32 v71, v160, v71
    v_fmac_f32 v64, v162, v80
    v_fmac_f32 v65, v162, v81
    v_fmac_f32 v66, v162, v82
    v_fmac_f32 v67, v162, v83
    v_fmac_f32 v68, v162, v84
    v_fmac_f32 v69, v162, v85
    v_fmac_f32 v70, v162, v86
    v_fmac_f32 v71, v162, v87
    v_cvt_pk_bf16_f32 v184, v64, v65
    v_cvt_pk_bf16_f32 v185, v66, v67
    v_cvt_pk_bf16_f32 v186, v68, v69
    v_cvt_pk_bf16_f32 v187, v70, v71
    ds_write_b128 v14, v[184:187] offset:0
    v_lshlrev_b32_e64 v88, 16, v188
    v_and_b32 v89, 0xffff0000, v188
    v_lshlrev_b32_e64 v90, 16, v189
    v_and_b32 v91, 0xffff0000, v189
    v_lshlrev_b32_e64 v92, 16, v190
    v_and_b32 v93, 0xffff0000, v190
    v_lshlrev_b32_e64 v94, 16, v191
    v_and_b32 v95, 0xffff0000, v191
    v_mul_f32 v72, v160, v72
    v_mul_f32 v73, v160, v73
    v_mul_f32 v74, v160, v74
    v_mul_f32 v75, v160, v75
    v_mul_f32 v76, v160, v76
    v_mul_f32 v77, v160, v77
    v_mul_f32 v78, v160, v78
    v_mul_f32 v79, v160, v79
    v_fmac_f32 v72, v162, v88
    v_fmac_f32 v73, v162, v89
    v_fmac_f32 v74, v162, v90
    v_fmac_f32 v75, v162, v91
    v_fmac_f32 v76, v162, v92
    v_fmac_f32 v77, v162, v93
    v_fmac_f32 v78, v162, v94
    v_fmac_f32 v79, v162, v95
    v_cvt_pk_bf16_f32 v188, v72, v73
    v_cvt_pk_bf16_f32 v189, v74, v75
    v_cvt_pk_bf16_f32 v190, v76, v77
    v_cvt_pk_bf16_f32 v191, v78, v79
    ds_write_b128 v14, v[188:191] offset:1024
    v_lshlrev_b32_e64 v112, 16, v192
    v_and_b32 v113, 0xffff0000, v192
    v_lshlrev_b32_e64 v114, 16, v193
    v_and_b32 v115, 0xffff0000, v193
    v_lshlrev_b32_e64 v116, 16, v194
    v_and_b32 v117, 0xffff0000, v194
    v_lshlrev_b32_e64 v118, 16, v195
    v_and_b32 v119, 0xffff0000, v195
    v_mul_f32 v96, v164, v96
    v_mul_f32 v97, v164, v97
    v_mul_f32 v98, v164, v98
    v_mul_f32 v99, v164, v99
    v_mul_f32 v100, v164, v100
    v_mul_f32 v101, v164, v101
    v_mul_f32 v102, v164, v102
    v_mul_f32 v103, v164, v103
    v_fmac_f32 v96, v166, v112
    v_fmac_f32 v97, v166, v113
    v_fmac_f32 v98, v166, v114
    v_fmac_f32 v99, v166, v115
    v_fmac_f32 v100, v166, v116
    v_fmac_f32 v101, v166, v117
    v_fmac_f32 v102, v166, v118
    v_fmac_f32 v103, v166, v119
    v_cvt_pk_bf16_f32 v192, v96, v97
    v_cvt_pk_bf16_f32 v193, v98, v99
    v_cvt_pk_bf16_f32 v194, v100, v101
    v_cvt_pk_bf16_f32 v195, v102, v103
    ds_write_b128 v14, v[192:195] offset:2048
    v_lshlrev_b32_e64 v120, 16, v196
    v_and_b32 v121, 0xffff0000, v196
    v_lshlrev_b32_e64 v122, 16, v197
    v_and_b32 v123, 0xffff0000, v197
    v_lshlrev_b32_e64 v124, 16, v198
    v_and_b32 v125, 0xffff0000, v198
    v_lshlrev_b32_e64 v126, 16, v199
    v_and_b32 v127, 0xffff0000, v199
    v_mul_f32 v104, v164, v104
    v_mul_f32 v105, v164, v105
    v_mul_f32 v106, v164, v106
    v_mul_f32 v107, v164, v107
    v_mul_f32 v108, v164, v108
    v_mul_f32 v109, v164, v109
    v_mul_f32 v110, v164, v110
    v_mul_f32 v111, v164, v111
    v_fmac_f32 v104, v166, v120
    v_fmac_f32 v105, v166, v121
    v_fmac_f32 v106, v166, v122
    v_fmac_f32 v107, v166, v123
    v_fmac_f32 v108, v166, v124
    v_fmac_f32 v109, v166, v125
    v_fmac_f32 v110, v166, v126
    v_fmac_f32 v111, v166, v127
    v_cvt_pk_bf16_f32 v196, v104, v105
    v_cvt_pk_bf16_f32 v197, v106, v107
    v_cvt_pk_bf16_f32 v198, v108, v109
    v_cvt_pk_bf16_f32 v199, v110, v111
    ds_write_b128 v14, v[196:199] offset:3072
    v_lshlrev_b32_e64 v144, 16, v200
    v_and_b32 v145, 0xffff0000, v200
    v_lshlrev_b32_e64 v146, 16, v201
    v_and_b32 v147, 0xffff0000, v201
    v_lshlrev_b32_e64 v148, 16, v202
    v_and_b32 v149, 0xffff0000, v202
    v_lshlrev_b32_e64 v150, 16, v203
    v_and_b32 v151, 0xffff0000, v203
    v_mul_f32 v128, v168, v128
    v_mul_f32 v129, v168, v129
    v_mul_f32 v130, v168, v130
    v_mul_f32 v131, v168, v131
    v_mul_f32 v132, v168, v132
    v_mul_f32 v133, v168, v133
    v_mul_f32 v134, v168, v134
    v_mul_f32 v135, v168, v135
    v_fmac_f32 v128, v170, v144
    v_fmac_f32 v129, v170, v145
    v_fmac_f32 v130, v170, v146
    v_fmac_f32 v131, v170, v147
    v_fmac_f32 v132, v170, v148
    v_fmac_f32 v133, v170, v149
    v_fmac_f32 v134, v170, v150
    v_fmac_f32 v135, v170, v151
    v_cvt_pk_bf16_f32 v200, v128, v129
    v_cvt_pk_bf16_f32 v201, v130, v131
    v_cvt_pk_bf16_f32 v202, v132, v133
    v_cvt_pk_bf16_f32 v203, v134, v135
    ds_write_b128 v5, v[200:203] offset:0
    v_lshlrev_b32_e64 v152, 16, v204
    v_and_b32 v153, 0xffff0000, v204
    v_lshlrev_b32_e64 v154, 16, v205
    v_and_b32 v155, 0xffff0000, v205
    v_lshlrev_b32_e64 v156, 16, v206
    v_and_b32 v157, 0xffff0000, v206
    v_lshlrev_b32_e64 v158, 16, v207
    v_and_b32 v159, 0xffff0000, v207
    v_mul_f32 v136, v168, v136
    v_mul_f32 v137, v168, v137
    v_mul_f32 v138, v168, v138
    v_mul_f32 v139, v168, v139
    v_mul_f32 v140, v168, v140
    v_mul_f32 v141, v168, v141
    v_mul_f32 v142, v168, v142
    v_mul_f32 v143, v168, v143
    v_fmac_f32 v136, v170, v152
    v_fmac_f32 v137, v170, v153
    v_fmac_f32 v138, v170, v154
    v_fmac_f32 v139, v170, v155
    v_fmac_f32 v140, v170, v156
    v_fmac_f32 v141, v170, v157
    v_fmac_f32 v142, v170, v158
    v_fmac_f32 v143, v170, v159
    v_cvt_pk_bf16_f32 v204, v136, v137
    v_cvt_pk_bf16_f32 v205, v138, v139
    v_cvt_pk_bf16_f32 v206, v140, v141
    v_cvt_pk_bf16_f32 v207, v142, v143
    ds_write_b128 v5, v[204:207] offset:1024
    s_mov_b32 s50, 1
    s_lshl_b32 s53, s62, 12
    s_add_u32 s53, s53, 57344
    s_mov_b32 s51, 32768
    s_waitcnt lgkmcnt(0)
    s_branch L_item
L_rare0:
    s_nop 15
    v_subrev_u32 v5, s49, v1
    ds_read_b128 v[12:15], v5 offset:0
    s_waitcnt lgkmcnt(0)
    s_nop 0
    v_mfma_f32_16x16x32_bf16 v[184:187], v[12:15], v[16:19], v[172:175]
    s_nop 3
    s_nop 0
    ds_read_b128 v[12:15], v5 offset:256
    s_waitcnt lgkmcnt(0)
    s_nop 0
    v_mfma_f32_16x16x32_bf16 v[184:187], v[12:15], v[20:23], v[184:187]
    s_nop 3
    s_nop 0
    ds_read_b128 v[12:15], v5 offset:512
    s_waitcnt lgkmcnt(0)
    s_nop 0
    v_mfma_f32_16x16x32_bf16 v[184:187], v[12:15], v[24:27], v[184:187]
    s_nop 3
    s_nop 0
    ds_read_b128 v[12:15], v5 offset:768
    s_waitcnt lgkmcnt(0)
    s_nop 0
    v_mfma_f32_16x16x32_bf16 v[184:187], v[12:15], v[28:31], v[184:187]
    s_nop 3
    s_nop 0
    ds_read_b128 v[12:15], v5 offset:4096
    s_waitcnt lgkmcnt(0)
    s_nop 0
    v_mfma_f32_16x16x32_bf16 v[188:191], v[12:15], v[16:19], v[172:175]
    s_nop 3
    s_nop 0
    ds_read_b128 v[12:15], v5 offset:4352
    s_waitcnt lgkmcnt(0)
    s_nop 0
    v_mfma_f32_16x16x32_bf16 v[188:191], v[12:15], v[20:23], v[188:191]
    s_nop 3
    s_nop 0
    ds_read_b128 v[12:15], v5 offset:4608
    s_waitcnt lgkmcnt(0)
    s_nop 0
    v_mfma_f32_16x16x32_bf16 v[188:191], v[12:15], v[24:27], v[188:191]
    s_nop 3
    s_nop 0
    ds_read_b128 v[12:15], v5 offset:4864
    s_waitcnt lgkmcnt(0)
    s_nop 0
    v_mfma_f32_16x16x32_bf16 v[188:191], v[12:15], v[28:31], v[188:191]
    s_nop 3
    s_nop 0
    v_max3_f32 v12, v184, v185, v186
    s_nop 2
    s_nop 0
    v_max3_f32 v13, v187, v188, v189
    v_max3_f32 v12, v12, v190, v191
    v_max_f32 v12, v12, v13
    v_mov_b32 v13, v12
    s_nop 1
    v_permlane16_swap_b32 v12, v13
    v_max_f32 v12, v12, v13
    v_mov_b32 v13, v12
    s_nop 1
    v_permlane32_swap_b32 v12, v13
    v_max_f32 v12, v12, v13
    v_add_f32 v12, s47, v12
    v_max_f32 v12, 0, v12
    v_sub_f32 v184, v184, v12
    v_sub_f32 v185, v185, v12
    v_sub_f32 v186, v186, v12
    v_sub_f32 v187, v187, v12
    v_sub_f32 v188, v188, v12
    v_sub_f32 v189, v189, v12
    v_sub_f32 v190, v190, v12
    v_sub_f32 v191, v191, v12
    v_sub_f32 v172, v172, v12
    v_sub_f32 v173, v173, v12
    v_sub_f32 v174, v174, v12
    v_sub_f32_e64 v175, v175, v12
    v_exp_f32 v13, -v12
    s_nop 0
    v_mul_f32 v160, v160, v13
    v_mul_f32 v161, v161, v13
    v_mul_f32 v162, v162, v13
    v_mul_f32 v163, v163, v13
    v_mul_f32 v64, v64, v13
    v_mul_f32 v65, v65, v13
    v_mul_f32 v66, v66, v13
    v_mul_f32 v67, v67, v13
    v_mul_f32 v68, v68, v13
    v_mul_f32 v69, v69, v13
    v_mul_f32 v70, v70, v13
    v_mul_f32 v71, v71, v13
    v_mul_f32 v72, v72, v13
    v_mul_f32 v73, v73, v13
    v_mul_f32 v74, v74, v13
    v_mul_f32 v75, v75, v13
    v_mul_f32 v76, v76, v13
    v_mul_f32 v77, v77, v13
    v_mul_f32 v78, v78, v13
    v_mul_f32 v79, v79, v13
    v_mul_f32 v80, v80, v13
    v_mul_f32 v81, v81, v13
    v_mul_f32 v82, v82, v13
    v_mul_f32 v83, v83, v13
    v_mul_f32 v84, v84, v13
    v_mul_f32 v85, v85, v13
    v_mul_f32 v86, v86, v13
    v_mul_f32 v87, v87, v13
    v_mul_f32 v88, v88, v13
    v_mul_f32 v89, v89, v13
    v_mul_f32 v90, v90, v13
    v_mul_f32 v91, v91, v13
    v_mul_f32 v92, v92, v13
    v_mul_f32 v93, v93, v13
    v_mul_f32 v94, v94, v13
    v_mul_f32 v95, v95, v13
    v_exp_f32 v184, v184
    v_exp_f32 v185, v185
    v_exp_f32 v186, v186
    v_exp_f32 v187, v187
    v_exp_f32 v188, v188
    v_exp_f32 v189, v189
    v_exp_f32 v190, v190
    v_exp_f32_e64 v191, v191
    v_cvt_pk_bf16_f32 v184, v184, v185
    v_cvt_pk_bf16_f32 v185, v186, v187
    v_cvt_pk_bf16_f32 v186, v188, v189
    v_cvt_pk_bf16_f32 v187, v190, v191
    s_nop 3
    s_branch L_back0
L_rare1:
    s_nop 15
    v_subrev_u32 v5, s49, v1
    ds_read_b128 v[12:15], v5 offset:0
    s_waitcnt lgkmcnt(0)
    s_nop 0
    v_mfma_f32_16x16x32_bf16 v[192:195], v[12:15], v[32:35], v[176:179]
    s_nop 3
    s_nop 0
    ds_read_b128 v[12:15], v5 offset:256
    s_waitcnt lgkmcnt(0)
    s_nop 0
    v_mfma_f32_16x16x32_bf16 v[192:195], v[12:15], v[36:39], v[192:195]
    s_nop 3
    s_nop 0
    ds_read_b128 v[12:15], v5 offset:512
    s_waitcnt lgkmcnt(0)
    s_nop 0
    v_mfma_f32_16x16x32_bf16 v[192:195], v[12:15], v[40:43], v[192:195]
    s_nop 3
    s_nop 0
    ds_read_b128 v[12:15], v5 offset:768
    s_waitcnt lgkmcnt(0)
    s_nop 0
    v_mfma_f32_16x16x32_bf16 v[192:195], v[12:15], v[44:47], v[192:195]
    s_nop 3
    s_nop 0
    ds_read_b128 v[12:15], v5 offset:4096
    s_waitcnt lgkmcnt(0)
    s_nop 0
    v_mfma_f32_16x16x32_bf16 v[196:199], v[12:15], v[32:35], v[176:179]
    s_nop 3
    s_nop 0
    ds_read_b128 v[12:15], v5 offset:4352
    s_waitcnt lgkmcnt(0)
    s_nop 0
    v_mfma_f32_16x16x32_bf16 v[196:199], v[12:15], v[36:39], v[196:199]
    s_nop 3
    s_nop 0
    ds_read_b128 v[12:15], v5 offset:4608
    s_waitcnt lgkmcnt(0)
    s_nop 0
    v_mfma_f32_16x16x32_bf16 v[196:199], v[12:15], v[40:43], v[196:199]
    s_nop 3
    s_nop 0
    ds_read_b128 v[12:15], v5 offset:4864
    s_waitcnt lgkmcnt(0)
    s_nop 0
    v_mfma_f32_16x16x32_bf16 v[196:199], v[12:15], v[44:47], v[196:199]
    s_nop 3
    s_nop 0
    v_max3_f32 v12, v192, v193, v194
    s_nop 2
    s_nop 0
    v_max3_f32 v13, v195, v196, v197
    v_max3_f32 v12, v12, v198, v199
    v_max_f32 v12, v12, v13
    v_mov_b32 v13, v12
    s_nop 1
    v_permlane16_swap_b32 v12, v13
    v_max_f32 v12, v12, v13
    v_mov_b32 v13, v12
    s_nop 1
    v_permlane32_swap_b32 v12, v13
    v_max_f32 v12, v12, v13
    v_add_f32 v12, s47, v12
    v_max_f32 v12, 0, v12
    v_sub_f32 v192, v192, v12
    v_sub_f32 v193, v193, v12
    v_sub_f32 v194, v194, v12
    v_sub_f32 v195, v195, v12
    v_sub_f32 v196, v196, v12
    v_sub_f32 v197, v197, v12
    v_sub_f32 v198, v198, v12
    v_sub_f32 v199, v199, v12
    v_sub_f32 v176, v176, v12
    v_sub_f32 v177, v177, v12
    v_sub_f32 v178, v178, v12
    v_sub_f32_e64 v179, v179, v12
    v_exp_f32 v13, -v12
    s_nop 0
    v_mul_f32 v164, v164, v13
    v_mul_f32 v165, v165, v13
    v_mul_f32 v166, v166, v13
    v_mul_f32 v167, v167, v13
    v_mul_f32 v96, v96, v13
    v_mul_f32 v97, v97, v13
    v_mul_f32 v98, v98, v13
    v_mul_f32 v99, v99, v13
    v_mul_f32 v100, v100, v13
    v_mul_f32 v101, v101, v13
    v_mul_f32 v102, v102, v13
    v_mul_f32 v103, v103, v13
    v_mul_f32 v104, v104, v13
    v_mul_f32 v105, v105, v13
    v_mul_f32 v106, v106, v13
    v_mul_f32 v107, v107, v13
    v_mul_f32 v108, v108, v13
    v_mul_f32 v109, v109, v13
    v_mul_f32 v110, v110, v13
    v_mul_f32 v111, v111, v13
    v_mul_f32 v112, v112, v13
    v_mul_f32 v113, v113, v13
    v_mul_f32 v114, v114, v13
    v_mul_f32 v115, v115, v13
    v_mul_f32 v116, v116, v13
    v_mul_f32 v117, v117, v13
    v_mul_f32 v118, v118, v13
    v_mul_f32 v119, v119, v13
    v_mul_f32 v120, v120, v13
    v_mul_f32 v121, v121, v13
    v_mul_f32 v122, v122, v13
    v_mul_f32 v123, v123, v13
    v_mul_f32 v124, v124, v13
    v_mul_f32 v125, v125, v13
    v_mul_f32 v126, v126, v13
    v_mul_f32 v127, v127, v13
    v_exp_f32 v192, v192
    v_exp_f32 v193, v193
    v_exp_f32 v194, v194
    v_exp_f32 v195, v195
    v_exp_f32 v196, v196
    v_exp_f32 v197, v197
    v_exp_f32 v198, v198
    v_exp_f32_e64 v199, v199
    v_cvt_pk_bf16_f32 v192, v192, v193
    v_cvt_pk_bf16_f32 v193, v194, v195
    v_cvt_pk_bf16_f32 v194, v196, v197
    v_cvt_pk_bf16_f32 v195, v198, v199
    s_nop 3
    s_branch L_back1
L_rare2:
    s_nop 15
    v_subrev_u32 v5, s49, v1
    ds_read_b128 v[12:15], v5 offset:0
    s_waitcnt lgkmcnt(0)
    s_nop 0
    v_mfma_f32_16x16x32_bf16 v[200:203], v[12:15], v[48:51], v[180:183]
    s_nop 3
    s_nop 0
    ds_read_b128 v[12:15], v5 offset:256
    s_waitcnt lgkmcnt(0)
    s_nop 0
    v_mfma_f32_16x16x32_bf16 v[200:203], v[12:15], v[52:55], v[200:203]
    s_nop 3
    s_nop 0
    ds_read_b128 v[12:15], v5 offset:512
    s_waitcnt lgkmcnt(0)
    s_nop 0
    v_mfma_f32_16x16x32_bf16 v[200:203], v[12:15], v[56:59], v[200:203]
    s_nop 3
    s_nop 0
    ds_read_b128 v[12:15], v5 offset:768
    s_waitcnt lgkmcnt(0)
    s_nop 0
    v_mfma_f32_16x16x32_bf16 v[200:203], v[12:15], v[60:63], v[200:203]
    s_nop 3
    s_nop 0
    ds_read_b128 v[12:15], v5 offset:4096
    s_waitcnt lgkmcnt(0)
    s_nop 0
    v_mfma_f32_16x16x32_bf16 v[204:207], v[12:15], v[48:51], v[180:183]
    s_nop 3
    s_nop 0
    ds_read_b128 v[12:15], v5 offset:4352
    s_waitcnt lgkmcnt(0)
    s_nop 0
    v_mfma_f32_16x16x32_bf16 v[204:207], v[12:15], v[52:55], v[204:207]
    s_nop 3
    s_nop 0
    ds_read_b128 v[12:15], v5 offset:4608
    s_waitcnt lgkmcnt(0)
    s_nop 0
    v_mfma_f32_16x16x32_bf16 v[204:207], v[12:15], v[56:59], v[204:207]
    s_nop 3
    s_nop 0
    ds_read_b128 v[12:15], v5 offset:4864
    s_waitcnt lgkmcnt(0)
    s_nop 0
    v_mfma_f32_16x16x32_bf16 v[204:207], v[12:15], v[60:63], v[204:207]
    s_nop 3
    s_nop 0
    v_max3_f32 v12, v200, v201, v202
    s_nop 2
    s_nop 0
    v_max3_f32 v13, v203, v204, v205
    v_max3_f32 v12, v12, v206, v207
    v_max_f32 v12, v12, v13
    v_mov_b32 v13, v12
    s_nop 1
    v_permlane16_swap_b32 v12, v13
    v_max_f32 v12, v12, v13
    v_mov_b32 v13, v12
    s_nop 1
    v_permlane32_swap_b32 v12, v13
    v_max_f32 v12, v12, v13
    v_add_f32 v12, s47, v12
    v_max_f32 v12, 0, v12
    v_sub_f32 v200, v200, v12
    v_sub_f32 v201, v201, v12
    v_sub_f32 v202, v202, v12
    v_sub_f32 v203, v203, v12
    v_sub_f32 v204, v204, v12
    v_sub_f32 v205, v205, v12
    v_sub_f32 v206, v206, v12
    v_sub_f32 v207, v207, v12
    v_sub_f32 v180, v180, v12
    v_sub_f32 v181, v181, v12
    v_sub_f32 v182, v182, v12
    v_sub_f32_e64 v183, v183, v12
    v_exp_f32 v13, -v12
    s_nop 0
    v_mul_f32 v168, v168, v13
    v_mul_f32 v169, v169, v13
    v_mul_f32 v170, v170, v13
    v_mul_f32 v171, v171, v13
    v_mul_f32 v128, v128, v13
    v_mul_f32 v129, v129, v13
    v_mul_f32 v130, v130, v13
    v_mul_f32 v131, v131, v13
    v_mul_f32 v132, v132, v13
    v_mul_f32 v133, v133, v13
    v_mul_f32 v134, v134, v13
    v_mul_f32 v135, v135, v13
    v_mul_f32 v136, v136, v13
    v_mul_f32 v137, v137, v13
    v_mul_f32 v138, v138, v13
    v_mul_f32 v139, v139, v13
    v_mul_f32 v140, v140, v13
    v_mul_f32 v141, v141, v13
    v_mul_f32 v142, v142, v13
    v_mul_f32 v143, v143, v13
    v_mul_f32 v144, v144, v13
    v_mul_f32 v145, v145, v13
    v_mul_f32 v146, v146, v13
    v_mul_f32 v147, v147, v13
    v_mul_f32 v148, v148, v13
    v_mul_f32 v149, v149, v13
    v_mul_f32 v150, v150, v13
    v_mul_f32 v151, v151, v13
    v_mul_f32 v152, v152, v13
    v_mul_f32 v153, v153, v13
    v_mul_f32 v154, v154, v13
    v_mul_f32 v155, v155, v13
    v_mul_f32 v156, v156, v13
    v_mul_f32 v157, v157, v13
    v_mul_f32 v158, v158, v13
    v_mul_f32 v159, v159, v13
    v_exp_f32 v200, v200
    v_exp_f32 v201, v201
    v_exp_f32 v202, v202
    v_exp_f32 v203, v203
    v_exp_f32 v204, v204
    v_exp_f32 v205, v205
    v_exp_f32 v206, v206
    v_exp_f32_e64 v207, v207
    v_cvt_pk_bf16_f32 v200, v200, v201
    v_cvt_pk_bf16_f32 v201, v202, v203
    v_cvt_pk_bf16_f32 v202, v204, v205
    v_cvt_pk_bf16_f32 v203, v206, v207
    s_nop 3
    s_branch L_back2
L_att_done:
    s_mov_b64 exec, 1
    s_nop 0
    v_mov_b32 v14, 163712
    v_mov_b32_e64 v13, 1
    ds_add_u32 v14, v13
    s_mov_b64 exec, -1
    v_lshlrev_b32 v80, 16, v184
    v_and_b32 v81, 0xffff0000, v184
    v_lshlrev_b32_e64 v82, 16, v185
    v_and_b32 v83, 0xffff0000, v185
    v_lshlrev_b32_e64 v84, 16, v186
    v_and_b32 v85, 0xffff0000, v186
    v_lshlrev_b32_e64 v86, 16, v187
    v_and_b32 v87, 0xffff0000, v187
    v_mul_f32 v64, v160, v64
    v_mul_f32 v65, v160, v65
    v_mul_f32 v66, v160, v66
    v_mul_f32 v67, v160, v67
    v_mul_f32 v68, v160, v68
    v_mul_f32 v69, v160, v69
    v_mul_f32 v70, v160, v70
    v_mul_f32 v71, v160, v71
    v_fmac_f32 v64, v162, v80
    v_fmac_f32 v65, v162, v81
    v_fmac_f32 v66, v162, v82
    v_fmac_f32 v67, v162, v83
    v_fmac_f32 v68, v162, v84
    v_fmac_f32 v69, v162, v85
    v_fmac_f32 v70, v162, v86
    v_fmac_f32 v71, v162, v87
    v_cvt_pk_bf16_f32 v184, v64, v65
    v_cvt_pk_bf16_f32 v185, v66, v67
    v_cvt_pk_bf16_f32 v186, v68, v69
    v_cvt_pk_bf16_f32 v187, v70, v71
    s_add_u32 s42, s54, 0
    s_nop 0
    buffer_store_dwordx4 v[184:187], v4, s[16:19], s42 offen sc1
    v_lshlrev_b32_e64 v88, 16, v188
    v_and_b32 v89, 0xffff0000, v188
    v_lshlrev_b32_e64 v90, 16, v189
    v_and_b32 v91, 0xffff0000, v189
    v_lshlrev_b32_e64 v92, 16, v190
    v_and_b32 v93, 0xffff0000, v190
    v_lshlrev_b32_e64 v94, 16, v191
    v_and_b32 v95, 0xffff0000, v191
    v_mul_f32 v72, v160, v72
    v_mul_f32 v73, v160, v73
    v_mul_f32 v74, v160, v74
    v_mul_f32 v75, v160, v75
    v_mul_f32 v76, v160, v76
    v_mul_f32 v77, v160, v77
    v_mul_f32 v78, v160, v78
    v_mul_f32 v79, v160, v79
    v_fmac_f32 v72, v162, v88
    v_fmac_f32 v73, v162, v89
    v_fmac_f32 v74, v162, v90
    v_fmac_f32 v75, v162, v91
    v_fmac_f32 v76, v162, v92
    v_fmac_f32 v77, v162, v93
    v_fmac_f32 v78, v162, v94
    v_fmac_f32 v79, v162, v95
    v_cvt_pk_bf16_f32 v188, v72, v73
    v_cvt_pk_bf16_f32 v189, v74, v75
    v_cvt_pk_bf16_f32 v190, v76, v77
    v_cvt_pk_bf16_f32 v191, v78, v79
    s_add_u32 s42, s54, 9216
    buffer_store_dwordx4 v[188:191], v4, s[16:19], s42 offen sc1
    v_lshlrev_b32_e64 v112, 16, v192
    v_and_b32 v113, 0xffff0000, v192
    v_lshlrev_b32_e64 v114, 16, v193
    v_and_b32 v115, 0xffff0000, v193
    v_lshlrev_b32_e64 v116, 16, v194
    v_and_b32 v117, 0xffff0000, v194
    v_lshlrev_b32_e64 v118, 16, v195
    v_and_b32 v119, 0xffff0000, v195
    v_mul_f32 v96, v164, v96
    v_mul_f32 v97, v164, v97
    v_mul_f32 v98, v164, v98
    v_mul_f32 v99, v164, v99
    v_mul_f32 v100, v164, v100
    v_mul_f32 v101, v164, v101
    v_mul_f32 v102, v164, v102
    v_mul_f32 v103, v164, v103
    v_fmac_f32 v96, v166, v112
    v_fmac_f32 v97, v166, v113
    v_fmac_f32 v98, v166, v114
    v_fmac_f32 v99, v166, v115
    v_fmac_f32 v100, v166, v116
    v_fmac_f32 v101, v166, v117
    v_fmac_f32 v102, v166, v118
    v_fmac_f32 v103, v166, v119
    v_cvt_pk_bf16_f32 v192, v96, v97
    v_cvt_pk_bf16_f32 v193, v98, v99
    v_cvt_pk_bf16_f32 v194, v100, v101
    v_cvt_pk_bf16_f32 v195, v102, v103
    s_add_u32 s42, s54, 1024
    buffer_store_dwordx4 v[192:195], v4, s[16:19], s42 offen sc1
    v_lshlrev_b32_e64 v120, 16, v196
    v_and_b32 v121, 0xffff0000, v196
    v_lshlrev_b32_e64 v122, 16, v197
    v_and_b32 v123, 0xffff0000, v197
    v_lshlrev_b32_e64 v124, 16, v198
    v_and_b32 v125, 0xffff0000, v198
    v_lshlrev_b32_e64 v126, 16, v199
    v_and_b32 v127, 0xffff0000, v199
    v_mul_f32 v104, v164, v104
    v_mul_f32 v105, v164, v105
    v_mul_f32 v106, v164, v106
    v_mul_f32 v107, v164, v107
    v_mul_f32 v108, v164, v108
    v_mul_f32 v109, v164, v109
    v_mul_f32 v110, v164, v110
    v_mul_f32 v111, v164, v111
    v_fmac_f32 v104, v166, v120
    v_fmac_f32 v105, v166, v121
    v_fmac_f32 v106, v166, v122
    v_fmac_f32 v107, v166, v123
    v_fmac_f32 v108, v166, v124
    v_fmac_f32 v109, v166, v125
    v_fmac_f32 v110, v166, v126
    v_fmac_f32 v111, v166, v127
    v_cvt_pk_bf16_f32 v196, v104, v105
    v_cvt_pk_bf16_f32 v197, v106, v107
    v_cvt_pk_bf16_f32 v198, v108, v109
    v_cvt_pk_bf16_f32 v199, v110, v111
    s_add_u32 s42, s54, 10240
    buffer_store_dwordx4 v[196:199], v4, s[16:19], s42 offen sc1
    v_lshlrev_b32_e64 v144, 16, v200
    v_and_b32 v145, 0xffff0000, v200
    v_lshlrev_b32_e64 v146, 16, v201
    v_and_b32 v147, 0xffff0000, v201
    v_lshlrev_b32_e64 v148, 16, v202
    v_and_b32 v149, 0xffff0000, v202
    v_lshlrev_b32_e64 v150, 16, v203
    v_and_b32 v151, 0xffff0000, v203
    v_mul_f32 v128, v168, v128
    v_mul_f32 v129, v168, v129
    v_mul_f32 v130, v168, v130
    v_mul_f32 v131, v168, v131
    v_mul_f32 v132, v168, v132
    v_mul_f32 v133, v168, v133
    v_mul_f32 v134, v168, v134
    v_mul_f32 v135, v168, v135
    v_fmac_f32 v128, v170, v144
    v_fmac_f32 v129, v170, v145
    v_fmac_f32 v130, v170, v146
    v_fmac_f32 v131, v170, v147
    v_fmac_f32 v132, v170, v148
    v_fmac_f32 v133, v170, v149
    v_fmac_f32 v134, v170, v150
    v_fmac_f32 v135, v170, v151
    v_cvt_pk_bf16_f32 v200, v128, v129
    v_cvt_pk_bf16_f32 v201, v130, v131
    v_cvt_pk_bf16_f32 v202, v132, v133
    v_cvt_pk_bf16_f32 v203, v134, v135
    s_add_u32 s42, s54, 2048
    buffer_store_dwordx4 v[200:203], v4, s[16:19], s42 offen sc1
    v_lshlrev_b32_e64 v152, 16, v204
    v_and_b32 v153, 0xffff0000, v204
    v_lshlrev_b32_e64 v154, 16, v205
    v_and_b32 v155, 0xffff0000, v205
    v_lshlrev_b32_e64 v156, 16, v206
    v_and_b32 v157, 0xffff0000, v206
    v_lshlrev_b32_e64 v158, 16, v207
    v_and_b32 v159, 0xffff0000, v207
    v_mul_f32 v136, v168, v136
    v_mul_f32 v137, v168, v137
    v_mul_f32 v138, v168, v138
    v_mul_f32 v139, v168, v139
    v_mul_f32 v140, v168, v140
    v_mul_f32 v141, v168, v141
    v_mul_f32 v142, v168, v142
    v_mul_f32 v143, v168, v143
    v_fmac_f32 v136, v170, v152
    v_fmac_f32 v137, v170, v153
    v_fmac_f32 v138, v170, v154
    v_fmac_f32 v139, v170, v155
    v_fmac_f32 v140, v170, v156
    v_fmac_f32 v141, v170, v157
    v_fmac_f32 v142, v170, v158
    v_fmac_f32 v143, v170, v159
    v_cvt_pk_bf16_f32 v204, v136, v137
    v_cvt_pk_bf16_f32 v205, v138, v139
    v_cvt_pk_bf16_f32 v206, v140, v141
    v_cvt_pk_bf16_f32 v207, v142, v143
    s_add_u32 s42, s54, 11264
    buffer_store_dwordx4 v[204:207], v4, s[16:19], s42 offen sc1
    s_cmp_lt_u32 s36, 2
    s_cbranch_scc1 L_join
    s_waitcnt vmcnt(0)
    s_mov_b64 exec, 1
    v_mov_b32 v14, 163712
    v_mov_b32_e64 v13, 1
    ds_add_rtn_u32 v12, v14, v13 offset:4
    ds_read_b32 v13, v14 offset:8
    s_waitcnt lgkmcnt(0)
    v_readfirstlane_b32 s42, v12
    s_nop 0
    s_cmp_lg_u32 s42, 5
    s_cbranch_scc1 L_pub_x
    v_or_b32 v13, 0x40000000, v13
    s_lshl_b32 s43, s38, 7
    v_mov_b32 v12, s43
    buffer_store_dword v13, v12, s[4:7], 0 offen sc1
L_pub_x:
    s_mov_b64 exec, -1
    s_endpgm
L_join:
    s_lshl_b32 s49, s36, 14
    s_nop 0
    s_mov_b32 s45, 32768
    v_and_b32 v12, 63, v0
    v_lshrrev_b32 v13, 4, v12
    v_and_b32_e64 v14, 15, v12
    v_bfe_u32 v15, v12, 2, 2
    v_lshlrev_b32_e64 v1, 4, v12
    v_add_u32 v8, 4096, v1
    v_lshrrev_b32 v9, 5, v12
    v_and_b32 v4, 3, v12
    v_lshlrev_b32 v5, 1, v9
    v_xor_b32 v4, v4, v5
    v_lshlrev_b32 v4, 4, v4
    v_and_b32 v5, 1, v13
    v_lshl_add_u32 v4, v5, 6, v4
    v_lshl_add_u32 v4, v15, 10, v4
    v_lshl_add_u32 v4, v9, 12, v4
    v_xor_b32 v4, 64, v4
    s_and_b32 s42, s38, 3
    s_lshl_b32 s42, s42, 8
    s_and_b32 s43, s36, 1
    s_lshl_b32 s43, s43, 7
    s_add_u32 s42, s42, s43
    v_add_u32 v4, s42, v4
    v_and_b32 v2, 3, v12
    v_lshlrev_b32_e64 v2, 3, v2
    v_lshl_add_u32 v2, v15, 6, v2
    v_lshl_add_u32 v2, v5, 5, v2
    v_lshl_add_u32 v2, v13, 9, v2
    v_add_u32 v2, s49, v2
    v_xor_b32 v3, 32, v2
    v_add_u32 v5, 7168, v4
    v_add_u32 v6, 14336, v4
    v_add_u32 v7, 21504, v4
    v_add_u32 v9, 8192, v1
    v_lshlrev_b32 v11, 7, v14
    s_lshr_b32 s42, s38, 2
    v_mov_b32 v10, 0x10000
    v_cmp_eq_u32 vcc, s42, v15
    s_nop 1
    v_cndmask_b32 v11, v10, v11, vcc
    v_mov_b32 v15, 3
    v_lshrrev_b32 v15, v13, v15
    v_lshlrev_b32 v15, 29, v15
    s_and_b32 s83, s36, 1
    s_lshl_b32 s83, s83, 1
    s_add_u32 s83, s83, 1
    v_mov_b64 v[16:17], 0
    v_mov_b64 v[18:19], 0
    v_mov_b64 v[20:21], 0
    v_mov_b64 v[22:23], 0
    v_mov_b64 v[24:25], 0
    v_mov_b64 v[26:27], 0
    v_mov_b64 v[28:29], 0
    v_mov_b64 v[30:31], 0
    v_mov_b64 v[32:33], 0
    v_mov_b64 v[34:35], 0
    v_mov_b64 v[36:37], 0
    v_mov_b64 v[38:39], 0
    v_mov_b64 v[40:41], 0
    v_mov_b64 v[42:43], 0
    v_mov_b64 v[44:45], 0
    v_mov_b64 v[46:47], 0
    v_mov_b64 v[48:49], 0
    v_mov_b64 v[50:51], 0
    v_mov_b64 v[52:53], 0
    v_mov_b64 v[54:55], 0
    v_mov_b64 v[56:57], 0
    v_mov_b64 v[58:59], 0
    v_mov_b64 v[60:61], 0
    v_mov_b64 v[62:63], 0
    v_mov_b64 v[64:65], 0
    v_mov_b64 v[66:67], 0
    v_mov_b64 v[68:69], 0
    v_mov_b64 v[70:71], 0
    v_mov_b64 v[72:73], 0
    v_mov_b64 v[74:75], 0
    v_mov_b64 v[76:77], 0
    v_mov_b64 v[78:79], 0
    v_mov_b64 v[80:81], 0
    v_mov_b64 v[82:83], 0
    v_mov_b64 v[84:85], 0
    v_mov_b64 v[86:87], 0
    v_mov_b64 v[88:89], 0
    v_mov_b64 v[90:91], 0
    v_mov_b64 v[92:93], 0
    v_mov_b64 v[94:95], 0
    v_mov_b64 v[96:97], 0
    v_mov_b64 v[98:99], 0
    v_mov_b64 v[100:101], 0
    v_mov_b64 v[102:103], 0
    v_mov_b64 v[104:105], 0
    v_mov_b64 v[106:107], 0
    v_mov_b64 v[108:109], 0
    v_mov_b64 v[110:111], 0
    v_mov_b64 v[112:113], 0
    v_mov_b64 v[114:115], 0
    v_mov_b64 v[116:117], 0
    v_mov_b64 v[118:119], 0
    v_mov_b64 v[120:121], 0
    v_mov_b64 v[122:123], 0
    v_mov_b64 v[124:125], 0
    v_mov_b64 v[126:127], 0
    v_mov_b64 v[176:177], 0
    v_mov_b64 v[178:179], 0
    v_mov_b64 v[180:181], 0
    v_mov_b64 v[182:183], 0
    v_mov_b64 v[184:185], 0
    v_mov_b64 v[186:187], 0
    v_mov_b64 v[188:189], 0
    v_mov_b64 v[190:191], 0
    v_mov_b64 v[192:193], 0
    v_mov_b64 v[194:195], 0
    v_mov_b64 v[196:197], 0
    v_mov_b64 v[198:199], 0
    v_mov_b64 v[200:201], 0
    v_mov_b64 v[202:203], 0
    v_mov_b64 v[204:205], 0
    v_mov_b64_e64 v[206:207], 0
    s_waitcnt vmcnt(0)
    s_mov_b64 exec, 1
    v_mov_b32 v252, 163712
    v_mov_b32_e64 v251, 1
    ds_add_rtn_u32 v250, v252, v251 offset:4
    ds_read_b32 v251, v252 offset:8
    s_waitcnt lgkmcnt(0)
    v_readfirstlane_b32 s42, v250
    s_nop 0
    s_cmp_lg_u32 s42, 5
    s_cbranch_scc1 L_pub_y
    v_or_b32 v251, 0x40000000, v251
    s_lshl_b32 s43, s38, 7
    v_mov_b32 v250, s43
    buffer_store_dword v251, v250, s[4:7], 0 offen sc1
L_pub_y:
    s_mov_b64 exec, -1
    s_nop 0
    v_mov_b32 v250, 163712
L_w6:
    ds_read_b32 v251, v250
    ds_read_b32 v252, v250 offset:8
    s_waitcnt lgkmcnt(0)
    v_readfirstlane_b32 s42, v251
    v_readfirstlane_b32 s84, v252
    s_cmp_lt_u32 s42, 6
    s_cbranch_scc1 L_w6
    s_nop 0
    s_or_b32 s85, s84, 0x60000000
    s_branch L_p2
.p2align 3
L_auxrole:
    s_mul_i32 s42, s37, 1180672
    s_add_u32 s42, s42, 1024
    s_add_u32 s90, s92, s42
    s_addc_u32 s91, s93, 0
    s_mov_b32 s16, s90
    s_mov_b32 s17, s91
    s_mov_b32 s18, 1179648
    s_mov_b32 s19, 0x20000
    s_cmp_eq_u32 s36, 6
    s_cselect_b32 s82, s82, s84
    s_cselect_b32 s83, s83, s85
    s_lshl_b32 s42, s40, 4
    s_add_u32 s42, s42, s38
    s_lshl_b32 s42, s42, 19
    s_add_u32 s82, s82, s42
    s_addc_u32 s83, s83, 0
    s_mov_b32 s20, s82
    s_mov_b32 s21, s83
    s_mov_b32 s22, 524288
    s_mov_b32 s23, 0x20000
    s_mov_b32 s24, s88
    s_mov_b32 s25, s89
    s_mov_b32 s26, 4194304
    s_mov_b32 s27, 0x20000
    s_mov_b32 s28, s96
    s_mov_b32 s29, s97
    s_mov_b32 s30, 2359296
    s_mov_b32 s31, 0x20000
    s_mov_b32 s32, s98
    s_mov_b32 s33, s99
    s_mov_b32 s34, 256
    s_mov_b32 s35, 0x20000
    s_lshl_b32 s42, s37, 12
    s_nop 0
    s_add_u32 s42, s42, 0x2000000
    s_add_u32 s90, s92, s42
    s_addc_u32 s91, s93, 0
    s_mov_b32 s4, s90
    s_mov_b32 s5, s91
    s_mov_b32 s6, 2048
    s_mov_b32 s7, 0x20000
    s_mov_b32 s100, s92
    s_mov_b32 s101, s93
    s_and_b32 s59, s36, 1
    s_lshr_b32 s62, s36, 1
    v_and_b32 v236, 31, v0
    v_lshlrev_b32 v236, 2, v236
    v_add_u32 v236, 163712, v236
    v_mov_b32_e64 v234, 0
    ds_write_b32 v236, v234
    v_and_b32 v231, 3, v12
    v_lshlrev_b32 v231, 3, v231
    v_lshl_add_u32 v231, v15, 6, v231
    v_and_b32_e64 v232, 1, v13
    v_lshl_add_u32 v231, v232, 5, v231
    v_lshl_add_u32 v2, v13, 10, v231
    v_lshl_add_u32 v231, v13, 11, v231
    s_and_b32 s42, s36, 3
    s_lshl_b32 s42, s42, 8
    v_add_u32 v231, s42, v231
    v_xor_b32 v232, 32, v231
    v_lshrrev_b32 v233, 3, v14
    v_lshlrev_b32 v233, 1, v233
    v_xor_b32 v233, v233, v13
    v_lshlrev_b32 v233, 4, v233
    v_and_b32_e64 v236, 3, v14
    v_lshl_add_u32 v233, v236, 6, v233
    v_lshl_add_u32 v233, v15, 9, v233
    s_cmp_eq_u32 s36, 6
    s_cselect_b32 s42, 0, 32
    s_cselect_b32 s43, 16, 0
    s_cselect_b32 s44, 16, 32
    s_cselect_b32 s60, 0, 128
    s_cselect_b32 s59, 0, 16384
    v_xor_b32 v129, s42, v128
    v_xor_b32 v130, s43, v128
    v_xor_b32 v131, s44, v128
    v_xor_b32 v132, s60, v128
    v_xor_b32 v133, s60, v129
    v_xor_b32 v134, s60, v130
    v_xor_b32_e64 v135, s60, v131
    v_add_u32 v1, 98304, v233
    v_mov_b32 v238, 0x3e0293ee
    v_mov_b32 v239, 0x3e0293ee
    s_add_u32 s46, s41, 1
    s_and_b32 s46, s46, 7
    s_lshl_b32 s47, s46, 19
    s_nop 0
    s_add_u32 m0, s63, 49152
    s_nop 0
    s_nop 0
    buffer_load_dwordx4 v224, s[8:11], s47 offen offset:0 lds
    buffer_load_dwordx4 v225, s[8:11], s47 offen offset:1024 lds
    buffer_load_dwordx4 v226, s[8:11], s47 offen offset:2048 lds
    buffer_load_dwordx4 v227, s[8:11], s47 offen offset:3072 lds
    s_add_u32 m0, s61, 116736
    s_lshl_b32 s47, s46, 7
    s_nop 0
    buffer_load_dwordx4 v248, s[12:15], s47 offen offset:0 lds
    buffer_load_dwordx4 v249, s[12:15], s47 offen offset:1024 lds
    buffer_load_dwordx4 v250, s[12:15], s47 offen offset:2048 lds
    buffer_load_dwordx4 v251, s[12:15], s47 offen offset:3072 lds
    s_setprio 1
    s_waitcnt vmcnt(8)
    v_add_u32 v234, 32768, v231
    v_add_u32 v235, 32768, v232
    v_add_u32 v236, 98304, v233
    s_waitcnt lgkmcnt(0)
    s_barrier
    ds_read_b64_tr_b16 v[96:97], v234 offset:0
    ds_read_b64_tr_b16 v[98:99], v234 offset:1024
    ds_read_b128 v[56:59], v236 offset:10240
    ds_read_b128 v[60:63], v236 offset:12288
    ds_read_b128 v[64:67], v236 offset:14336
    ds_read_b128 v[68:71], v236 offset:16384
    ds_read_b64_tr_b16 v[100:101], v235 offset:0
    ds_read_b64_tr_b16 v[102:103], v235 offset:1024
    s_add_u32 s46, s41, 2
    s_and_b32 s46, s46, 7
    s_lshl_b32 s47, s46, 19
    s_add_u32 m0, s63, 0
    s_nop 0
    s_nop 0
    buffer_load_dwordx4 v224, s[8:11], s47 offen offset:0 lds
    buffer_load_dwordx4 v225, s[8:11], s47 offen offset:1024 lds
    buffer_load_dwordx4 v226, s[8:11], s47 offen offset:2048 lds
    buffer_load_dwordx4 v227, s[8:11], s47 offen offset:3072 lds
    s_waitcnt lgkmcnt(0)
    s_nop 0
    v_mfma_f32_16x16x32_bf16 v[16:19], v[96:99], v[56:59], 0
    ds_read_b64_tr_b16 v[104:105], v234 offset:8192
    ds_read_b64_tr_b16 v[106:107], v234 offset:9216
    s_add_u32 m0, s61, 135168
    s_lshl_b32 s47, s46, 7
    s_nop 0
    buffer_load_dwordx4 v248, s[12:15], s47 offen offset:0 lds
    v_mfma_f32_16x16x32_bf16 v[24:27], v[96:99], v[60:63], 0
    ds_read_b128 v[76:79], v236 offset:10496
    ds_read_b128 v[80:83], v236 offset:12544
    v_mfma_f32_16x16x32_bf16 v[32:35], v[96:99], v[64:67], 0
    ds_read_b128 v[84:87], v236 offset:14592
    ds_read_b128 v[88:91], v236 offset:16640
    buffer_load_dwordx4 v249, s[12:15], s47 offen offset:1024 lds
    v_mfma_f32_16x16x32_bf16 v[40:43], v[96:99], v[68:71], 0
    ds_read_b64_tr_b16 v[108:109], v235 offset:8192
    ds_read_b64_tr_b16 v[110:111], v235 offset:9216
    v_mfma_f32_16x16x32_bf16 v[20:23], v[100:103], v[56:59], 0
    buffer_load_dwordx4 v250, s[12:15], s47 offen offset:2048 lds
    v_mfma_f32_16x16x32_bf16 v[28:31], v[100:103], v[60:63], 0
    v_mfma_f32_16x16x32_bf16 v[36:39], v[100:103], v[64:67], 0
    buffer_load_dwordx4 v251, s[12:15], s47 offen offset:3072 lds
    v_mfma_f32_16x16x32_bf16 v[44:47], v[100:103], v[68:71], 0
    s_waitcnt vmcnt(8)
    s_nop 0
    v_add_u32 v234, 49152, v231
    v_add_u32 v235, 49152, v232
    v_add_u32 v236, 116736, v233
    s_waitcnt lgkmcnt(0)
    s_barrier
    v_mfma_f32_16x16x32_bf16 v[16:19], v[104:107], v[76:79], v[16:19]
    ds_read_b64_tr_b16 v[96:97], v234 offset:0
    ds_read_b64_tr_b16 v[98:99], v234 offset:1024
    s_add_u32 s46, s41, 3
    s_and_b32 s46, s46, 7
    s_lshl_b32 s47, s46, 19
    s_nop 0
    s_add_u32 m0, s63, 32768
    s_nop 0
    s_nop 0
    buffer_load_dwordx4 v224, s[8:11], s47 offen offset:0 lds
    v_mfma_f32_16x16x32_bf16 v[24:27], v[104:107], v[80:83], v[24:27]
    ds_read_b128 v[56:59], v236 offset:10240
    ds_read_b128 v[60:63], v236 offset:12288
    v_mfma_f32_16x16x32_bf16 v[32:35], v[104:107], v[84:87], v[32:35]
    ds_read_b128 v[64:67], v236 offset:14336
    ds_read_b128 v[68:71], v236 offset:16384
    buffer_load_dwordx4 v225, s[8:11], s47 offen offset:1024 lds
    v_mfma_f32_16x16x32_bf16 v[40:43], v[104:107], v[88:91], v[40:43]
    ds_read_b64_tr_b16 v[100:101], v235 offset:0
    ds_read_b64_tr_b16 v[102:103], v235 offset:1024
    v_mfma_f32_16x16x32_bf16 v[20:23], v[108:111], v[76:79], v[20:23]
    buffer_load_dwordx4 v226, s[8:11], s47 offen offset:2048 lds
    v_mfma_f32_16x16x32_bf16 v[28:31], v[108:111], v[80:83], v[28:31]
    v_mfma_f32_16x16x32_bf16 v[36:39], v[108:111], v[84:87], v[36:39]
    buffer_load_dwordx4 v227, s[8:11], s47 offen offset:3072 lds
    v_mfma_f32_16x16x32_bf16 v[44:47], v[108:111], v[88:91], v[44:47]
    s_waitcnt lgkmcnt(0)
    s_nop 0
    v_mfma_f32_16x16x32_bf16 v[16:19], v[96:99], v[56:59], v[16:19]
    ds_read_b64_tr_b16 v[104:105], v234 offset:8192
    ds_read_b64_tr_b16 v[106:107], v234 offset:9216
    s_add_u32 m0, s61, 98304
    s_lshl_b32 s47, s46, 7
    s_nop 0
    buffer_load_dwordx4 v248, s[12:15], s47 offen offset:0 lds
    v_mfma_f32_16x16x32_bf16 v[24:27], v[96:99], v[60:63], v[24:27]
    ds_read_b128 v[76:79], v236 offset:10496
    ds_read_b128 v[80:83], v236 offset:12544
    v_mfma_f32_16x16x32_bf16 v[32:35], v[96:99], v[64:67], v[32:35]
    ds_read_b128 v[84:87], v236 offset:14592
    ds_read_b128 v[88:91], v236 offset:16640
    buffer_load_dwordx4 v249, s[12:15], s47 offen offset:1024 lds
    v_mfma_f32_16x16x32_bf16 v[40:43], v[96:99], v[68:71], v[40:43]
    ds_read_b64_tr_b16 v[108:109], v235 offset:8192
    ds_read_b64_tr_b16 v[110:111], v235 offset:9216
    v_mfma_f32_16x16x32_bf16 v[20:23], v[100:103], v[56:59], v[20:23]
    buffer_load_dwordx4 v250, s[12:15], s47 offen offset:2048 lds
    v_mfma_f32_16x16x32_bf16 v[28:31], v[100:103], v[60:63], v[28:31]
    v_mfma_f32_16x16x32_bf16 v[36:39], v[100:103], v[64:67], v[36:39]
    buffer_load_dwordx4 v251, s[12:15], s47 offen offset:3072 lds
    v_mfma_f32_16x16x32_bf16 v[44:47], v[100:103], v[68:71], v[44:47]
    s_waitcnt vmcnt(8)
    v_add_u32 v234, 0, v231
    v_add_u32_e64 v235, 0, v232
    v_add_u32 v236, 135168, v233
    s_waitcnt lgkmcnt(0)
    s_barrier
    v_mfma_f32_16x16x32_bf16 v[16:19], v[104:107], v[76:79], v[16:19]
    ds_read_b64_tr_b16 v[96:97], v234 offset:0
    ds_read_b64_tr_b16 v[98:99], v234 offset:1024
    s_add_u32 s46, s41, 4
    s_and_b32 s46, s46, 7
    s_lshl_b32 s47, s46, 19
    s_nop 0
    s_add_u32 m0, s63, 49152
    s_nop 0
    s_nop 0
    buffer_load_dwordx4 v224, s[8:11], s47 offen offset:0 lds
    v_mfma_f32_16x16x32_bf16 v[24:27], v[104:107], v[80:83], v[24:27]
    ds_read_b128 v[56:59], v236 offset:10240
    ds_read_b128 v[60:63], v236 offset:12288
    v_mfma_f32_16x16x32_bf16 v[32:35], v[104:107], v[84:87], v[32:35]
    ds_read_b128 v[64:67], v236 offset:14336
    ds_read_b128 v[68:71], v236 offset:16384
    buffer_load_dwordx4 v225, s[8:11], s47 offen offset:1024 lds
    v_mfma_f32_16x16x32_bf16 v[40:43], v[104:107], v[88:91], v[40:43]
    ds_read_b64_tr_b16 v[100:101], v235 offset:0
    ds_read_b64_tr_b16 v[102:103], v235 offset:1024
    v_mfma_f32_16x16x32_bf16 v[20:23], v[108:111], v[76:79], v[20:23]
    buffer_load_dwordx4 v226, s[8:11], s47 offen offset:2048 lds
    v_mfma_f32_16x16x32_bf16 v[28:31], v[108:111], v[80:83], v[28:31]
    v_mfma_f32_16x16x32_bf16 v[36:39], v[108:111], v[84:87], v[36:39]
    buffer_load_dwordx4 v227, s[8:11], s47 offen offset:3072 lds
    v_mfma_f32_16x16x32_bf16 v[44:47], v[108:111], v[88:91], v[44:47]
    s_waitcnt lgkmcnt(0)
    s_nop 0
    v_mfma_f32_16x16x32_bf16 v[16:19], v[96:99], v[56:59], v[16:19]
    ds_read_b64_tr_b16 v[104:105], v234 offset:8192
    ds_read_b64_tr_b16 v[106:107], v234 offset:9216
    s_add_u32 m0, s61, 116736
    s_lshl_b32 s47, s46, 7
    s_nop 0
    buffer_load_dwordx4 v248, s[12:15], s47 offen offset:0 lds
    v_mfma_f32_16x16x32_bf16 v[24:27], v[96:99], v[60:63], v[24:27]
    ds_read_b128 v[76:79], v236 offset:10496
    ds_read_b128 v[80:83], v236 offset:12544
    v_mfma_f32_16x16x32_bf16 v[32:35], v[96:99], v[64:67], v[32:35]
    ds_read_b128 v[84:87], v236 offset:14592
    ds_read_b128 v[88:91], v236 offset:16640
    buffer_load_dwordx4 v249, s[12:15], s47 offen offset:1024 lds
    v_mfma_f32_16x16x32_bf16 v[40:43], v[96:99], v[68:71], v[40:43]
    ds_read_b64_tr_b16 v[108:109], v235 offset:8192
    ds_read_b64_tr_b16 v[110:111], v235 offset:9216
    v_mfma_f32_16x16x32_bf16 v[20:23], v[100:103], v[56:59], v[20:23]
    buffer_load_dwordx4 v250, s[12:15], s47 offen offset:2048 lds
    v_mfma_f32_16x16x32_bf16 v[28:31], v[100:103], v[60:63], v[28:31]
    v_mfma_f32_16x16x32_bf16 v[36:39], v[100:103], v[64:67], v[36:39]
    buffer_load_dwordx4 v251, s[12:15], s47 offen offset:3072 lds
    v_mfma_f32_16x16x32_bf16 v[44:47], v[100:103], v[68:71], v[44:47]
    s_waitcnt vmcnt(8)
    s_nop 0
    v_add_u32 v234, 32768, v231
    v_add_u32 v235, 32768, v232
    v_add_u32 v236, 98304, v233
    s_waitcnt lgkmcnt(0)
    s_barrier
    v_mfma_f32_16x16x32_bf16 v[16:19], v[104:107], v[76:79], v[16:19]
    ds_read_b64_tr_b16 v[96:97], v234 offset:0
    ds_read_b64_tr_b16 v[98:99], v234 offset:1024
    s_add_u32 s46, s41, 5
    s_and_b32 s46, s46, 7
    s_lshl_b32 s47, s46, 19
    s_add_u32 m0, s63, 0
    s_nop 0
    s_nop 0
    buffer_load_dwordx4 v224, s[8:11], s47 offen offset:0 lds
    v_mfma_f32_16x16x32_bf16 v[24:27], v[104:107], v[80:83], v[24:27]
    ds_read_b128 v[56:59], v236 offset:10240
    ds_read_b128 v[60:63], v236 offset:12288
    v_mfma_f32_16x16x32_bf16 v[32:35], v[104:107], v[84:87], v[32:35]
    ds_read_b128 v[64:67], v236 offset:14336
    ds_read_b128 v[68:71], v236 offset:16384
    buffer_load_dwordx4 v225, s[8:11], s47 offen offset:1024 lds
    v_mfma_f32_16x16x32_bf16 v[40:43], v[104:107], v[88:91], v[40:43]
    ds_read_b64_tr_b16 v[100:101], v235 offset:0
    ds_read_b64_tr_b16 v[102:103], v235 offset:1024
    v_mfma_f32_16x16x32_bf16 v[20:23], v[108:111], v[76:79], v[20:23]
    buffer_load_dwordx4 v226, s[8:11], s47 offen offset:2048 lds
    v_mfma_f32_16x16x32_bf16 v[28:31], v[108:111], v[80:83], v[28:31]
    v_mfma_f32_16x16x32_bf16 v[36:39], v[108:111], v[84:87], v[36:39]
    buffer_load_dwordx4 v227, s[8:11], s47 offen offset:3072 lds
    v_mfma_f32_16x16x32_bf16 v[44:47], v[108:111], v[88:91], v[44:47]
    s_waitcnt lgkmcnt(0)
    s_nop 0
    v_mfma_f32_16x16x32_bf16 v[16:19], v[96:99], v[56:59], v[16:19]
    ds_read_b64_tr_b16 v[104:105], v234 offset:8192
    ds_read_b64_tr_b16 v[106:107], v234 offset:9216
    s_add_u32 m0, s61, 135168
    s_lshl_b32 s47, s46, 7
    s_nop 0
    buffer_load_dwordx4 v248, s[12:15], s47 offen offset:0 lds
    v_mfma_f32_16x16x32_bf16 v[24:27], v[96:99], v[60:63], v[24:27]
    ds_read_b128 v[76:79], v236 offset:10496
    ds_read_b128 v[80:83], v236 offset:12544
    v_mfma_f32_16x16x32_bf16 v[32:35], v[96:99], v[64:67], v[32:35]
    ds_read_b128 v[84:87], v236 offset:14592
    ds_read_b128 v[88:91], v236 offset:16640
    buffer_load_dwordx4 v249, s[12:15], s47 offen offset:1024 lds
    v_mfma_f32_16x16x32_bf16 v[40:43], v[96:99], v[68:71], v[40:43]
    ds_read_b64_tr_b16 v[108:109], v235 offset:8192
    ds_read_b64_tr_b16 v[110:111], v235 offset:9216
    v_mfma_f32_16x16x32_bf16 v[20:23], v[100:103], v[56:59], v[20:23]
    buffer_load_dwordx4 v250, s[12:15], s47 offen offset:2048 lds
    v_mfma_f32_16x16x32_bf16 v[28:31], v[100:103], v[60:63], v[28:31]
    v_mfma_f32_16x16x32_bf16 v[36:39], v[100:103], v[64:67], v[36:39]
    buffer_load_dwordx4 v251, s[12:15], s47 offen offset:3072 lds
    v_mfma_f32_16x16x32_bf16 v[44:47], v[100:103], v[68:71], v[44:47]
    s_waitcnt vmcnt(8)
    s_nop 0
    v_add_u32 v234, 49152, v231
    v_add_u32 v235, 49152, v232
    v_add_u32 v236, 116736, v233
    s_waitcnt lgkmcnt(0)
    s_barrier
    v_mfma_f32_16x16x32_bf16 v[16:19], v[104:107], v[76:79], v[16:19]
    ds_read_b64_tr_b16 v[96:97], v234 offset:0
    ds_read_b64_tr_b16 v[98:99], v234 offset:1024
    s_add_u32 s46, s41, 6
    s_and_b32 s46, s46, 7
    s_lshl_b32 s47, s46, 19
    s_nop 0
    s_add_u32 m0, s63, 32768
    s_nop 0
    s_nop 0
    buffer_load_dwordx4 v224, s[8:11], s47 offen offset:0 lds
    v_mfma_f32_16x16x32_bf16 v[24:27], v[104:107], v[80:83], v[24:27]
    ds_read_b128 v[56:59], v236 offset:10240
    ds_read_b128 v[60:63], v236 offset:12288
    v_mfma_f32_16x16x32_bf16 v[32:35], v[104:107], v[84:87], v[32:35]
    ds_read_b128 v[64:67], v236 offset:14336
    ds_read_b128 v[68:71], v236 offset:16384
    buffer_load_dwordx4 v225, s[8:11], s47 offen offset:1024 lds
    v_mfma_f32_16x16x32_bf16 v[40:43], v[104:107], v[88:91], v[40:43]
    ds_read_b64_tr_b16 v[100:101], v235 offset:0
    ds_read_b64_tr_b16 v[102:103], v235 offset:1024
    v_mfma_f32_16x16x32_bf16 v[20:23], v[108:111], v[76:79], v[20:23]
    buffer_load_dwordx4 v226, s[8:11], s47 offen offset:2048 lds
    v_mfma_f32_16x16x32_bf16 v[28:31], v[108:111], v[80:83], v[28:31]
    v_mfma_f32_16x16x32_bf16 v[36:39], v[108:111], v[84:87], v[36:39]
    buffer_load_dwordx4 v227, s[8:11], s47 offen offset:3072 lds
    v_mfma_f32_16x16x32_bf16 v[44:47], v[108:111], v[88:91], v[44:47]
    s_waitcnt lgkmcnt(0)
    s_nop 0
    v_mfma_f32_16x16x32_bf16 v[16:19], v[96:99], v[56:59], v[16:19]
    ds_read_b64_tr_b16 v[104:105], v234 offset:8192
    ds_read_b64_tr_b16 v[106:107], v234 offset:9216
    s_add_u32 m0, s61, 98304
    s_lshl_b32 s47, s46, 7
    s_nop 0
    buffer_load_dwordx4 v248, s[12:15], s47 offen offset:0 lds
    v_mfma_f32_16x16x32_bf16 v[24:27], v[96:99], v[60:63], v[24:27]
    ds_read_b128 v[76:79], v236 offset:10496
    ds_read_b128 v[80:83], v236 offset:12544
    v_mfma_f32_16x16x32_bf16 v[32:35], v[96:99], v[64:67], v[32:35]
    ds_read_b128 v[84:87], v236 offset:14592
    ds_read_b128 v[88:91], v236 offset:16640
    buffer_load_dwordx4 v249, s[12:15], s47 offen offset:1024 lds
    v_mfma_f32_16x16x32_bf16 v[40:43], v[96:99], v[68:71], v[40:43]
    ds_read_b64_tr_b16 v[108:109], v235 offset:8192
    ds_read_b64_tr_b16 v[110:111], v235 offset:9216
    v_mfma_f32_16x16x32_bf16 v[20:23], v[100:103], v[56:59], v[20:23]
    buffer_load_dwordx4 v250, s[12:15], s47 offen offset:2048 lds
    v_mfma_f32_16x16x32_bf16 v[28:31], v[100:103], v[60:63], v[28:31]
    v_mfma_f32_16x16x32_bf16 v[36:39], v[100:103], v[64:67], v[36:39]
    buffer_load_dwordx4 v251, s[12:15], s47 offen offset:3072 lds
    v_mfma_f32_16x16x32_bf16 v[44:47], v[100:103], v[68:71], v[44:47]
    s_waitcnt vmcnt(8)
    v_add_u32 v234, 0, v231
    v_add_u32_e64 v235, 0, v232
    v_add_u32 v236, 135168, v233
    s_waitcnt lgkmcnt(0)
    s_barrier
    v_mfma_f32_16x16x32_bf16 v[16:19], v[104:107], v[76:79], v[16:19]
    ds_read_b64_tr_b16 v[96:97], v234 offset:0
    ds_read_b64_tr_b16 v[98:99], v234 offset:1024
    s_add_u32 s46, s41, 7
    s_and_b32 s46, s46, 7
    s_lshl_b32 s47, s46, 19
    s_nop 0
    s_add_u32 m0, s63, 49152
    s_nop 0
    s_nop 0
    buffer_load_dwordx4 v224, s[8:11], s47 offen offset:0 lds
    v_mfma_f32_16x16x32_bf16 v[24:27], v[104:107], v[80:83], v[24:27]
    ds_read_b128 v[56:59], v236 offset:10240
    ds_read_b128 v[60:63], v236 offset:12288
    v_mfma_f32_16x16x32_bf16 v[32:35], v[104:107], v[84:87], v[32:35]
    ds_read_b128 v[64:67], v236 offset:14336
    ds_read_b128 v[68:71], v236 offset:16384
    buffer_load_dwordx4 v225, s[8:11], s47 offen offset:1024 lds
    v_mfma_f32_16x16x32_bf16 v[40:43], v[104:107], v[88:91], v[40:43]
    ds_read_b64_tr_b16 v[100:101], v235 offset:0
    ds_read_b64_tr_b16 v[102:103], v235 offset:1024
    v_mfma_f32_16x16x32_bf16 v[20:23], v[108:111], v[76:79], v[20:23]
    buffer_load_dwordx4 v226, s[8:11], s47 offen offset:2048 lds
    v_mfma_f32_16x16x32_bf16 v[28:31], v[108:111], v[80:83], v[28:31]
    v_mfma_f32_16x16x32_bf16 v[36:39], v[108:111], v[84:87], v[36:39]
    buffer_load_dwordx4 v227, s[8:11], s47 offen offset:3072 lds
    v_mfma_f32_16x16x32_bf16 v[44:47], v[108:111], v[88:91], v[44:47]
    s_waitcnt lgkmcnt(0)
    s_nop 0
    v_mfma_f32_16x16x32_bf16 v[16:19], v[96:99], v[56:59], v[16:19]
    ds_read_b64_tr_b16 v[104:105], v234 offset:8192
    ds_read_b64_tr_b16 v[106:107], v234 offset:9216
    s_add_u32 m0, s61, 116736
    s_lshl_b32 s47, s46, 7
    s_nop 0
    buffer_load_dwordx4 v248, s[12:15], s47 offen offset:0 lds
    v_mfma_f32_16x16x32_bf16 v[24:27], v[96:99], v[60:63], v[24:27]
    ds_read_b128 v[76:79], v236 offset:10496
    ds_read_b128 v[80:83], v236 offset:12544
    v_mfma_f32_16x16x32_bf16 v[32:35], v[96:99], v[64:67], v[32:35]
    ds_read_b128 v[84:87], v236 offset:14592
    ds_read_b128 v[88:91], v236 offset:16640
    buffer_load_dwordx4 v249, s[12:15], s47 offen offset:1024 lds
    v_mfma_f32_16x16x32_bf16 v[40:43], v[96:99], v[68:71], v[40:43]
    ds_read_b64_tr_b16 v[108:109], v235 offset:8192
    ds_read_b64_tr_b16 v[110:111], v235 offset:9216
    v_mfma_f32_16x16x32_bf16 v[20:23], v[100:103], v[56:59], v[20:23]
    buffer_load_dwordx4 v250, s[12:15], s47 offen offset:2048 lds
    v_mfma_f32_16x16x32_bf16 v[28:31], v[100:103], v[60:63], v[28:31]
    v_mfma_f32_16x16x32_bf16 v[36:39], v[100:103], v[64:67], v[36:39]
    buffer_load_dwordx4 v251, s[12:15], s47 offen offset:3072 lds
    v_mfma_f32_16x16x32_bf16 v[44:47], v[100:103], v[68:71], v[44:47]
    s_add_u32 m0, s59, 65536
    s_mov_b32 s50, 0
    s_nop 0
    buffer_load_dwordx4 v128, s[20:23], s50 offen offset:0 nt lds
    s_add_u32 m0, s59, 65536
    s_mov_b32 s50, 0
    s_nop 0
    buffer_load_dwordx4 v129, s[20:23], s50 offen offset:1024 nt lds
    s_add_u32 m0, s59, 65536
    s_mov_b32 s50, 0
    s_nop 0
    buffer_load_dwordx4 v130, s[20:23], s50 offen offset:2048 nt lds
    s_add_u32 m0, s59, 65536
    s_mov_b32 s50, 0
    s_nop 0
    buffer_load_dwordx4 v131, s[20:23], s50 offen offset:3072 nt lds
    s_add_u32 m0, s59, 69632
    s_mov_b32 s50, 4096
    buffer_load_dwordx4 v128, s[20:23], s50 offen offset:0 nt lds
    s_add_u32 m0, s59, 69632
    s_mov_b32 s50, 4096
    buffer_load_dwordx4 v129, s[20:23], s50 offen offset:1024 nt lds
    s_add_u32 m0, s59, 69632
    s_mov_b32 s50, 4096
    buffer_load_dwordx4 v130, s[20:23], s50 offen offset:2048 nt lds
    s_add_u32 m0, s59, 69632
    s_mov_b32 s50, 4096
    buffer_load_dwordx4 v131, s[20:23], s50 offen offset:3072 nt lds
    s_add_u32 m0, s59, 73728
    s_mov_b32 s50, 8192
    buffer_load_dwordx4 v132, s[20:23], s50 offen offset:0 nt lds
    s_add_u32 m0, s59, 73728
    s_mov_b32 s50, 8192
    buffer_load_dwordx4 v133, s[20:23], s50 offen offset:1024 nt lds
    s_add_u32 m0, s59, 73728
    s_mov_b32 s50, 8192
    buffer_load_dwordx4 v134, s[20:23], s50 offen offset:2048 nt lds
    s_add_u32 m0, s59, 73728
    s_mov_b32 s50, 8192
    buffer_load_dwordx4 v135, s[20:23], s50 offen offset:3072 nt lds
    s_add_u32 m0, s59, 77824
    s_mov_b32 s50, 12288
    buffer_load_dwordx4 v132, s[20:23], s50 offen offset:0 nt lds
    s_add_u32 m0, s59, 77824
    s_mov_b32 s50, 12288
    buffer_load_dwordx4 v133, s[20:23], s50 offen offset:1024 nt lds
    s_add_u32 m0, s59, 77824
    s_mov_b32 s50, 12288
    buffer_load_dwordx4 v134, s[20:23], s50 offen offset:2048 nt lds
    s_add_u32 m0, s59, 77824
    s_mov_b32 s50, 12288
    buffer_load_dwordx4 v135, s[20:23], s50 offen offset:3072 nt lds
    s_waitcnt vmcnt(24)
    s_nop 0
    v_add_u32 v234, 32768, v231
    v_add_u32 v235, 32768, v232
    v_add_u32 v236, 98304, v233
    s_waitcnt lgkmcnt(0)
    s_barrier
    v_mfma_f32_16x16x32_bf16 v[16:19], v[104:107], v[76:79], v[16:19]
    ds_read_b64_tr_b16 v[96:97], v234 offset:0
    ds_read_b64_tr_b16 v[98:99], v234 offset:1024
    v_mfma_f32_16x16x32_bf16 v[24:27], v[104:107], v[80:83], v[24:27]
    ds_read_b128 v[56:59], v236 offset:10240
    ds_read_b128 v[60:63], v236 offset:12288
    v_mfma_f32_16x16x32_bf16 v[32:35], v[104:107], v[84:87], v[32:35]
    ds_read_b128 v[64:67], v236 offset:14336
    ds_read_b128 v[68:71], v236 offset:16384
    v_mfma_f32_16x16x32_bf16 v[40:43], v[104:107], v[88:91], v[40:43]
    ds_read_b64_tr_b16 v[100:101], v235 offset:0
    ds_read_b64_tr_b16 v[102:103], v235 offset:1024
    v_mfma_f32_16x16x32_bf16 v[20:23], v[108:111], v[76:79], v[20:23]
    v_mfma_f32_16x16x32_bf16 v[28:31], v[108:111], v[80:83], v[28:31]
    v_mfma_f32_16x16x32_bf16 v[36:39], v[108:111], v[84:87], v[36:39]
    v_mfma_f32_16x16x32_bf16 v[44:47], v[108:111], v[88:91], v[44:47]
    s_waitcnt lgkmcnt(0)
    s_nop 0
    v_mfma_f32_16x16x32_bf16 v[16:19], v[96:99], v[56:59], v[16:19]
    ds_read_b64_tr_b16 v[104:105], v234 offset:8192
    ds_read_b64_tr_b16 v[106:107], v234 offset:9216
    v_mfma_f32_16x16x32_bf16 v[24:27], v[96:99], v[60:63], v[24:27]
    ds_read_b128 v[76:79], v236 offset:10496
    ds_read_b128 v[80:83], v236 offset:12544
    v_mfma_f32_16x16x32_bf16 v[32:35], v[96:99], v[64:67], v[32:35]
    ds_read_b128 v[84:87], v236 offset:14592
    ds_read_b128 v[88:91], v236 offset:16640
    v_mfma_f32_16x16x32_bf16 v[40:43], v[96:99], v[68:71], v[40:43]
    ds_read_b64_tr_b16 v[108:109], v235 offset:8192
    ds_read_b64_tr_b16 v[110:111], v235 offset:9216
    v_mfma_f32_16x16x32_bf16 v[20:23], v[100:103], v[56:59], v[20:23]
    v_mfma_f32_16x16x32_bf16 v[28:31], v[100:103], v[60:63], v[28:31]
    v_mfma_f32_16x16x32_bf16 v[36:39], v[100:103], v[64:67], v[36:39]
    v_mfma_f32_16x16x32_bf16 v[44:47], v[100:103], v[68:71], v[44:47]
    s_add_u32 m0, s59, 0
    s_nop 0
    s_mov_b32 s50, 16384
    buffer_load_dwordx4 v128, s[20:23], s50 offen offset:0 nt lds
    s_add_u32 m0, s59, 0
    s_nop 0
    s_mov_b32 s50, 16384
    buffer_load_dwordx4 v129, s[20:23], s50 offen offset:1024 nt lds
    s_add_u32 m0, s59, 0
    s_nop 0
    s_mov_b32 s50, 16384
    buffer_load_dwordx4 v130, s[20:23], s50 offen offset:2048 nt lds
    s_add_u32 m0, s59, 0
    s_nop 0
    s_mov_b32 s50, 16384
    buffer_load_dwordx4 v131, s[20:23], s50 offen offset:3072 nt lds
    s_add_u32 m0, s59, 4096
    s_mov_b32 s50, 20480
    buffer_load_dwordx4 v128, s[20:23], s50 offen offset:0 nt lds
    s_add_u32 m0, s59, 4096
    s_mov_b32 s50, 20480
    buffer_load_dwordx4 v129, s[20:23], s50 offen offset:1024 nt lds
    s_add_u32 m0, s59, 4096
    s_mov_b32 s50, 20480
    buffer_load_dwordx4 v130, s[20:23], s50 offen offset:2048 nt lds
    s_add_u32 m0, s59, 4096
    s_mov_b32 s50, 20480
    buffer_load_dwordx4 v131, s[20:23], s50 offen offset:3072 nt lds
    s_waitcnt vmcnt(24)
    s_nop 0
    v_add_u32 v234, 49152, v231
    v_add_u32 v235, 49152, v232
    v_add_u32 v236, 116736, v233
    s_waitcnt lgkmcnt(0)
    s_barrier
    v_mfma_f32_16x16x32_bf16 v[16:19], v[104:107], v[76:79], v[16:19]
    ds_read_b64_tr_b16 v[96:97], v234 offset:0
    ds_read_b64_tr_b16 v[98:99], v234 offset:1024
    v_mfma_f32_16x16x32_bf16 v[24:27], v[104:107], v[80:83], v[24:27]
    ds_read_b128 v[56:59], v236 offset:10240
    ds_read_b128 v[60:63], v236 offset:12288
    v_mfma_f32_16x16x32_bf16 v[32:35], v[104:107], v[84:87], v[32:35]
    ds_read_b128 v[64:67], v236 offset:14336
    ds_read_b128 v[68:71], v236 offset:16384
    v_mfma_f32_16x16x32_bf16 v[40:43], v[104:107], v[88:91], v[40:43]
    ds_read_b64_tr_b16 v[100:101], v235 offset:0
    ds_read_b64_tr_b16 v[102:103], v235 offset:1024
    v_mfma_f32_16x16x32_bf16 v[20:23], v[108:111], v[76:79], v[20:23]
    v_mfma_f32_16x16x32_bf16 v[28:31], v[108:111], v[80:83], v[28:31]
    v_mfma_f32_16x16x32_bf16 v[36:39], v[108:111], v[84:87], v[36:39]
    v_mfma_f32_16x16x32_bf16 v[44:47], v[108:111], v[88:91], v[44:47]
    s_waitcnt lgkmcnt(0)
    s_nop 0
    v_mfma_f32_16x16x32_bf16 v[16:19], v[96:99], v[56:59], v[16:19]
    ds_read_b64_tr_b16 v[104:105], v234 offset:8192
    ds_read_b64_tr_b16 v[106:107], v234 offset:9216
    v_mfma_f32_16x16x32_bf16 v[24:27], v[96:99], v[60:63], v[24:27]
    ds_read_b128 v[76:79], v236 offset:10496
    ds_read_b128 v[80:83], v236 offset:12544
    v_mfma_f32_16x16x32_bf16 v[32:35], v[96:99], v[64:67], v[32:35]
    ds_read_b128 v[84:87], v236 offset:14592
    ds_read_b128 v[88:91], v236 offset:16640
    v_mfma_f32_16x16x32_bf16 v[40:43], v[96:99], v[68:71], v[40:43]
    ds_read_b64_tr_b16 v[108:109], v235 offset:8192
    ds_read_b64_tr_b16 v[110:111], v235 offset:9216
    v_mfma_f32_16x16x32_bf16 v[20:23], v[100:103], v[56:59], v[20:23]
    v_mfma_f32_16x16x32_bf16 v[28:31], v[100:103], v[60:63], v[28:31]
    v_mfma_f32_16x16x32_bf16 v[36:39], v[100:103], v[64:67], v[36:39]
    v_mfma_f32_16x16x32_bf16 v[44:47], v[100:103], v[68:71], v[44:47]
    s_add_u32 m0, s59, 8192
    s_mov_b32 s50, 24576
    buffer_load_dwordx4 v132, s[20:23], s50 offen offset:0 nt lds
    s_add_u32 m0, s59, 8192
    s_mov_b32 s50, 24576
    buffer_load_dwordx4 v133, s[20:23], s50 offen offset:1024 nt lds
    s_add_u32 m0, s59, 8192
    s_mov_b32 s50, 24576
    buffer_load_dwordx4 v134, s[20:23], s50 offen offset:2048 nt lds
    s_add_u32 m0, s59, 8192
    s_mov_b32 s50, 24576
    buffer_load_dwordx4 v135, s[20:23], s50 offen offset:3072 nt lds
    s_add_u32 m0, s59, 12288
    s_mov_b32 s50, 28672
    buffer_load_dwordx4 v132, s[20:23], s50 offen offset:0 nt lds
    s_add_u32 m0, s59, 12288
    s_mov_b32 s50, 28672
    buffer_load_dwordx4 v133, s[20:23], s50 offen offset:1024 nt lds
    s_add_u32 m0, s59, 12288
    s_mov_b32 s50, 28672
    buffer_load_dwordx4 v134, s[20:23], s50 offen offset:2048 nt lds
    s_add_u32 m0, s59, 12288
    s_mov_b32 s50, 28672
    buffer_load_dwordx4 v135, s[20:23], s50 offen offset:3072 nt lds
    s_waitcnt lgkmcnt(5)
    s_nop 0
    v_mfma_f32_16x16x32_bf16 v[16:19], v[104:107], v[76:79], v[16:19]
    s_waitcnt lgkmcnt(4)
    s_nop 0
    v_mfma_f32_16x16x32_bf16 v[24:27], v[104:107], v[80:83], v[24:27]
    s_waitcnt lgkmcnt(3)
    s_nop 0
    v_mfma_f32_16x16x32_bf16 v[32:35], v[104:107], v[84:87], v[32:35]
    s_waitcnt lgkmcnt(2)
    s_nop 0
    v_mfma_f32_16x16x32_bf16 v[40:43], v[104:107], v[88:91], v[40:43]
    s_waitcnt lgkmcnt(0)
    s_nop 0
    v_mfma_f32_16x16x32_bf16 v[20:23], v[108:111], v[76:79], v[20:23]
    v_mfma_f32_16x16x32_bf16 v[28:31], v[108:111], v[80:83], v[28:31]
    v_mfma_f32_16x16x32_bf16 v[36:39], v[108:111], v[84:87], v[36:39]
    v_mfma_f32_16x16x32_bf16 v[44:47], v[108:111], v[88:91], v[44:47]
    s_and_b32 s60, s36, 3
    s_lshl_b32 s60, s60, 10
    v_lshlrev_b32 v236, 4, v12
    v_add_u32 v236, s60, v236
    v_add_u32 v234, 135168, v236
    v_add_u32 v235, 32768, v236
    v_pk_mul_f32 v[16:17], v[16:17], v[238:239]
    v_pk_mul_f32 v[18:19], v[18:19], v[238:239]
    v_pk_mul_f32 v[20:21], v[20:21], v[238:239]
    v_pk_mul_f32 v[22:23], v[22:23], v[238:239]
    v_cvt_pk_bf16_f32 v16, v16, v17
    v_cvt_pk_bf16_f32 v17, v18, v19
    v_cvt_pk_bf16_f32 v18, v20, v21
    v_cvt_pk_bf16_f32 v19, v22, v23
    v_pk_mul_f32 v[24:25], v[24:25], v[238:239]
    v_pk_mul_f32 v[26:27], v[26:27], v[238:239]
    v_pk_mul_f32 v[28:29], v[28:29], v[238:239]
    v_pk_mul_f32 v[30:31], v[30:31], v[238:239]
    v_cvt_pk_bf16_f32 v24, v24, v25
    v_cvt_pk_bf16_f32 v25, v26, v27
    v_cvt_pk_bf16_f32 v26, v28, v29
    v_cvt_pk_bf16_f32 v27, v30, v31
    v_pk_mul_f32 v[32:33], v[32:33], v[238:239]
    v_pk_mul_f32 v[34:35], v[34:35], v[238:239]
    v_pk_mul_f32 v[36:37], v[36:37], v[238:239]
    v_pk_mul_f32 v[38:39], v[38:39], v[238:239]
    v_cvt_pk_bf16_f32 v32, v32, v33
    v_cvt_pk_bf16_f32 v33, v34, v35
    v_cvt_pk_bf16_f32 v34, v36, v37
    v_cvt_pk_bf16_f32 v35, v38, v39
    v_pk_mul_f32 v[40:41], v[40:41], v[238:239]
    v_pk_mul_f32 v[42:43], v[42:43], v[238:239]
    v_pk_mul_f32 v[44:45], v[44:45], v[238:239]
    v_pk_mul_f32 v[46:47], v[46:47], v[238:239]
    v_cvt_pk_bf16_f32 v40, v40, v41
    v_cvt_pk_bf16_f32 v41, v42, v43
    v_cvt_pk_bf16_f32 v42, v44, v45
    v_cvt_pk_bf16_f32 v43, v46, v47
    v_permlane16_swap_b32 v16, v18
    v_permlane16_swap_b32 v17, v19
    v_permlane16_swap_b32 v24, v26
    v_permlane16_swap_b32 v25, v27
    v_permlane16_swap_b32 v32, v34
    v_permlane16_swap_b32 v33, v35
    v_permlane16_swap_b32 v40, v42
    v_permlane16_swap_b32 v41, v43
    ds_write_b128 v234, v[16:19] offset:20480
    ds_write_b128 v235, v[24:27] offset:0
    ds_write_b128 v235, v[32:35] offset:4096
    ds_write_b128 v235, v[40:43] offset:8192
    s_setprio 0
    s_waitcnt lgkmcnt(0)
    s_barrier
    v_lshlrev_b32 v136, 7, v14
    v_lshlrev_b32 v146, 7, v12
    s_lshl_b32 s42, s37, 4
    v_mov_b32 v137, s42
    s_and_b32 s44, s36, 1
    v_lshrrev_b32_e64 v9, 5, v12
    v_lshl_add_u32 v4, v15, 13, v4
    v_lshl_add_u32 v4, v9, 15, v4
    s_lshl_b32 s42, s38, 9
    s_lshl_b32 s43, s44, 7
    s_add_u32 s42, s42, s43
    s_nop 0
    s_add_u32 s42, s42, 256
    v_add_u32_e64 v4, s42, v4
    v_add_u32 v5, 64512, v4
    v_xor_b32_e64 v5, 32, v5
    v_add_u32 v6, 129024, v4
    v_add_u32 v7, 129024, v5
    s_mul_i32 s58, s44, 12288
    s_add_u32 s58, s58, 135168
    v_add_u32 v2, s58, v2
    v_xor_b32 v3, 32, v2
    s_lshl_b32 s42, s44, 5
    v_xor_b32 v8, s42, v8
    v_xor_b32 v9, 32, v8
    s_mul_i32 s61, s44, 9
    v_mov_b32 v10, 0x3e0293ee
    v_mov_b32 v11, 0x3e0293ee
    s_waitcnt vmcnt(16)
    s_barrier
    s_add_u32 m0, s59, 32768
    s_mov_b32 s50, 32768
    s_waitcnt vmcnt(13)
    s_nop 0
    buffer_load_dwordx4 v128, s[20:23], s50 offen offset:0 nt lds
    s_add_u32 m0, s59, 32768
    s_mov_b32 s50, 32768
    s_waitcnt vmcnt(13)
    s_nop 0
    buffer_load_dwordx4 v129, s[20:23], s50 offen offset:1024 nt lds
    s_add_u32 m0, s59, 32768
    s_mov_b32 s50, 32768
    s_waitcnt vmcnt(13)
    s_nop 0
    buffer_load_dwordx4 v130, s[20:23], s50 offen offset:2048 nt lds
    s_add_u32 s44, s41, 6
    s_and_b32 s44, s44, 7
    s_lshl_b32 s43, s44, 19
    s_add_u32 s43, s43, 0
    s_add_u32 m0, s58, 0
    s_nop 0
    buffer_load_dwordx4 v4, s[8:11], s43 offen offset:0 lds
    buffer_load_dwordx4 v5, s[8:11], s43 offen offset:1024 lds
    buffer_load_dwordx4 v6, s[8:11], s43 offen offset:2048 lds
    buffer_load_dwordx4 v7, s[8:11], s43 offen offset:3072 lds
    s_add_u32 s44, s41, 6
    s_and_b32 s44, s44, 7
    s_lshl_b32 s43, s44, 19
    s_nop 0
    s_add_u32 s43, s43, 262144
    s_add_u32 m0, s58, 4096
    s_nop 0
    s_nop 0
    buffer_load_dwordx4 v4, s[8:11], s43 offen offset:0 lds
    buffer_load_dwordx4 v5, s[8:11], s43 offen offset:1024 lds
    buffer_load_dwordx4 v6, s[8:11], s43 offen offset:2048 lds
    buffer_load_dwordx4 v7, s[8:11], s43 offen offset:3072 lds
    s_add_u32 s44, s41, 7
    s_and_b32 s44, s44, 7
    s_lshl_b32 s43, s44, 19
    s_add_u32 s43, s43, 0
    s_add_u32 m0, s58, 8192
    s_nop 0
    s_nop 0
    buffer_load_dwordx4 v4, s[8:11], s43 offen offset:0 lds
    buffer_load_dwordx4 v5, s[8:11], s43 offen offset:1024 lds
    buffer_load_dwordx4 v6, s[8:11], s43 offen offset:2048 lds
    buffer_load_dwordx4 v7, s[8:11], s43 offen offset:3072 lds
    s_add_u32 m0, s59, 32768
    s_mov_b32 s50, 32768
    s_waitcnt vmcnt(25)
    s_nop 0
    buffer_load_dwordx4 v131, s[20:23], s50 offen offset:3072 nt lds
    s_add_u32 m0, s59, 36864
    s_mov_b32 s50, 36864
    s_waitcnt vmcnt(25)
    s_nop 0
    buffer_load_dwordx4 v128, s[20:23], s50 offen offset:0 nt lds
    s_add_u32 m0, s59, 36864
    s_mov_b32 s50, 36864
    s_waitcnt vmcnt(25)
    s_nop 0
    buffer_load_dwordx4 v129, s[20:23], s50 offen offset:1024 nt lds
    s_add_u32 m0, s59, 36864
    s_mov_b32 s50, 36864
    s_waitcnt vmcnt(25)
    s_nop 0
    buffer_load_dwordx4 v130, s[20:23], s50 offen offset:2048 nt lds
    s_add_u32 m0, s59, 36864
    s_mov_b32 s50, 36864
    s_waitcnt vmcnt(25)
    s_nop 0
    buffer_load_dwordx4 v131, s[20:23], s50 offen offset:3072 nt lds
    s_add_u32 m0, s59, 40960
    s_mov_b32 s50, 40960
    s_waitcnt vmcnt(25)
    s_nop 0
    buffer_load_dwordx4 v132, s[20:23], s50 offen offset:0 nt lds
    s_add_u32 m0, s59, 40960
    s_mov_b32 s50, 40960
    s_waitcnt vmcnt(25)
    s_nop 0
    buffer_load_dwordx4 v133, s[20:23], s50 offen offset:1024 nt lds
    s_add_u32 m0, s59, 40960
    s_mov_b32 s50, 40960
    s_waitcnt vmcnt(25)
    s_nop 0
    buffer_load_dwordx4 v134, s[20:23], s50 offen offset:2048 nt lds
    s_add_u32 m0, s59, 40960
    s_mov_b32 s50, 40960
    s_waitcnt vmcnt(25)
    s_nop 0
    buffer_load_dwordx4 v135, s[20:23], s50 offen offset:3072 nt lds
    s_add_u32 m0, s59, 45056
    s_mov_b32 s50, 45056
    s_waitcnt vmcnt(25)
    s_nop 0
    buffer_load_dwordx4 v132, s[20:23], s50 offen offset:0 nt lds
    s_add_u32 m0, s59, 45056
    s_mov_b32 s50, 45056
    s_waitcnt vmcnt(25)
    s_nop 0
    buffer_load_dwordx4 v133, s[20:23], s50 offen offset:1024 nt lds
    s_add_u32 m0, s59, 45056
    s_mov_b32 s50, 45056
    s_waitcnt vmcnt(25)
    s_nop 0
    buffer_load_dwordx4 v134, s[20:23], s50 offen offset:2048 nt lds
    s_add_u32 m0, s59, 45056
    s_mov_b32 s50, 45056
    s_waitcnt vmcnt(25)
    s_nop 0
    buffer_load_dwordx4 v135, s[20:23], s50 offen offset:3072 nt lds
    s_lshl_b32 s42, s38, 3
    s_add_u32 s42, s42, s36
    s_cmp_lg_u32 s42, 6
    s_cbranch_scc1 L_nosnap
    buffer_load_dword v139, v136, s[4:7], 0 offen sc1
L_nosnap:
    s_barrier
    s_nop 0
    s_add_u32 m0, s59, 65536
    s_mov_b32 s50, 49152
    s_waitcnt vmcnt(25)
    s_nop 0
    buffer_load_dwordx4 v128, s[20:23], s50 offen offset:0 nt lds
    s_add_u32 m0, s59, 65536
    s_mov_b32 s50, 49152
    s_waitcnt vmcnt(13)
    s_nop 0
    buffer_load_dwordx4 v129, s[20:23], s50 offen offset:1024 nt lds
    s_add_u32 m0, s59, 65536
    s_mov_b32 s50, 49152
    s_waitcnt vmcnt(13)
    s_nop 0
    buffer_load_dwordx4 v130, s[20:23], s50 offen offset:2048 nt lds
    ds_read_b64_tr_b16 v[156:157], v2 offset:0
    ds_read_b64_tr_b16 v[158:159], v2 offset:512
    ds_read_b64_tr_b16 v[160:161], v3 offset:0
    ds_read_b64_tr_b16 v[162:163], v3 offset:512
    ds_read_b64_tr_b16 v[164:165], v2 offset:256
    ds_read_b64_tr_b16 v[166:167], v2 offset:768
    ds_read_b64_tr_b16 v[168:169], v3 offset:256
    ds_read_b64_tr_b16 v[170:171], v3 offset:768
    ds_read_b128 v[208:211], v1 offset:0
    ds_read_b128 v[212:215], v1 offset:2048
    ds_read_b128 v[216:219], v1 offset:4096
    ds_read_b128 v[220:223], v1 offset:6144
    ds_read_b128 v[224:227], v1 offset:8192
    ds_read_b128 v[228:231], v1 offset:10240
    ds_read_b128 v[232:235], v1 offset:12288
    ds_read_b128 v[236:239], v1 offset:14336
    ds_read_b128 v[240:243], v1 offset:16384
    s_add_u32 m0, s59, 65536
    s_mov_b32 s50, 49152
    s_waitcnt vmcnt(13)
    s_nop 0
    buffer_load_dwordx4 v131, s[20:23], s50 offen offset:3072 nt lds
    s_add_u32 m0, s59, 69632
    s_mov_b32 s50, 53248
    s_waitcnt vmcnt(13)
    s_nop 0
    buffer_load_dwordx4 v128, s[20:23], s50 offen offset:0 nt lds
    s_waitcnt lgkmcnt(9)
    s_add_u32 s44, s41, 7
    s_and_b32 s44, s44, 7
    s_lshl_b32 s43, s44, 19
    s_add_u32 s43, s43, 262144
    s_add_u32 m0, s58, 0
    s_nop 0
    buffer_load_dwordx4 v4, s[8:11], s43 offen offset:0 lds
    buffer_load_dwordx4 v5, s[8:11], s43 offen offset:1024 lds
    buffer_load_dwordx4 v6, s[8:11], s43 offen offset:2048 lds
    buffer_load_dwordx4 v7, s[8:11], s43 offen offset:3072 lds
    s_waitcnt lgkmcnt(0)
    s_nop 0
    v_mfma_f32_16x16x32_bf16 v[16:19], v[156:159], v[208:211], 0
    s_add_u32 m0, s59, 69632
    s_mov_b32 s50, 53248
    s_waitcnt vmcnt(17)
    s_nop 0
    buffer_load_dwordx4 v129, s[20:23], s50 offen offset:1024 nt lds
    v_mfma_f32_16x16x32_bf16 v[20:23], v[160:163], v[208:211], 0
    v_mfma_f32_16x16x32_bf16 v[24:27], v[164:167], v[208:211], 0
    v_mfma_f32_16x16x32_bf16 v[28:31], v[168:171], v[208:211], 0
    ds_read_b128 v[208:211], v1 offset:256
    v_mfma_f32_16x16x32_bf16 v[32:35], v[156:159], v[212:215], 0
    v_mfma_f32_16x16x32_bf16 v[36:39], v[160:163], v[212:215], 0
    v_mfma_f32_16x16x32_bf16 v[40:43], v[164:167], v[212:215], 0
    v_mfma_f32_16x16x32_bf16 v[44:47], v[168:171], v[212:215], 0
    ds_read_b128 v[212:215], v1 offset:2304
    v_mfma_f32_16x16x32_bf16 v[48:51], v[156:159], v[216:219], 0
    v_mfma_f32_16x16x32_bf16 v[52:55], v[160:163], v[216:219], 0
    s_add_u32 m0, s59, 69632
    s_mov_b32 s50, 53248
    s_waitcnt vmcnt(17)
    s_nop 0
    buffer_load_dwordx4 v130, s[20:23], s50 offen offset:2048 nt lds
    v_mfma_f32_16x16x32_bf16 v[56:59], v[164:167], v[216:219], 0
    v_mfma_f32_16x16x32_bf16 v[60:63], v[168:171], v[216:219], 0
    ds_read_b128 v[216:219], v1 offset:4352
    v_mfma_f32_16x16x32_bf16 v[64:67], v[156:159], v[220:223], 0
    v_mfma_f32_16x16x32_bf16 v[68:71], v[160:163], v[220:223], 0
    v_mfma_f32_16x16x32_bf16 v[72:75], v[164:167], v[220:223], 0
    v_mfma_f32_16x16x32_bf16 v[76:79], v[168:171], v[220:223], 0
    ds_read_b128 v[220:223], v1 offset:6400
    v_mfma_f32_16x16x32_bf16 v[80:83], v[156:159], v[224:227], 0
    ds_read_b64_tr_b16 v[172:173], v2 offset:4096
    ds_read_b64_tr_b16 v[174:175], v2 offset:4608
    ds_read_b64_tr_b16 v[244:245], v3 offset:4096
    ds_read_b64_tr_b16 v[246:247], v3 offset:4608
    ds_read_b64_tr_b16 v[248:249], v2 offset:4352
    ds_read_b64_tr_b16 v[250:251], v2 offset:4864
    ds_read_b64_tr_b16 v[252:253], v3 offset:4352
    ds_read_b64_tr_b16 v[254:255], v3 offset:4864
    v_mfma_f32_16x16x32_bf16 v[84:87], v[160:163], v[224:227], 0
    v_mfma_f32_16x16x32_bf16 v[88:91], v[164:167], v[224:227], 0
    s_add_u32 m0, s59, 69632
    s_mov_b32 s50, 53248
    s_waitcnt vmcnt(17)
    s_nop 0
    buffer_load_dwordx4 v131, s[20:23], s50 offen offset:3072 nt lds
    v_mfma_f32_16x16x32_bf16 v[92:95], v[168:171], v[224:227], 0
    ds_read_b128 v[224:227], v1 offset:8448
    v_mfma_f32_16x16x32_bf16 v[96:99], v[156:159], v[228:231], 0
    v_mfma_f32_16x16x32_bf16 v[100:103], v[160:163], v[228:231], 0
    v_mfma_f32_16x16x32_bf16 v[104:107], v[164:167], v[228:231], 0
    v_mfma_f32_16x16x32_bf16 v[108:111], v[168:171], v[228:231], 0
    ds_read_b128 v[228:231], v1 offset:10496
    v_mfma_f32_16x16x32_bf16 v[112:115], v[156:159], v[232:235], 0
    v_mfma_f32_16x16x32_bf16 v[116:119], v[160:163], v[232:235], 0
    v_mfma_f32_16x16x32_bf16 v[120:123], v[164:167], v[232:235], 0
    v_mfma_f32_16x16x32_bf16 v[124:127], v[168:171], v[232:235], 0
    ds_read_b128 v[232:235], v1 offset:12544
    s_add_u32 m0, s59, 73728
    s_mov_b32 s50, 57344
    s_waitcnt vmcnt(17)
    s_nop 0
    buffer_load_dwordx4 v132, s[20:23], s50 offen offset:0 nt lds
    v_mfma_f32_16x16x32_bf16 v[176:179], v[156:159], v[236:239], 0
    v_mfma_f32_16x16x32_bf16 v[180:183], v[160:163], v[236:239], 0
    v_mfma_f32_16x16x32_bf16 v[184:187], v[164:167], v[236:239], 0
    v_mfma_f32_16x16x32_bf16 v[188:191], v[168:171], v[236:239], 0
    ds_read_b128 v[236:239], v1 offset:14592
    v_mfma_f32_16x16x32_bf16 v[192:195], v[156:159], v[240:243], 0
    v_mfma_f32_16x16x32_bf16 v[196:199], v[160:163], v[240:243], 0
    v_mfma_f32_16x16x32_bf16 v[200:203], v[164:167], v[240:243], 0
    v_mfma_f32_16x16x32_bf16 v[204:207], v[168:171], v[240:243], 0
    ds_read_b128 v[240:243], v1 offset:16640
    s_waitcnt lgkmcnt(5)
    s_add_u32 s44, s41, 0
    s_and_b32 s44, s44, 7
    s_lshl_b32 s43, s44, 19
    s_add_u32 s43, s43, 0
    s_nop 0
    s_add_u32 m0, s58, 4096
    s_nop 0
    s_nop 0
    buffer_load_dwordx4 v4, s[8:11], s43 offen offset:0 lds
    buffer_load_dwordx4 v5, s[8:11], s43 offen offset:1024 lds
    buffer_load_dwordx4 v6, s[8:11], s43 offen offset:2048 lds
    buffer_load_dwordx4 v7, s[8:11], s43 offen offset:3072 lds
    v_mfma_f32_16x16x32_bf16 v[16:19], v[172:175], v[208:211], v[16:19]
    s_add_u32 m0, s59, 73728
    s_mov_b32 s50, 57344
    s_waitcnt vmcnt(21)
    s_nop 0
    buffer_load_dwordx4 v133, s[20:23], s50 offen offset:1024 nt lds
    v_mfma_f32_16x16x32_bf16 v[20:23], v[244:247], v[208:211], v[20:23]
    v_mfma_f32_16x16x32_bf16 v[24:27], v[248:251], v[208:211], v[24:27]
    v_mfma_f32_16x16x32_bf16 v[28:31], v[252:255], v[208:211], v[28:31]
    v_mfma_f32_16x16x32_bf16 v[32:35], v[172:175], v[212:215], v[32:35]
    v_mfma_f32_16x16x32_bf16 v[36:39], v[244:247], v[212:215], v[36:39]
    v_mfma_f32_16x16x32_bf16 v[40:43], v[248:251], v[212:215], v[40:43]
    s_add_u32 m0, s59, 73728
    s_mov_b32 s50, 57344
    s_waitcnt vmcnt(21)
    s_nop 0
    buffer_load_dwordx4 v134, s[20:23], s50 offen offset:2048 nt lds
    v_mfma_f32_16x16x32_bf16 v[44:47], v[252:255], v[212:215], v[44:47]
    v_mfma_f32_16x16x32_bf16 v[48:51], v[172:175], v[216:219], v[48:51]
    v_mfma_f32_16x16x32_bf16 v[52:55], v[244:247], v[216:219], v[52:55]
    v_mfma_f32_16x16x32_bf16 v[56:59], v[248:251], v[216:219], v[56:59]
    v_mfma_f32_16x16x32_bf16 v[60:63], v[252:255], v[216:219], v[60:63]
    s_add_u32 m0, s59, 73728
    s_mov_b32 s50, 57344
    s_waitcnt vmcnt(21)
    s_nop 0
    buffer_load_dwordx4 v135, s[20:23], s50 offen offset:3072 nt lds
    v_mfma_f32_16x16x32_bf16 v[64:67], v[172:175], v[220:223], v[64:67]
    v_mfma_f32_16x16x32_bf16 v[68:71], v[244:247], v[220:223], v[68:71]
    v_mfma_f32_16x16x32_bf16 v[72:75], v[248:251], v[220:223], v[72:75]
    v_mfma_f32_16x16x32_bf16 v[76:79], v[252:255], v[220:223], v[76:79]
    s_waitcnt lgkmcnt(4)
    s_nop 0
    v_mfma_f32_16x16x32_bf16 v[80:83], v[172:175], v[224:227], v[80:83]
    s_add_u32 m0, s59, 77824
    s_mov_b32 s50, 61440
    s_waitcnt vmcnt(21)
    s_nop 0
    buffer_load_dwordx4 v132, s[20:23], s50 offen offset:0 nt lds
    v_mfma_f32_16x16x32_bf16 v[84:87], v[244:247], v[224:227], v[84:87]
    v_mfma_f32_16x16x32_bf16 v[88:91], v[248:251], v[224:227], v[88:91]
    v_mfma_f32_16x16x32_bf16 v[92:95], v[252:255], v[224:227], v[92:95]
    s_waitcnt lgkmcnt(3)
    s_nop 0
    v_mfma_f32_16x16x32_bf16 v[96:99], v[172:175], v[228:231], v[96:99]
    v_mfma_f32_16x16x32_bf16 v[100:103], v[244:247], v[228:231], v[100:103]
    s_add_u32 m0, s59, 77824
    s_mov_b32 s50, 61440
    s_waitcnt vmcnt(21)
    s_nop 0
    buffer_load_dwordx4 v133, s[20:23], s50 offen offset:1024 nt lds
    v_mfma_f32_16x16x32_bf16 v[104:107], v[248:251], v[228:231], v[104:107]
    v_mfma_f32_16x16x32_bf16 v[108:111], v[252:255], v[228:231], v[108:111]
    s_waitcnt lgkmcnt(2)
    s_nop 0
    v_mfma_f32_16x16x32_bf16 v[112:115], v[172:175], v[232:235], v[112:115]
    v_mfma_f32_16x16x32_bf16 v[116:119], v[244:247], v[232:235], v[116:119]
    v_mfma_f32_16x16x32_bf16 v[120:123], v[248:251], v[232:235], v[120:123]
    s_add_u32 m0, s59, 77824
    s_mov_b32 s50, 61440
    s_waitcnt vmcnt(21)
    s_nop 0
    buffer_load_dwordx4 v134, s[20:23], s50 offen offset:2048 nt lds
    v_mfma_f32_16x16x32_bf16 v[124:127], v[252:255], v[232:235], v[124:127]
    s_waitcnt lgkmcnt(1)
    s_nop 0
    v_mfma_f32_16x16x32_bf16 v[176:179], v[172:175], v[236:239], v[176:179]
    v_mfma_f32_16x16x32_bf16 v[180:183], v[244:247], v[236:239], v[180:183]
    v_mfma_f32_16x16x32_bf16 v[184:187], v[248:251], v[236:239], v[184:187]
    v_mfma_f32_16x16x32_bf16 v[188:191], v[252:255], v[236:239], v[188:191]
    s_add_u32 m0, s59, 77824
    s_mov_b32 s50, 61440
    s_waitcnt vmcnt(21)
    s_nop 0
    buffer_load_dwordx4 v135, s[20:23], s50 offen offset:3072 nt lds
    s_waitcnt lgkmcnt(0)
    s_nop 0
    v_mfma_f32_16x16x32_bf16 v[192:195], v[172:175], v[240:243], v[192:195]
    v_mfma_f32_16x16x32_bf16 v[196:199], v[244:247], v[240:243], v[196:199]
    v_mfma_f32_16x16x32_bf16 v[200:203], v[248:251], v[240:243], v[200:203]
    v_mfma_f32_16x16x32_bf16 v[204:207], v[252:255], v[240:243], v[204:207]
    s_barrier
    s_add_u32 m0, s59, 0
    s_mov_b32 s50, 65536
    s_waitcnt vmcnt(21)
    s_nop 0
    buffer_load_dwordx4 v128, s[20:23], s50 offen offset:0 nt lds
    s_add_u32 m0, s59, 0
    s_nop 0
    s_mov_b32 s50, 65536
    s_waitcnt vmcnt(21)
    s_nop 0
    buffer_load_dwordx4 v129, s[20:23], s50 offen offset:1024 nt lds
    s_add_u32 m0, s59, 0
    s_nop 0
    s_mov_b32 s50, 65536
    s_waitcnt vmcnt(21)
    s_nop 0
    buffer_load_dwordx4 v130, s[20:23], s50 offen offset:2048 nt lds
    s_add_u32 s44, s41, 0
    s_and_b32 s44, s44, 7
    s_lshl_b32 s44, s44, 7
    s_lshl_b32 s43, s61, 13
    s_add_u32 s44, s44, s43
    s_lshl_b32 s63, s61, 10
    s_add_u32 m0, s63, 98304
    s_add_u32 s43, s44, 0
    s_nop 0
    buffer_load_dwordx4 v8, s[12:15], s43 offen lds
    s_add_u32 m0, s63, 99328
    s_add_u32 s43, s44, 8192
    buffer_load_dwordx4 v9, s[12:15], s43 offen lds
    s_add_u32 m0, s63, 100352
    s_add_u32 s43, s44, 16384
    buffer_load_dwordx4 v8, s[12:15], s43 offen lds
    s_add_u32 m0, s63, 101376
    s_add_u32 s43, s44, 24576
    buffer_load_dwordx4 v9, s[12:15], s43 offen lds
    s_add_u32 m0, s63, 102400
    s_add_u32 s43, s44, 32768
    buffer_load_dwordx4 v8, s[12:15], s43 offen lds
    s_add_u32 m0, s63, 103424
    s_add_u32 s43, s44, 40960
    buffer_load_dwordx4 v9, s[12:15], s43 offen lds
    s_add_u32 m0, s63, 104448
    s_add_u32 s43, s44, 49152
    buffer_load_dwordx4 v8, s[12:15], s43 offen lds
    s_add_u32 m0, s63, 105472
    s_add_u32 s43, s44, 57344
    buffer_load_dwordx4 v9, s[12:15], s43 offen lds
    s_add_u32 m0, s63, 106496
    s_add_u32 s43, s44, 65536
    buffer_load_dwordx4 v8, s[12:15], s43 offen lds
    ds_read_b64_tr_b16 v[156:157], v2 offset:8192
    ds_read_b64_tr_b16 v[158:159], v2 offset:8704
    ds_read_b64_tr_b16 v[160:161], v3 offset:8192
    ds_read_b64_tr_b16 v[162:163], v3 offset:8704
    ds_read_b64_tr_b16 v[164:165], v2 offset:8448
    ds_read_b64_tr_b16 v[166:167], v2 offset:8960
    ds_read_b64_tr_b16 v[168:169], v3 offset:8448
    ds_read_b64_tr_b16 v[170:171], v3 offset:8960
    ds_read_b128 v[208:211], v1 offset:18432
    ds_read_b128 v[212:215], v1 offset:20480
    ds_read_b128 v[216:219], v1 offset:22528
    ds_read_b128 v[220:223], v1 offset:24576
    ds_read_b128 v[224:227], v1 offset:26624
    ds_read_b128 v[228:231], v1 offset:28672
    ds_read_b128 v[232:235], v1 offset:30720
    ds_read_b128 v[236:239], v1 offset:32768
    ds_read_b128 v[240:243], v1 offset:34816
    s_add_u32 m0, s59, 0
    s_nop 0
    s_mov_b32 s50, 65536
    s_waitcnt vmcnt(26)
    s_nop 0
    buffer_load_dwordx4 v131, s[20:23], s50 offen offset:3072 nt lds
    s_add_u32 m0, s59, 4096
    s_mov_b32 s50, 69632
    s_waitcnt vmcnt(26)
    s_nop 0
    buffer_load_dwordx4 v128, s[20:23], s50 offen offset:0 nt lds
    s_waitcnt lgkmcnt(9)
    s_add_u32 s44, s41, 0
    s_and_b32 s44, s44, 7
    s_lshl_b32 s43, s44, 19
    s_add_u32 s43, s43, 262144
    s_add_u32 m0, s58, 8192
    s_nop 0
    s_nop 0
    buffer_load_dwordx4 v4, s[8:11], s43 offen offset:0 lds
    buffer_load_dwordx4 v5, s[8:11], s43 offen offset:1024 lds
    buffer_load_dwordx4 v6, s[8:11], s43 offen offset:2048 lds
    buffer_load_dwordx4 v7, s[8:11], s43 offen offset:3072 lds
    s_waitcnt lgkmcnt(0)
    s_nop 0
    v_mfma_f32_16x16x32_bf16 v[16:19], v[156:159], v[208:211], v[16:19]
    s_add_u32 m0, s59, 4096
    s_mov_b32 s50, 69632
    s_waitcnt vmcnt(30)
    s_nop 0
    buffer_load_dwordx4 v129, s[20:23], s50 offen offset:1024 nt lds
    v_mfma_f32_16x16x32_bf16 v[20:23], v[160:163], v[208:211], v[20:23]
    v_mfma_f32_16x16x32_bf16 v[24:27], v[164:167], v[208:211], v[24:27]
    v_mfma_f32_16x16x32_bf16 v[28:31], v[168:171], v[208:211], v[28:31]
    ds_read_b128 v[208:211], v1 offset:18688
    v_mfma_f32_16x16x32_bf16 v[32:35], v[156:159], v[212:215], v[32:35]
    v_mfma_f32_16x16x32_bf16 v[36:39], v[160:163], v[212:215], v[36:39]
    v_mfma_f32_16x16x32_bf16 v[40:43], v[164:167], v[212:215], v[40:43]
    v_mfma_f32_16x16x32_bf16 v[44:47], v[168:171], v[212:215], v[44:47]
    ds_read_b128 v[212:215], v1 offset:20736
    v_mfma_f32_16x16x32_bf16 v[48:51], v[156:159], v[216:219], v[48:51]
    v_mfma_f32_16x16x32_bf16 v[52:55], v[160:163], v[216:219], v[52:55]
    s_add_u32 m0, s59, 4096
    s_mov_b32 s50, 69632
    s_waitcnt vmcnt(30)
    s_nop 0
    buffer_load_dwordx4 v130, s[20:23], s50 offen offset:2048 nt lds
    v_mfma_f32_16x16x32_bf16 v[56:59], v[164:167], v[216:219], v[56:59]
    v_mfma_f32_16x16x32_bf16 v[60:63], v[168:171], v[216:219], v[60:63]
    ds_read_b128 v[216:219], v1 offset:22784
    v_mfma_f32_16x16x32_bf16 v[64:67], v[156:159], v[220:223], v[64:67]
    v_mfma_f32_16x16x32_bf16 v[68:71], v[160:163], v[220:223], v[68:71]
    v_mfma_f32_16x16x32_bf16 v[72:75], v[164:167], v[220:223], v[72:75]
    v_mfma_f32_16x16x32_bf16 v[76:79], v[168:171], v[220:223], v[76:79]
    ds_read_b128 v[220:223], v1 offset:24832
    v_mfma_f32_16x16x32_bf16 v[80:83], v[156:159], v[224:227], v[80:83]
    ds_read_b64_tr_b16 v[172:173], v2 offset:0
    ds_read_b64_tr_b16 v[174:175], v2 offset:512
    ds_read_b64_tr_b16 v[244:245], v3 offset:0
    ds_read_b64_tr_b16 v[246:247], v3 offset:512
    ds_read_b64_tr_b16 v[248:249], v2 offset:256
    ds_read_b64_tr_b16 v[250:251], v2 offset:768
    ds_read_b64_tr_b16 v[252:253], v3 offset:256
    ds_read_b64_tr_b16 v[254:255], v3 offset:768
    v_mfma_f32_16x16x32_bf16 v[84:87], v[160:163], v[224:227], v[84:87]
    v_mfma_f32_16x16x32_bf16 v[88:91], v[164:167], v[224:227], v[88:91]
    s_add_u32 m0, s59, 4096
    s_mov_b32 s50, 69632
    s_waitcnt vmcnt(26)
    s_nop 0
    buffer_load_dwordx4 v131, s[20:23], s50 offen offset:3072 nt lds
    v_mfma_f32_16x16x32_bf16 v[92:95], v[168:171], v[224:227], v[92:95]
    ds_read_b128 v[224:227], v1 offset:26880
    v_mfma_f32_16x16x32_bf16 v[96:99], v[156:159], v[228:231], v[96:99]
    v_mfma_f32_16x16x32_bf16 v[100:103], v[160:163], v[228:231], v[100:103]
    v_mfma_f32_16x16x32_bf16 v[104:107], v[164:167], v[228:231], v[104:107]
    v_mfma_f32_16x16x32_bf16 v[108:111], v[168:171], v[228:231], v[108:111]
    ds_read_b128 v[228:231], v1 offset:28928
    v_mfma_f32_16x16x32_bf16 v[112:115], v[156:159], v[232:235], v[112:115]
    v_mfma_f32_16x16x32_bf16 v[116:119], v[160:163], v[232:235], v[116:119]
    v_mfma_f32_16x16x32_bf16 v[120:123], v[164:167], v[232:235], v[120:123]
    v_mfma_f32_16x16x32_bf16 v[124:127], v[168:171], v[232:235], v[124:127]
    ds_read_b128 v[232:235], v1 offset:30976
    s_add_u32 m0, s59, 8192
    s_mov_b32 s50, 73728
    s_waitcnt vmcnt(26)
    s_nop 0
    buffer_load_dwordx4 v132, s[20:23], s50 offen offset:0 nt lds
    v_mfma_f32_16x16x32_bf16 v[176:179], v[156:159], v[236:239], v[176:179]
    v_mfma_f32_16x16x32_bf16 v[180:183], v[160:163], v[236:239], v[180:183]
    v_mfma_f32_16x16x32_bf16 v[184:187], v[164:167], v[236:239], v[184:187]
    v_mfma_f32_16x16x32_bf16 v[188:191], v[168:171], v[236:239], v[188:191]
    ds_read_b128 v[236:239], v1 offset:33024
    v_mfma_f32_16x16x32_bf16 v[192:195], v[156:159], v[240:243], v[192:195]
    v_mfma_f32_16x16x32_bf16 v[196:199], v[160:163], v[240:243], v[196:199]
    v_mfma_f32_16x16x32_bf16 v[200:203], v[164:167], v[240:243], v[200:203]
    v_mfma_f32_16x16x32_bf16 v[204:207], v[168:171], v[240:243], v[204:207]
    ds_read_b128 v[240:243], v1 offset:35072
    s_waitcnt lgkmcnt(5)
    s_add_u32 s44, s41, 1
    s_and_b32 s44, s44, 7
    s_lshl_b32 s43, s44, 19
    s_add_u32 s43, s43, 0
    s_add_u32 m0, s58, 0
    s_nop 0
    s_nop 0
    buffer_load_dwordx4 v4, s[8:11], s43 offen offset:0 lds
    buffer_load_dwordx4 v5, s[8:11], s43 offen offset:1024 lds
    buffer_load_dwordx4 v6, s[8:11], s43 offen offset:2048 lds
    buffer_load_dwordx4 v7, s[8:11], s43 offen offset:3072 lds
    v_mfma_f32_16x16x32_bf16 v[16:19], v[172:175], v[208:211], v[16:19]
    s_add_u32 m0, s59, 8192
    s_mov_b32 s50, 73728
    s_waitcnt vmcnt(30)
    s_nop 0
    buffer_load_dwordx4 v133, s[20:23], s50 offen offset:1024 nt lds
    v_mfma_f32_16x16x32_bf16 v[20:23], v[244:247], v[208:211], v[20:23]
    v_mfma_f32_16x16x32_bf16 v[24:27], v[248:251], v[208:211], v[24:27]
    v_mfma_f32_16x16x32_bf16 v[28:31], v[252:255], v[208:211], v[28:31]
    v_mfma_f32_16x16x32_bf16 v[32:35], v[172:175], v[212:215], v[32:35]
    v_mfma_f32_16x16x32_bf16 v[36:39], v[244:247], v[212:215], v[36:39]
    v_mfma_f32_16x16x32_bf16 v[40:43], v[248:251], v[212:215], v[40:43]
    s_add_u32 m0, s59, 8192
    s_mov_b32 s50, 73728
    s_waitcnt vmcnt(30)
    s_nop 0
    buffer_load_dwordx4 v134, s[20:23], s50 offen offset:2048 nt lds
    v_mfma_f32_16x16x32_bf16 v[44:47], v[252:255], v[212:215], v[44:47]
    v_mfma_f32_16x16x32_bf16 v[48:51], v[172:175], v[216:219], v[48:51]
    v_mfma_f32_16x16x32_bf16 v[52:55], v[244:247], v[216:219], v[52:55]
    v_mfma_f32_16x16x32_bf16 v[56:59], v[248:251], v[216:219], v[56:59]
    v_mfma_f32_16x16x32_bf16 v[60:63], v[252:255], v[216:219], v[60:63]
    s_add_u32 m0, s59, 8192
    s_mov_b32 s50, 73728
    s_waitcnt vmcnt(30)
    s_nop 0
    buffer_load_dwordx4 v135, s[20:23], s50 offen offset:3072 nt lds
    v_mfma_f32_16x16x32_bf16 v[64:67], v[172:175], v[220:223], v[64:67]
    v_mfma_f32_16x16x32_bf16 v[68:71], v[244:247], v[220:223], v[68:71]
    v_mfma_f32_16x16x32_bf16 v[72:75], v[248:251], v[220:223], v[72:75]
    v_mfma_f32_16x16x32_bf16 v[76:79], v[252:255], v[220:223], v[76:79]
    s_waitcnt lgkmcnt(4)
    s_nop 0
    v_mfma_f32_16x16x32_bf16 v[80:83], v[172:175], v[224:227], v[80:83]
    s_add_u32 m0, s59, 12288
    s_mov_b32 s50, 77824
    s_waitcnt vmcnt(30)
    s_nop 0
    buffer_load_dwordx4 v132, s[20:23], s50 offen offset:0 nt lds
    v_mfma_f32_16x16x32_bf16 v[84:87], v[244:247], v[224:227], v[84:87]
    v_mfma_f32_16x16x32_bf16 v[88:91], v[248:251], v[224:227], v[88:91]
    v_mfma_f32_16x16x32_bf16 v[92:95], v[252:255], v[224:227], v[92:95]
    s_waitcnt lgkmcnt(3)
    s_nop 0
    v_mfma_f32_16x16x32_bf16 v[96:99], v[172:175], v[228:231], v[96:99]
    v_mfma_f32_16x16x32_bf16 v[100:103], v[244:247], v[228:231], v[100:103]
    s_add_u32 m0, s59, 12288
    s_mov_b32 s50, 77824
    s_waitcnt vmcnt(30)
    s_nop 0
    buffer_load_dwordx4 v133, s[20:23], s50 offen offset:1024 nt lds
    v_mfma_f32_16x16x32_bf16 v[104:107], v[248:251], v[228:231], v[104:107]
    v_mfma_f32_16x16x32_bf16 v[108:111], v[252:255], v[228:231], v[108:111]
    s_waitcnt lgkmcnt(2)
    s_nop 0
    v_mfma_f32_16x16x32_bf16 v[112:115], v[172:175], v[232:235], v[112:115]
    v_mfma_f32_16x16x32_bf16 v[116:119], v[244:247], v[232:235], v[116:119]
    v_mfma_f32_16x16x32_bf16 v[120:123], v[248:251], v[232:235], v[120:123]
    s_add_u32 m0, s59, 12288
    s_mov_b32 s50, 77824
    s_waitcnt vmcnt(30)
    s_nop 0
    buffer_load_dwordx4 v134, s[20:23], s50 offen offset:2048 nt lds
    v_mfma_f32_16x16x32_bf16 v[124:127], v[252:255], v[232:235], v[124:127]
    s_waitcnt lgkmcnt(1)
    s_nop 0
    v_mfma_f32_16x16x32_bf16 v[176:179], v[172:175], v[236:239], v[176:179]
    v_mfma_f32_16x16x32_bf16 v[180:183], v[244:247], v[236:239], v[180:183]
    v_mfma_f32_16x16x32_bf16 v[184:187], v[248:251], v[236:239], v[184:187]
    v_mfma_f32_16x16x32_bf16 v[188:191], v[252:255], v[236:239], v[188:191]
    s_add_u32 m0, s59, 12288
    s_mov_b32 s50, 77824
    s_waitcnt vmcnt(30)
    s_nop 0
    buffer_load_dwordx4 v135, s[20:23], s50 offen offset:3072 nt lds
    s_waitcnt lgkmcnt(0)
    s_nop 0
    v_mfma_f32_16x16x32_bf16 v[192:195], v[172:175], v[240:243], v[192:195]
    v_mfma_f32_16x16x32_bf16 v[196:199], v[244:247], v[240:243], v[196:199]
    v_mfma_f32_16x16x32_bf16 v[200:203], v[248:251], v[240:243], v[200:203]
    v_mfma_f32_16x16x32_bf16 v[204:207], v[252:255], v[240:243], v[204:207]
    s_waitcnt vmcnt(21)
    s_barrier
    s_add_u32 m0, s59, 32768
    s_mov_b32 s50, 81920
    buffer_load_dwordx4 v128, s[20:23], s50 offen offset:0 nt lds
    s_add_u32 m0, s59, 32768
    s_mov_b32 s50, 81920
    s_waitcnt vmcnt(21)
    s_nop 0
    buffer_load_dwordx4 v129, s[20:23], s50 offen offset:1024 nt lds
    s_add_u32 m0, s59, 32768
    s_mov_b32 s50, 81920
    s_waitcnt vmcnt(21)
    s_nop 0
    buffer_load_dwordx4 v130, s[20:23], s50 offen offset:2048 nt lds
    s_add_u32 s44, s41, 1
    s_and_b32 s44, s44, 7
    s_lshl_b32 s44, s44, 7
    s_lshl_b32 s43, s61, 13
    s_add_u32 s44, s44, s43
    s_lshl_b32 s63, s61, 10
    s_add_u32 m0, s63, 116736
    s_add_u32 s43, s44, 0
    s_nop 0
    buffer_load_dwordx4 v8, s[12:15], s43 offen lds
    s_add_u32 m0, s63, 117760
    s_add_u32 s43, s44, 8192
    buffer_load_dwordx4 v9, s[12:15], s43 offen lds
    s_add_u32 m0, s63, 118784
    s_add_u32 s43, s44, 16384
    buffer_load_dwordx4 v8, s[12:15], s43 offen lds
    s_add_u32 m0, s63, 119808
    s_add_u32 s43, s44, 24576
    buffer_load_dwordx4 v9, s[12:15], s43 offen lds
    s_add_u32 m0, s63, 120832
    s_add_u32 s43, s44, 32768
    buffer_load_dwordx4 v8, s[12:15], s43 offen lds
    s_add_u32 m0, s63, 121856
    s_add_u32 s43, s44, 40960
    buffer_load_dwordx4 v9, s[12:15], s43 offen lds
    s_add_u32 m0, s63, 122880
    s_add_u32 s43, s44, 49152
    buffer_load_dwordx4 v8, s[12:15], s43 offen lds
    s_add_u32 m0, s63, 123904
    s_add_u32 s43, s44, 57344
    buffer_load_dwordx4 v9, s[12:15], s43 offen lds
    s_add_u32 m0, s63, 124928
    s_add_u32 s43, s44, 65536
    buffer_load_dwordx4 v8, s[12:15], s43 offen lds
    ds_read_b64_tr_b16 v[156:157], v2 offset:4096
    ds_read_b64_tr_b16 v[158:159], v2 offset:4608
    ds_read_b64_tr_b16 v[160:161], v3 offset:4096
    ds_read_b64_tr_b16 v[162:163], v3 offset:4608
    ds_read_b64_tr_b16 v[164:165], v2 offset:4352
    ds_read_b64_tr_b16 v[166:167], v2 offset:4864
    ds_read_b64_tr_b16 v[168:169], v3 offset:4352
    ds_read_b64_tr_b16 v[170:171], v3 offset:4864
    ds_read_b128 v[208:211], v1 offset:0
    ds_read_b128 v[212:215], v1 offset:2048
    ds_read_b128 v[216:219], v1 offset:4096
    ds_read_b128 v[220:223], v1 offset:6144
    ds_read_b128 v[224:227], v1 offset:8192
    ds_read_b128 v[228:231], v1 offset:10240
    ds_read_b128 v[232:235], v1 offset:12288
    ds_read_b128 v[236:239], v1 offset:14336
    ds_read_b128 v[240:243], v1 offset:16384
    s_add_u32 m0, s59, 32768
    s_mov_b32 s50, 81920
    s_waitcnt vmcnt(26)
    s_nop 0
    buffer_load_dwordx4 v131, s[20:23], s50 offen offset:3072 nt lds
    s_add_u32 m0, s59, 36864
    s_mov_b32 s50, 86016
    s_waitcnt vmcnt(26)
    s_nop 0
    buffer_load_dwordx4 v128, s[20:23], s50 offen offset:0 nt lds
    s_waitcnt lgkmcnt(9)
    s_add_u32 s44, s41, 1
    s_and_b32 s44, s44, 7
    s_lshl_b32 s43, s44, 19
    s_add_u32 s43, s43, 262144
    s_add_u32 m0, s58, 4096
    s_nop 0
    s_nop 0
    buffer_load_dwordx4 v4, s[8:11], s43 offen offset:0 lds
    buffer_load_dwordx4 v5, s[8:11], s43 offen offset:1024 lds
    buffer_load_dwordx4 v6, s[8:11], s43 offen offset:2048 lds
    buffer_load_dwordx4 v7, s[8:11], s43 offen offset:3072 lds
    s_waitcnt lgkmcnt(0)
    s_nop 0
    v_mfma_f32_16x16x32_bf16 v[16:19], v[156:159], v[208:211], v[16:19]
    s_add_u32 m0, s59, 36864
    s_mov_b32 s50, 86016
    s_waitcnt vmcnt(30)
    s_nop 0
    buffer_load_dwordx4 v129, s[20:23], s50 offen offset:1024 nt lds
    v_mfma_f32_16x16x32_bf16 v[20:23], v[160:163], v[208:211], v[20:23]
    v_mfma_f32_16x16x32_bf16 v[24:27], v[164:167], v[208:211], v[24:27]
    v_mfma_f32_16x16x32_bf16 v[28:31], v[168:171], v[208:211], v[28:31]
    v_mfma_f32_16x16x32_bf16 v[32:35], v[156:159], v[212:215], v[32:35]
    s_add_u32 m0, s59, 36864
    s_mov_b32 s50, 86016
    s_waitcnt vmcnt(30)
    s_nop 0
    buffer_load_dwordx4 v130, s[20:23], s50 offen offset:2048 nt lds
    v_mfma_f32_16x16x32_bf16 v[36:39], v[160:163], v[212:215], v[36:39]
    v_mfma_f32_16x16x32_bf16 v[40:43], v[164:167], v[212:215], v[40:43]
    v_mfma_f32_16x16x32_bf16 v[44:47], v[168:171], v[212:215], v[44:47]
    s_add_u32 m0, s59, 36864
    s_mov_b32 s50, 86016
    s_waitcnt vmcnt(26)
    s_nop 0
    buffer_load_dwordx4 v131, s[20:23], s50 offen offset:3072 nt lds
    v_mfma_f32_16x16x32_bf16 v[48:51], v[156:159], v[216:219], v[48:51]
    v_mfma_f32_16x16x32_bf16 v[52:55], v[160:163], v[216:219], v[52:55]
    v_mfma_f32_16x16x32_bf16 v[56:59], v[164:167], v[216:219], v[56:59]
    s_add_u32 m0, s59, 40960
    s_mov_b32 s50, 90112
    s_waitcnt vmcnt(26)
    s_nop 0
    buffer_load_dwordx4 v132, s[20:23], s50 offen offset:0 nt lds
    v_mfma_f32_16x16x32_bf16 v[60:63], v[168:171], v[216:219], v[60:63]
    v_mfma_f32_16x16x32_bf16 v[64:67], v[156:159], v[220:223], v[64:67]
    v_mfma_f32_16x16x32_bf16 v[68:71], v[160:163], v[220:223], v[68:71]
    v_mfma_f32_16x16x32_bf16 v[72:75], v[164:167], v[220:223], v[72:75]
    s_add_u32 m0, s59, 40960
    s_mov_b32 s50, 90112
    s_waitcnt vmcnt(26)
    s_nop 0
    buffer_load_dwordx4 v133, s[20:23], s50 offen offset:1024 nt lds
    v_mfma_f32_16x16x32_bf16 v[76:79], v[168:171], v[220:223], v[76:79]
    v_mfma_f32_16x16x32_bf16 v[80:83], v[156:159], v[224:227], v[80:83]
    v_mfma_f32_16x16x32_bf16 v[84:87], v[160:163], v[224:227], v[84:87]
    s_add_u32 m0, s59, 40960
    s_mov_b32 s50, 90112
    s_waitcnt vmcnt(26)
    s_nop 0
    buffer_load_dwordx4 v134, s[20:23], s50 offen offset:2048 nt lds
    v_mfma_f32_16x16x32_bf16 v[88:91], v[164:167], v[224:227], v[88:91]
    v_mfma_f32_16x16x32_bf16 v[92:95], v[168:171], v[224:227], v[92:95]
    v_mfma_f32_16x16x32_bf16 v[96:99], v[156:159], v[228:231], v[96:99]
    s_add_u32 m0, s59, 40960
    s_mov_b32 s50, 90112
    s_waitcnt vmcnt(26)
    s_nop 0
    buffer_load_dwordx4 v135, s[20:23], s50 offen offset:3072 nt lds
    v_mfma_f32_16x16x32_bf16 v[100:103], v[160:163], v[228:231], v[100:103]
    v_mfma_f32_16x16x32_bf16 v[104:107], v[164:167], v[228:231], v[104:107]
    v_mfma_f32_16x16x32_bf16 v[108:111], v[168:171], v[228:231], v[108:111]
    s_add_u32 m0, s59, 45056
    s_mov_b32 s50, 94208
    s_waitcnt vmcnt(26)
    s_nop 0
    buffer_load_dwordx4 v132, s[20:23], s50 offen offset:0 nt lds
    v_mfma_f32_16x16x32_bf16 v[112:115], v[156:159], v[232:235], v[112:115]
    v_mfma_f32_16x16x32_bf16 v[116:119], v[160:163], v[232:235], v[116:119]
    v_mfma_f32_16x16x32_bf16 v[120:123], v[164:167], v[232:235], v[120:123]
    v_mfma_f32_16x16x32_bf16 v[124:127], v[168:171], v[232:235], v[124:127]
    s_add_u32 m0, s59, 45056
    s_mov_b32 s50, 94208
    s_waitcnt vmcnt(26)
    s_nop 0
    buffer_load_dwordx4 v133, s[20:23], s50 offen offset:1024 nt lds
    v_mfma_f32_16x16x32_bf16 v[176:179], v[156:159], v[236:239], v[176:179]
    v_mfma_f32_16x16x32_bf16 v[180:183], v[160:163], v[236:239], v[180:183]
    v_mfma_f32_16x16x32_bf16 v[184:187], v[164:167], v[236:239], v[184:187]
    s_add_u32 m0, s59, 45056
    s_mov_b32 s50, 94208
    s_waitcnt vmcnt(26)
    s_nop 0
    buffer_load_dwordx4 v134, s[20:23], s50 offen offset:2048 nt lds
    v_mfma_f32_16x16x32_bf16 v[188:191], v[168:171], v[236:239], v[188:191]
    v_mfma_f32_16x16x32_bf16 v[192:195], v[156:159], v[240:243], v[192:195]
    v_mfma_f32_16x16x32_bf16 v[196:199], v[160:163], v[240:243], v[196:199]
    s_add_u32 m0, s59, 45056
    s_mov_b32 s50, 94208
    s_waitcnt vmcnt(26)
    s_nop 0
    buffer_load_dwordx4 v135, s[20:23], s50 offen offset:3072 nt lds
    v_mfma_f32_16x16x32_bf16 v[200:203], v[164:167], v[240:243], v[200:203]
    v_mfma_f32_16x16x32_bf16 v[204:207], v[168:171], v[240:243], v[204:207]
    s_lshl_b32 s42, s38, 3
    s_add_u32 s42, s42, s36
    s_cmp_lg_u32 s42, 6
    s_cbranch_scc1 L_nolead
    v_lshrrev_b32 v139, v14, v139
    v_and_b32 v139, 1, v139
    v_cmp_eq_u32 vcc, 0, v139
    s_nop 1
    s_and_b32 s42, vcc_lo, 0xffff
    s_or_b32 s42, s42, 0x80000000
    v_mov_b32_e64 v139, s42
    buffer_store_dword v139, v137, s[32:35], 0 offen sc1
L_nolead:
    s_barrier
    s_nop 0
    s_add_u32 m0, s59, 65536
    s_mov_b32 s50, 98304
    s_waitcnt vmcnt(26)
    s_nop 0
    buffer_load_dwordx4 v128, s[20:23], s50 offen offset:0 nt lds
    s_add_u32 m0, s59, 65536
    s_mov_b32 s50, 98304
    s_waitcnt vmcnt(17)
    s_nop 0
    buffer_load_dwordx4 v129, s[20:23], s50 offen offset:1024 nt lds
    s_add_u32 m0, s59, 65536
    s_mov_b32 s50, 98304
    s_waitcnt vmcnt(17)
    s_nop 0
    buffer_load_dwordx4 v130, s[20:23], s50 offen offset:2048 nt lds
    ds_read_b64_tr_b16 v[156:157], v2 offset:8192
    ds_read_b64_tr_b16 v[158:159], v2 offset:8704
    ds_read_b64_tr_b16 v[160:161], v3 offset:8192
    ds_read_b64_tr_b16 v[162:163], v3 offset:8704
    ds_read_b64_tr_b16 v[164:165], v2 offset:8448
    ds_read_b64_tr_b16 v[166:167], v2 offset:8960
    ds_read_b64_tr_b16 v[168:169], v3 offset:8448
    ds_read_b64_tr_b16 v[170:171], v3 offset:8960
    ds_read_b128 v[208:211], v1 offset:256
    ds_read_b128 v[212:215], v1 offset:2304
    ds_read_b128 v[216:219], v1 offset:4352
    ds_read_b128 v[220:223], v1 offset:6400
    ds_read_b128 v[224:227], v1 offset:8448
    ds_read_b128 v[228:231], v1 offset:10496
    ds_read_b128 v[232:235], v1 offset:12544
    ds_read_b128 v[236:239], v1 offset:14592
    ds_read_b128 v[240:243], v1 offset:16640
    s_add_u32 m0, s59, 65536
    s_mov_b32 s50, 98304
    s_waitcnt vmcnt(13)
    s_nop 0
    buffer_load_dwordx4 v131, s[20:23], s50 offen offset:3072 nt lds
    s_add_u32 m0, s59, 69632
    s_mov_b32 s50, 102400
    s_waitcnt vmcnt(13)
    s_nop 0
    buffer_load_dwordx4 v128, s[20:23], s50 offen offset:0 nt lds
    s_waitcnt lgkmcnt(9)
    s_add_u32 s44, s41, 2
    s_and_b32 s44, s44, 7
    s_lshl_b32 s43, s44, 19
    s_add_u32 s43, s43, 0
    s_nop 0
    s_add_u32 m0, s58, 8192
    s_nop 0
    s_nop 0
    buffer_load_dwordx4 v4, s[8:11], s43 offen offset:0 lds
    buffer_load_dwordx4 v5, s[8:11], s43 offen offset:1024 lds
    buffer_load_dwordx4 v6, s[8:11], s43 offen offset:2048 lds
    buffer_load_dwordx4 v7, s[8:11], s43 offen offset:3072 lds
    s_waitcnt lgkmcnt(0)
    s_nop 0
    v_mfma_f32_16x16x32_bf16 v[16:19], v[156:159], v[208:211], v[16:19]
    s_add_u32 m0, s59, 69632
    s_mov_b32 s50, 102400
    s_waitcnt vmcnt(17)
    s_nop 0
    buffer_load_dwordx4 v129, s[20:23], s50 offen offset:1024 nt lds
    v_mfma_f32_16x16x32_bf16 v[20:23], v[160:163], v[208:211], v[20:23]
    v_mfma_f32_16x16x32_bf16 v[24:27], v[164:167], v[208:211], v[24:27]
    v_mfma_f32_16x16x32_bf16 v[28:31], v[168:171], v[208:211], v[28:31]
    v_mfma_f32_16x16x32_bf16 v[32:35], v[156:159], v[212:215], v[32:35]
    s_add_u32 m0, s59, 69632
    s_mov_b32 s50, 102400
    s_waitcnt vmcnt(17)
    s_nop 0
    buffer_load_dwordx4 v130, s[20:23], s50 offen offset:2048 nt lds
    v_mfma_f32_16x16x32_bf16 v[36:39], v[160:163], v[212:215], v[36:39]
    v_mfma_f32_16x16x32_bf16 v[40:43], v[164:167], v[212:215], v[40:43]
    v_mfma_f32_16x16x32_bf16 v[44:47], v[168:171], v[212:215], v[44:47]
    s_add_u32 m0, s59, 69632
    s_mov_b32 s50, 102400
    s_waitcnt vmcnt(17)
    s_nop 0
    buffer_load_dwordx4 v131, s[20:23], s50 offen offset:3072 nt lds
    v_mfma_f32_16x16x32_bf16 v[48:51], v[156:159], v[216:219], v[48:51]
    v_mfma_f32_16x16x32_bf16 v[52:55], v[160:163], v[216:219], v[52:55]
    v_mfma_f32_16x16x32_bf16 v[56:59], v[164:167], v[216:219], v[56:59]
    s_add_u32 m0, s59, 73728
    s_mov_b32 s50, 106496
    s_waitcnt vmcnt(17)
    s_nop 0
    buffer_load_dwordx4 v132, s[20:23], s50 offen offset:0 nt lds
    v_mfma_f32_16x16x32_bf16 v[60:63], v[168:171], v[216:219], v[60:63]
    v_mfma_f32_16x16x32_bf16 v[64:67], v[156:159], v[220:223], v[64:67]
    v_mfma_f32_16x16x32_bf16 v[68:71], v[160:163], v[220:223], v[68:71]
    v_mfma_f32_16x16x32_bf16 v[72:75], v[164:167], v[220:223], v[72:75]
    s_add_u32 m0, s59, 73728
    s_mov_b32 s50, 106496
    s_waitcnt vmcnt(17)
    s_nop 0
    buffer_load_dwordx4 v133, s[20:23], s50 offen offset:1024 nt lds
    v_mfma_f32_16x16x32_bf16 v[76:79], v[168:171], v[220:223], v[76:79]
    v_mfma_f32_16x16x32_bf16 v[80:83], v[156:159], v[224:227], v[80:83]
    v_mfma_f32_16x16x32_bf16 v[84:87], v[160:163], v[224:227], v[84:87]
    s_add_u32 m0, s59, 73728
    s_mov_b32 s50, 106496
    s_waitcnt vmcnt(17)
    s_nop 0
    buffer_load_dwordx4 v134, s[20:23], s50 offen offset:2048 nt lds
    v_mfma_f32_16x16x32_bf16 v[88:91], v[164:167], v[224:227], v[88:91]
    v_mfma_f32_16x16x32_bf16 v[92:95], v[168:171], v[224:227], v[92:95]
    v_mfma_f32_16x16x32_bf16 v[96:99], v[156:159], v[228:231], v[96:99]
    s_add_u32 m0, s59, 73728
    s_mov_b32 s50, 106496
    s_waitcnt vmcnt(17)
    s_nop 0
    buffer_load_dwordx4 v135, s[20:23], s50 offen offset:3072 nt lds
    v_mfma_f32_16x16x32_bf16 v[100:103], v[160:163], v[228:231], v[100:103]
    v_mfma_f32_16x16x32_bf16 v[104:107], v[164:167], v[228:231], v[104:107]
    v_mfma_f32_16x16x32_bf16 v[108:111], v[168:171], v[228:231], v[108:111]
    s_add_u32 m0, s59, 77824
    s_mov_b32 s50, 110592
    s_waitcnt vmcnt(17)
    s_nop 0
    buffer_load_dwordx4 v132, s[20:23], s50 offen offset:0 nt lds
    v_mfma_f32_16x16x32_bf16 v[112:115], v[156:159], v[232:235], v[112:115]
    v_mfma_f32_16x16x32_bf16 v[116:119], v[160:163], v[232:235], v[116:119]
    v_mfma_f32_16x16x32_bf16 v[120:123], v[164:167], v[232:235], v[120:123]
    v_mfma_f32_16x16x32_bf16 v[124:127], v[168:171], v[232:235], v[124:127]
    s_add_u32 m0, s59, 77824
    s_mov_b32 s50, 110592
    s_waitcnt vmcnt(17)
    s_nop 0
    buffer_load_dwordx4 v133, s[20:23], s50 offen offset:1024 nt lds
    v_mfma_f32_16x16x32_bf16 v[176:179], v[156:159], v[236:239], v[176:179]
    v_mfma_f32_16x16x32_bf16 v[180:183], v[160:163], v[236:239], v[180:183]
    v_mfma_f32_16x16x32_bf16 v[184:187], v[164:167], v[236:239], v[184:187]
    s_add_u32 m0, s59, 77824
    s_mov_b32 s50, 110592
    s_waitcnt vmcnt(17)
    s_nop 0
    buffer_load_dwordx4 v134, s[20:23], s50 offen offset:2048 nt lds
    v_mfma_f32_16x16x32_bf16 v[188:191], v[168:171], v[236:239], v[188:191]
    v_mfma_f32_16x16x32_bf16 v[192:195], v[156:159], v[240:243], v[192:195]
    v_mfma_f32_16x16x32_bf16 v[196:199], v[160:163], v[240:243], v[196:199]
    s_add_u32 m0, s59, 77824
    s_mov_b32 s50, 110592
    s_waitcnt vmcnt(17)
    s_nop 0
    buffer_load_dwordx4 v135, s[20:23], s50 offen offset:3072 nt lds
    v_mfma_f32_16x16x32_bf16 v[200:203], v[164:167], v[240:243], v[200:203]
    v_mfma_f32_16x16x32_bf16 v[204:207], v[168:171], v[240:243], v[204:207]
    s_barrier
    s_add_u32 m0, s59, 0
    s_mov_b32 s50, 114688
    s_waitcnt vmcnt(17)
    s_nop 0
    buffer_load_dwordx4 v128, s[20:23], s50 offen offset:0 nt lds
    s_add_u32 m0, s59, 0
    s_nop 0
    s_mov_b32 s50, 114688
    s_waitcnt vmcnt(17)
    s_nop 0
    buffer_load_dwordx4 v129, s[20:23], s50 offen offset:1024 nt lds
    s_add_u32 m0, s59, 0
    s_nop 0
    s_mov_b32 s50, 114688
    s_waitcnt vmcnt(17)
    s_nop 0
    buffer_load_dwordx4 v130, s[20:23], s50 offen offset:2048 nt lds
    s_add_u32 s44, s41, 2
    s_and_b32 s44, s44, 7
    s_lshl_b32 s44, s44, 7
    s_lshl_b32 s43, s61, 13
    s_add_u32 s44, s44, s43
    s_lshl_b32 s63, s61, 10
    s_add_u32 m0, s63, 98304
    s_add_u32 s43, s44, 0
    s_nop 0
    buffer_load_dwordx4 v8, s[12:15], s43 offen lds
    s_add_u32 m0, s63, 99328
    s_add_u32 s43, s44, 8192
    buffer_load_dwordx4 v9, s[12:15], s43 offen lds
    s_add_u32 m0, s63, 100352
    s_add_u32 s43, s44, 16384
    buffer_load_dwordx4 v8, s[12:15], s43 offen lds
    s_add_u32 m0, s63, 101376
    s_add_u32 s43, s44, 24576
    buffer_load_dwordx4 v9, s[12:15], s43 offen lds
    s_add_u32 m0, s63, 102400
    s_add_u32 s43, s44, 32768
    buffer_load_dwordx4 v8, s[12:15], s43 offen lds
    s_add_u32 m0, s63, 103424
    s_add_u32 s43, s44, 40960
    buffer_load_dwordx4 v9, s[12:15], s43 offen lds
    s_add_u32 m0, s63, 104448
    s_add_u32 s43, s44, 49152
    buffer_load_dwordx4 v8, s[12:15], s43 offen lds
    s_add_u32 m0, s63, 105472
    s_add_u32 s43, s44, 57344
    buffer_load_dwordx4 v9, s[12:15], s43 offen lds
    s_add_u32 m0, s63, 106496
    s_add_u32 s43, s44, 65536
    buffer_load_dwordx4 v8, s[12:15], s43 offen lds
    ds_read_b64_tr_b16 v[156:157], v2 offset:0
    ds_read_b64_tr_b16 v[158:159], v2 offset:512
    ds_read_b64_tr_b16 v[160:161], v3 offset:0
    ds_read_b64_tr_b16 v[162:163], v3 offset:512
    ds_read_b64_tr_b16 v[164:165], v2 offset:256
    ds_read_b64_tr_b16 v[166:167], v2 offset:768
    ds_read_b64_tr_b16 v[168:169], v3 offset:256
    ds_read_b64_tr_b16 v[170:171], v3 offset:768
    ds_read_b128 v[208:211], v1 offset:18432
    ds_read_b128 v[212:215], v1 offset:20480
    ds_read_b128 v[216:219], v1 offset:22528
    ds_read_b128 v[220:223], v1 offset:24576
    ds_read_b128 v[224:227], v1 offset:26624
    ds_read_b128 v[228:231], v1 offset:28672
    ds_read_b128 v[232:235], v1 offset:30720
    ds_read_b128 v[236:239], v1 offset:32768
    ds_read_b128 v[240:243], v1 offset:34816
    s_add_u32 m0, s59, 0
    s_nop 0
    s_mov_b32 s50, 114688
    s_waitcnt vmcnt(22)
    s_nop 0
    buffer_load_dwordx4 v131, s[20:23], s50 offen offset:3072 nt lds
    s_add_u32 m0, s59, 4096
    s_mov_b32 s50, 118784
    s_waitcnt vmcnt(22)
    s_nop 0
    buffer_load_dwordx4 v128, s[20:23], s50 offen offset:0 nt lds
    s_waitcnt lgkmcnt(9)
    s_add_u32 s44, s41, 2
    s_and_b32 s44, s44, 7
    s_lshl_b32 s43, s44, 19
    s_add_u32 s43, s43, 262144
    s_add_u32 m0, s58, 0
    s_nop 0
    buffer_load_dwordx4 v4, s[8:11], s43 offen offset:0 lds
    buffer_load_dwordx4 v5, s[8:11], s43 offen offset:1024 lds
    buffer_load_dwordx4 v6, s[8:11], s43 offen offset:2048 lds
    buffer_load_dwordx4 v7, s[8:11], s43 offen offset:3072 lds
    s_waitcnt lgkmcnt(0)
    s_nop 0
    v_mfma_f32_16x16x32_bf16 v[16:19], v[156:159], v[208:211], v[16:19]
    s_add_u32 m0, s59, 4096
    s_mov_b32 s50, 118784
    s_waitcnt vmcnt(26)
    s_nop 0
    buffer_load_dwordx4 v129, s[20:23], s50 offen offset:1024 nt lds
    v_mfma_f32_16x16x32_bf16 v[20:23], v[160:163], v[208:211], v[20:23]
    v_mfma_f32_16x16x32_bf16 v[24:27], v[164:167], v[208:211], v[24:27]
    v_mfma_f32_16x16x32_bf16 v[28:31], v[168:171], v[208:211], v[28:31]
    v_mfma_f32_16x16x32_bf16 v[32:35], v[156:159], v[212:215], v[32:35]
    s_add_u32 m0, s59, 4096
    s_mov_b32 s50, 118784
    s_waitcnt vmcnt(26)
    s_nop 0
    buffer_load_dwordx4 v130, s[20:23], s50 offen offset:2048 nt lds
    v_mfma_f32_16x16x32_bf16 v[36:39], v[160:163], v[212:215], v[36:39]
    v_mfma_f32_16x16x32_bf16 v[40:43], v[164:167], v[212:215], v[40:43]
    v_mfma_f32_16x16x32_bf16 v[44:47], v[168:171], v[212:215], v[44:47]
    s_add_u32 m0, s59, 4096
    s_mov_b32 s50, 118784
    s_waitcnt vmcnt(26)
    s_nop 0
    buffer_load_dwordx4 v131, s[20:23], s50 offen offset:3072 nt lds
    v_mfma_f32_16x16x32_bf16 v[48:51], v[156:159], v[216:219], v[48:51]
    v_mfma_f32_16x16x32_bf16 v[52:55], v[160:163], v[216:219], v[52:55]
    v_mfma_f32_16x16x32_bf16 v[56:59], v[164:167], v[216:219], v[56:59]
    s_add_u32 m0, s59, 8192
    s_mov_b32 s50, 122880
    s_waitcnt vmcnt(26)
    s_nop 0
    buffer_load_dwordx4 v132, s[20:23], s50 offen offset:0 nt lds
    v_mfma_f32_16x16x32_bf16 v[60:63], v[168:171], v[216:219], v[60:63]
    v_mfma_f32_16x16x32_bf16 v[64:67], v[156:159], v[220:223], v[64:67]
    v_mfma_f32_16x16x32_bf16 v[68:71], v[160:163], v[220:223], v[68:71]
    v_mfma_f32_16x16x32_bf16 v[72:75], v[164:167], v[220:223], v[72:75]
    s_add_u32 m0, s59, 8192
    s_mov_b32 s50, 122880
    s_waitcnt vmcnt(26)
    s_nop 0
    buffer_load_dwordx4 v133, s[20:23], s50 offen offset:1024 nt lds
    v_mfma_f32_16x16x32_bf16 v[76:79], v[168:171], v[220:223], v[76:79]
    v_mfma_f32_16x16x32_bf16 v[80:83], v[156:159], v[224:227], v[80:83]
    v_mfma_f32_16x16x32_bf16 v[84:87], v[160:163], v[224:227], v[84:87]
    s_add_u32 m0, s59, 8192
    s_mov_b32 s50, 122880
    s_waitcnt vmcnt(26)
    s_nop 0
    buffer_load_dwordx4 v134, s[20:23], s50 offen offset:2048 nt lds
    v_mfma_f32_16x16x32_bf16 v[88:91], v[164:167], v[224:227], v[88:91]
    v_mfma_f32_16x16x32_bf16 v[92:95], v[168:171], v[224:227], v[92:95]
    v_mfma_f32_16x16x32_bf16 v[96:99], v[156:159], v[228:231], v[96:99]
    s_add_u32 m0, s59, 8192
    s_mov_b32 s50, 122880
    s_waitcnt vmcnt(26)
    s_nop 0
    buffer_load_dwordx4 v135, s[20:23], s50 offen offset:3072 nt lds
    v_mfma_f32_16x16x32_bf16 v[100:103], v[160:163], v[228:231], v[100:103]
    v_mfma_f32_16x16x32_bf16 v[104:107], v[164:167], v[228:231], v[104:107]
    v_mfma_f32_16x16x32_bf16 v[108:111], v[168:171], v[228:231], v[108:111]
    s_add_u32 m0, s59, 12288
    s_mov_b32 s50, 126976
    s_waitcnt vmcnt(26)
    s_nop 0
    buffer_load_dwordx4 v132, s[20:23], s50 offen offset:0 nt lds
    v_mfma_f32_16x16x32_bf16 v[112:115], v[156:159], v[232:235], v[112:115]
    v_mfma_f32_16x16x32_bf16 v[116:119], v[160:163], v[232:235], v[116:119]
    v_mfma_f32_16x16x32_bf16 v[120:123], v[164:167], v[232:235], v[120:123]
    v_mfma_f32_16x16x32_bf16 v[124:127], v[168:171], v[232:235], v[124:127]
    s_add_u32 m0, s59, 12288
    s_mov_b32 s50, 126976
    s_waitcnt vmcnt(26)
    s_nop 0
    buffer_load_dwordx4 v133, s[20:23], s50 offen offset:1024 nt lds
    v_mfma_f32_16x16x32_bf16 v[176:179], v[156:159], v[236:239], v[176:179]
    v_mfma_f32_16x16x32_bf16 v[180:183], v[160:163], v[236:239], v[180:183]
    v_mfma_f32_16x16x32_bf16 v[184:187], v[164:167], v[236:239], v[184:187]
    s_add_u32 m0, s59, 12288
    s_mov_b32 s50, 126976
    s_waitcnt vmcnt(26)
    s_nop 0
    buffer_load_dwordx4 v134, s[20:23], s50 offen offset:2048 nt lds
    v_mfma_f32_16x16x32_bf16 v[188:191], v[168:171], v[236:239], v[188:191]
    v_mfma_f32_16x16x32_bf16 v[192:195], v[156:159], v[240:243], v[192:195]
    v_mfma_f32_16x16x32_bf16 v[196:199], v[160:163], v[240:243], v[196:199]
    s_add_u32 m0, s59, 12288
    s_mov_b32 s50, 126976
    s_waitcnt vmcnt(26)
    s_nop 0
    buffer_load_dwordx4 v135, s[20:23], s50 offen offset:3072 nt lds
    v_mfma_f32_16x16x32_bf16 v[200:203], v[164:167], v[240:243], v[200:203]
    v_mfma_f32_16x16x32_bf16 v[204:207], v[168:171], v[240:243], v[204:207]
    s_barrier
    s_nop 0
    s_add_u32 m0, s59, 32768
    s_mov_b32 s50, 131072
    s_waitcnt vmcnt(26)
    s_nop 0
    buffer_load_dwordx4 v128, s[20:23], s50 offen offset:0 nt lds
    s_add_u32 m0, s59, 32768
    s_mov_b32 s50, 131072
    s_waitcnt vmcnt(17)
    s_nop 0
    buffer_load_dwordx4 v129, s[20:23], s50 offen offset:1024 nt lds
    s_add_u32 m0, s59, 32768
    s_mov_b32 s50, 131072
    s_waitcnt vmcnt(17)
    s_nop 0
    buffer_load_dwordx4 v130, s[20:23], s50 offen offset:2048 nt lds
    ds_read_b64_tr_b16 v[156:157], v2 offset:4096
    ds_read_b64_tr_b16 v[158:159], v2 offset:4608
    ds_read_b64_tr_b16 v[160:161], v3 offset:4096
    ds_read_b64_tr_b16 v[162:163], v3 offset:4608
    ds_read_b64_tr_b16 v[164:165], v2 offset:4352
    ds_read_b64_tr_b16 v[166:167], v2 offset:4864
    ds_read_b64_tr_b16 v[168:169], v3 offset:4352
    ds_read_b64_tr_b16 v[170:171], v3 offset:4864
    ds_read_b128 v[208:211], v1 offset:18688
    ds_read_b128 v[212:215], v1 offset:20736
    ds_read_b128 v[216:219], v1 offset:22784
    ds_read_b128 v[220:223], v1 offset:24832
    ds_read_b128 v[224:227], v1 offset:26880
    ds_read_b128 v[228:231], v1 offset:28928
    ds_read_b128 v[232:235], v1 offset:30976
    ds_read_b128 v[236:239], v1 offset:33024
    ds_read_b128 v[240:243], v1 offset:35072
    s_add_u32 m0, s59, 32768
    s_mov_b32 s50, 131072
    s_waitcnt vmcnt(13)
    s_nop 0
    buffer_load_dwordx4 v131, s[20:23], s50 offen offset:3072 nt lds
    s_add_u32 m0, s59, 36864
    s_mov_b32 s50, 135168
    s_waitcnt vmcnt(13)
    s_nop 0
    buffer_load_dwordx4 v128, s[20:23], s50 offen offset:0 nt lds
    s_waitcnt lgkmcnt(9)
    s_add_u32 s44, s41, 3
    s_and_b32 s44, s44, 7
    s_lshl_b32 s43, s44, 19
    s_add_u32 s43, s43, 0
    s_nop 0
    s_add_u32 m0, s58, 4096
    s_nop 0
    s_nop 0
    buffer_load_dwordx4 v4, s[8:11], s43 offen offset:0 lds
    buffer_load_dwordx4 v5, s[8:11], s43 offen offset:1024 lds
    buffer_load_dwordx4 v6, s[8:11], s43 offen offset:2048 lds
    buffer_load_dwordx4 v7, s[8:11], s43 offen offset:3072 lds
    s_waitcnt lgkmcnt(0)
    s_nop 0
    v_mfma_f32_16x16x32_bf16 v[16:19], v[156:159], v[208:211], v[16:19]
    s_add_u32 m0, s59, 36864
    s_mov_b32 s50, 135168
    s_waitcnt vmcnt(17)
    s_nop 0
    buffer_load_dwordx4 v129, s[20:23], s50 offen offset:1024 nt lds
    v_mfma_f32_16x16x32_bf16 v[20:23], v[160:163], v[208:211], v[20:23]
    v_mfma_f32_16x16x32_bf16 v[24:27], v[164:167], v[208:211], v[24:27]
    v_mfma_f32_16x16x32_bf16 v[28:31], v[168:171], v[208:211], v[28:31]
    v_mfma_f32_16x16x32_bf16 v[32:35], v[156:159], v[212:215], v[32:35]
    s_add_u32 m0, s59, 36864
    s_mov_b32 s50, 135168
    s_waitcnt vmcnt(17)
    s_nop 0
    buffer_load_dwordx4 v130, s[20:23], s50 offen offset:2048 nt lds
    v_mfma_f32_16x16x32_bf16 v[36:39], v[160:163], v[212:215], v[36:39]
    v_mfma_f32_16x16x32_bf16 v[40:43], v[164:167], v[212:215], v[40:43]
    v_mfma_f32_16x16x32_bf16 v[44:47], v[168:171], v[212:215], v[44:47]
    s_add_u32 m0, s59, 36864
    s_mov_b32 s50, 135168
    s_waitcnt vmcnt(17)
    s_nop 0
    buffer_load_dwordx4 v131, s[20:23], s50 offen offset:3072 nt lds
    v_mfma_f32_16x16x32_bf16 v[48:51], v[156:159], v[216:219], v[48:51]
    v_mfma_f32_16x16x32_bf16 v[52:55], v[160:163], v[216:219], v[52:55]
    v_mfma_f32_16x16x32_bf16 v[56:59], v[164:167], v[216:219], v[56:59]
    s_add_u32 m0, s59, 40960
    s_mov_b32 s50, 139264
    s_waitcnt vmcnt(17)
    s_nop 0
    buffer_load_dwordx4 v132, s[20:23], s50 offen offset:0 nt lds
    v_mfma_f32_16x16x32_bf16 v[60:63], v[168:171], v[216:219], v[60:63]
    v_mfma_f32_16x16x32_bf16 v[64:67], v[156:159], v[220:223], v[64:67]
    v_mfma_f32_16x16x32_bf16 v[68:71], v[160:163], v[220:223], v[68:71]
    v_mfma_f32_16x16x32_bf16 v[72:75], v[164:167], v[220:223], v[72:75]
    s_add_u32 m0, s59, 40960
    s_mov_b32 s50, 139264
    s_waitcnt vmcnt(17)
    s_nop 0
    buffer_load_dwordx4 v133, s[20:23], s50 offen offset:1024 nt lds
    v_mfma_f32_16x16x32_bf16 v[76:79], v[168:171], v[220:223], v[76:79]
    v_mfma_f32_16x16x32_bf16 v[80:83], v[156:159], v[224:227], v[80:83]
    v_mfma_f32_16x16x32_bf16 v[84:87], v[160:163], v[224:227], v[84:87]
    s_add_u32 m0, s59, 40960
    s_mov_b32 s50, 139264
    s_waitcnt vmcnt(17)
    s_nop 0
    buffer_load_dwordx4 v134, s[20:23], s50 offen offset:2048 nt lds
    v_mfma_f32_16x16x32_bf16 v[88:91], v[164:167], v[224:227], v[88:91]
    v_mfma_f32_16x16x32_bf16 v[92:95], v[168:171], v[224:227], v[92:95]
    v_mfma_f32_16x16x32_bf16 v[96:99], v[156:159], v[228:231], v[96:99]
    s_add_u32 m0, s59, 40960
    s_mov_b32 s50, 139264
    s_waitcnt vmcnt(17)
    s_nop 0
    buffer_load_dwordx4 v135, s[20:23], s50 offen offset:3072 nt lds
    v_mfma_f32_16x16x32_bf16 v[100:103], v[160:163], v[228:231], v[100:103]
    v_mfma_f32_16x16x32_bf16 v[104:107], v[164:167], v[228:231], v[104:107]
    v_mfma_f32_16x16x32_bf16 v[108:111], v[168:171], v[228:231], v[108:111]
    s_add_u32 m0, s59, 45056
    s_mov_b32 s50, 143360
    s_waitcnt vmcnt(17)
    s_nop 0
    buffer_load_dwordx4 v132, s[20:23], s50 offen offset:0 nt lds
    v_mfma_f32_16x16x32_bf16 v[112:115], v[156:159], v[232:235], v[112:115]
    v_mfma_f32_16x16x32_bf16 v[116:119], v[160:163], v[232:235], v[116:119]
    v_mfma_f32_16x16x32_bf16 v[120:123], v[164:167], v[232:235], v[120:123]
    v_mfma_f32_16x16x32_bf16 v[124:127], v[168:171], v[232:235], v[124:127]
    s_add_u32 m0, s59, 45056
    s_mov_b32 s50, 143360
    s_waitcnt vmcnt(17)
    s_nop 0
    buffer_load_dwordx4 v133, s[20:23], s50 offen offset:1024 nt lds
    v_mfma_f32_16x16x32_bf16 v[176:179], v[156:159], v[236:239], v[176:179]
    v_mfma_f32_16x16x32_bf16 v[180:183], v[160:163], v[236:239], v[180:183]
    v_mfma_f32_16x16x32_bf16 v[184:187], v[164:167], v[236:239], v[184:187]
    s_add_u32 m0, s59, 45056
    s_mov_b32 s50, 143360
    s_waitcnt vmcnt(17)
    s_nop 0
    buffer_load_dwordx4 v134, s[20:23], s50 offen offset:2048 nt lds
    v_mfma_f32_16x16x32_bf16 v[188:191], v[168:171], v[236:239], v[188:191]
    v_mfma_f32_16x16x32_bf16 v[192:195], v[156:159], v[240:243], v[192:195]
    v_mfma_f32_16x16x32_bf16 v[196:199], v[160:163], v[240:243], v[196:199]
    s_add_u32 m0, s59, 45056
    s_mov_b32 s50, 143360
    s_waitcnt vmcnt(17)
    s_nop 0
    buffer_load_dwordx4 v135, s[20:23], s50 offen offset:3072 nt lds
    v_mfma_f32_16x16x32_bf16 v[200:203], v[164:167], v[240:243], v[200:203]
    v_mfma_f32_16x16x32_bf16 v[204:207], v[168:171], v[240:243], v[204:207]
    s_barrier
    s_nop 0
    s_add_u32 m0, s59, 65536
    s_mov_b32 s50, 147456
    s_waitcnt vmcnt(17)
    s_nop 0
    buffer_load_dwordx4 v128, s[20:23], s50 offen offset:0 nt lds
    s_add_u32 m0, s59, 65536
    s_mov_b32 s50, 147456
    s_waitcnt vmcnt(17)
    s_nop 0
    buffer_load_dwordx4 v129, s[20:23], s50 offen offset:1024 nt lds
    s_add_u32 m0, s59, 65536
    s_mov_b32 s50, 147456
    s_waitcnt vmcnt(17)
    s_nop 0
    buffer_load_dwordx4 v130, s[20:23], s50 offen offset:2048 nt lds
    s_add_u32 s44, s41, 3
    s_and_b32 s44, s44, 7
    s_lshl_b32 s44, s44, 7
    s_lshl_b32 s43, s61, 13
    s_add_u32 s44, s44, s43
    s_lshl_b32 s63, s61, 10
    s_add_u32 m0, s63, 116736
    s_add_u32 s43, s44, 0
    s_nop 0
    buffer_load_dwordx4 v8, s[12:15], s43 offen lds
    s_add_u32 m0, s63, 117760
    s_add_u32 s43, s44, 8192
    buffer_load_dwordx4 v9, s[12:15], s43 offen lds
    s_add_u32 m0, s63, 118784
    s_add_u32 s43, s44, 16384
    buffer_load_dwordx4 v8, s[12:15], s43 offen lds
    s_add_u32 m0, s63, 119808
    s_add_u32 s43, s44, 24576
    buffer_load_dwordx4 v9, s[12:15], s43 offen lds
    s_add_u32 m0, s63, 120832
    s_add_u32 s43, s44, 32768
    buffer_load_dwordx4 v8, s[12:15], s43 offen lds
    s_add_u32 m0, s63, 121856
    s_add_u32 s43, s44, 40960
    buffer_load_dwordx4 v9, s[12:15], s43 offen lds
    s_add_u32 m0, s63, 122880
    s_add_u32 s43, s44, 49152
    buffer_load_dwordx4 v8, s[12:15], s43 offen lds
    s_add_u32 m0, s63, 123904
    s_add_u32 s43, s44, 57344
    buffer_load_dwordx4 v9, s[12:15], s43 offen lds
    s_add_u32 m0, s63, 124928
    s_add_u32 s43, s44, 65536
    buffer_load_dwordx4 v8, s[12:15], s43 offen lds
    ds_read_b64_tr_b16 v[156:157], v2 offset:8192
    ds_read_b64_tr_b16 v[158:159], v2 offset:8704
    ds_read_b64_tr_b16 v[160:161], v3 offset:8192
    ds_read_b64_tr_b16 v[162:163], v3 offset:8704
    ds_read_b64_tr_b16 v[164:165], v2 offset:8448
    ds_read_b64_tr_b16 v[166:167], v2 offset:8960
    ds_read_b64_tr_b16 v[168:169], v3 offset:8448
    ds_read_b64_tr_b16 v[170:171], v3 offset:8960
    ds_read_b128 v[208:211], v1 offset:0
    ds_read_b128 v[212:215], v1 offset:2048
    ds_read_b128 v[216:219], v1 offset:4096
    ds_read_b128 v[220:223], v1 offset:6144
    ds_read_b128 v[224:227], v1 offset:8192
    ds_read_b128 v[228:231], v1 offset:10240
    ds_read_b128 v[232:235], v1 offset:12288
    ds_read_b128 v[236:239], v1 offset:14336
    ds_read_b128 v[240:243], v1 offset:16384
    s_add_u32 m0, s59, 65536
    s_mov_b32 s50, 147456
    s_waitcnt vmcnt(22)
    s_nop 0
    buffer_load_dwordx4 v131, s[20:23], s50 offen offset:3072 nt lds
    s_add_u32 m0, s59, 69632
    s_mov_b32 s50, 151552
    s_waitcnt vmcnt(22)
    s_nop 0
    buffer_load_dwordx4 v128, s[20:23], s50 offen offset:0 nt lds
    s_waitcnt lgkmcnt(9)
    s_add_u32 s44, s41, 3
    s_and_b32 s44, s44, 7
    s_lshl_b32 s43, s44, 19
    s_add_u32 s43, s43, 262144
    s_add_u32 m0, s58, 8192
    s_nop 0
    s_nop 0
    buffer_load_dwordx4 v4, s[8:11], s43 offen offset:0 lds
    buffer_load_dwordx4 v5, s[8:11], s43 offen offset:1024 lds
    buffer_load_dwordx4 v6, s[8:11], s43 offen offset:2048 lds
    buffer_load_dwordx4 v7, s[8:11], s43 offen offset:3072 lds
    s_waitcnt lgkmcnt(0)
    s_nop 0
    v_mfma_f32_16x16x32_bf16 v[16:19], v[156:159], v[208:211], v[16:19]
    s_add_u32 m0, s59, 69632
    s_mov_b32 s50, 151552
    s_waitcnt vmcnt(26)
    s_nop 0
    buffer_load_dwordx4 v129, s[20:23], s50 offen offset:1024 nt lds
    v_mfma_f32_16x16x32_bf16 v[20:23], v[160:163], v[208:211], v[20:23]
    v_mfma_f32_16x16x32_bf16 v[24:27], v[164:167], v[208:211], v[24:27]
    v_mfma_f32_16x16x32_bf16 v[28:31], v[168:171], v[208:211], v[28:31]
    v_mfma_f32_16x16x32_bf16 v[32:35], v[156:159], v[212:215], v[32:35]
    s_add_u32 m0, s59, 69632
    s_mov_b32 s50, 151552
    s_waitcnt vmcnt(26)
    s_nop 0
    buffer_load_dwordx4 v130, s[20:23], s50 offen offset:2048 nt lds
    v_mfma_f32_16x16x32_bf16 v[36:39], v[160:163], v[212:215], v[36:39]
    v_mfma_f32_16x16x32_bf16 v[40:43], v[164:167], v[212:215], v[40:43]
    v_mfma_f32_16x16x32_bf16 v[44:47], v[168:171], v[212:215], v[44:47]
    s_add_u32 m0, s59, 69632
    s_mov_b32 s50, 151552
    s_waitcnt vmcnt(26)
    s_nop 0
    buffer_load_dwordx4 v131, s[20:23], s50 offen offset:3072 nt lds
    v_mfma_f32_16x16x32_bf16 v[48:51], v[156:159], v[216:219], v[48:51]
    v_mfma_f32_16x16x32_bf16 v[52:55], v[160:163], v[216:219], v[52:55]
    v_mfma_f32_16x16x32_bf16 v[56:59], v[164:167], v[216:219], v[56:59]
    s_add_u32 m0, s59, 73728
    s_mov_b32 s50, 155648
    s_waitcnt vmcnt(26)
    s_nop 0
    buffer_load_dwordx4 v132, s[20:23], s50 offen offset:0 nt lds
    v_mfma_f32_16x16x32_bf16 v[60:63], v[168:171], v[216:219], v[60:63]
    v_mfma_f32_16x16x32_bf16 v[64:67], v[156:159], v[220:223], v[64:67]
    v_mfma_f32_16x16x32_bf16 v[68:71], v[160:163], v[220:223], v[68:71]
    v_mfma_f32_16x16x32_bf16 v[72:75], v[164:167], v[220:223], v[72:75]
    s_add_u32 m0, s59, 73728
    s_mov_b32 s50, 155648
    s_waitcnt vmcnt(26)
    s_nop 0
    buffer_load_dwordx4 v133, s[20:23], s50 offen offset:1024 nt lds
    v_mfma_f32_16x16x32_bf16 v[76:79], v[168:171], v[220:223], v[76:79]
    v_mfma_f32_16x16x32_bf16 v[80:83], v[156:159], v[224:227], v[80:83]
    v_mfma_f32_16x16x32_bf16 v[84:87], v[160:163], v[224:227], v[84:87]
    s_add_u32 m0, s59, 73728
    s_mov_b32 s50, 155648
    s_waitcnt vmcnt(26)
    s_nop 0
    buffer_load_dwordx4 v134, s[20:23], s50 offen offset:2048 nt lds
    v_mfma_f32_16x16x32_bf16 v[88:91], v[164:167], v[224:227], v[88:91]
    v_mfma_f32_16x16x32_bf16 v[92:95], v[168:171], v[224:227], v[92:95]
    v_mfma_f32_16x16x32_bf16 v[96:99], v[156:159], v[228:231], v[96:99]
    s_add_u32 m0, s59, 73728
    s_mov_b32 s50, 155648
    s_waitcnt vmcnt(26)
    s_nop 0
    buffer_load_dwordx4 v135, s[20:23], s50 offen offset:3072 nt lds
    v_mfma_f32_16x16x32_bf16 v[100:103], v[160:163], v[228:231], v[100:103]
    v_mfma_f32_16x16x32_bf16 v[104:107], v[164:167], v[228:231], v[104:107]
    v_mfma_f32_16x16x32_bf16 v[108:111], v[168:171], v[228:231], v[108:111]
    s_add_u32 m0, s59, 77824
    s_mov_b32 s50, 159744
    s_waitcnt vmcnt(26)
    s_nop 0
    buffer_load_dwordx4 v132, s[20:23], s50 offen offset:0 nt lds
    v_mfma_f32_16x16x32_bf16 v[112:115], v[156:159], v[232:235], v[112:115]
    v_mfma_f32_16x16x32_bf16 v[116:119], v[160:163], v[232:235], v[116:119]
    v_mfma_f32_16x16x32_bf16 v[120:123], v[164:167], v[232:235], v[120:123]
    v_mfma_f32_16x16x32_bf16 v[124:127], v[168:171], v[232:235], v[124:127]
    s_add_u32 m0, s59, 77824
    s_mov_b32 s50, 159744
    s_waitcnt vmcnt(26)
    s_nop 0
    buffer_load_dwordx4 v133, s[20:23], s50 offen offset:1024 nt lds
    v_mfma_f32_16x16x32_bf16 v[176:179], v[156:159], v[236:239], v[176:179]
    v_mfma_f32_16x16x32_bf16 v[180:183], v[160:163], v[236:239], v[180:183]
    v_mfma_f32_16x16x32_bf16 v[184:187], v[164:167], v[236:239], v[184:187]
    s_add_u32 m0, s59, 77824
    s_mov_b32 s50, 159744
    s_waitcnt vmcnt(26)
    s_nop 0
    buffer_load_dwordx4 v134, s[20:23], s50 offen offset:2048 nt lds
    v_mfma_f32_16x16x32_bf16 v[188:191], v[168:171], v[236:239], v[188:191]
    v_mfma_f32_16x16x32_bf16 v[192:195], v[156:159], v[240:243], v[192:195]
    v_mfma_f32_16x16x32_bf16 v[196:199], v[160:163], v[240:243], v[196:199]
    s_add_u32 m0, s59, 77824
    s_mov_b32 s50, 159744
    s_waitcnt vmcnt(26)
    s_nop 0
    buffer_load_dwordx4 v135, s[20:23], s50 offen offset:3072 nt lds
    v_mfma_f32_16x16x32_bf16 v[200:203], v[164:167], v[240:243], v[200:203]
    v_mfma_f32_16x16x32_bf16 v[204:207], v[168:171], v[240:243], v[204:207]
    s_barrier
    s_add_u32 m0, s59, 0
    s_mov_b32 s50, 163840
    s_waitcnt vmcnt(26)
    s_nop 0
    buffer_load_dwordx4 v128, s[20:23], s50 offen offset:0 nt lds
    s_add_u32 m0, s59, 0
    s_nop 0
    s_mov_b32 s50, 163840
    s_waitcnt vmcnt(17)
    s_nop 0
    buffer_load_dwordx4 v129, s[20:23], s50 offen offset:1024 nt lds
    s_add_u32 m0, s59, 0
    s_nop 0
    s_mov_b32 s50, 163840
    s_waitcnt vmcnt(17)
    s_nop 0
    buffer_load_dwordx4 v130, s[20:23], s50 offen offset:2048 nt lds
    ds_read_b64_tr_b16 v[156:157], v2 offset:0
    ds_read_b64_tr_b16 v[158:159], v2 offset:512
    ds_read_b64_tr_b16 v[160:161], v3 offset:0
    ds_read_b64_tr_b16 v[162:163], v3 offset:512
    ds_read_b64_tr_b16 v[164:165], v2 offset:256
    ds_read_b64_tr_b16 v[166:167], v2 offset:768
    ds_read_b64_tr_b16 v[168:169], v3 offset:256
    ds_read_b64_tr_b16 v[170:171], v3 offset:768
    ds_read_b128 v[208:211], v1 offset:256
    ds_read_b128 v[212:215], v1 offset:2304
    ds_read_b128 v[216:219], v1 offset:4352
    ds_read_b128 v[220:223], v1 offset:6400
    ds_read_b128 v[224:227], v1 offset:8448
    ds_read_b128 v[228:231], v1 offset:10496
    ds_read_b128 v[232:235], v1 offset:12544
    ds_read_b128 v[236:239], v1 offset:14592
    ds_read_b128 v[240:243], v1 offset:16640
    s_add_u32 m0, s59, 0
    s_nop 0
    s_mov_b32 s50, 163840
    s_waitcnt vmcnt(13)
    s_nop 0
    buffer_load_dwordx4 v131, s[20:23], s50 offen offset:3072 nt lds
    s_add_u32 m0, s59, 4096
    s_mov_b32 s50, 167936
    s_waitcnt vmcnt(13)
    s_nop 0
    buffer_load_dwordx4 v128, s[20:23], s50 offen offset:0 nt lds
    s_waitcnt lgkmcnt(9)
    s_add_u32 s44, s41, 4
    s_and_b32 s44, s44, 7
    s_lshl_b32 s43, s44, 19
    s_add_u32 s43, s43, 0
    s_add_u32 m0, s58, 0
    s_nop 0
    s_nop 0
    buffer_load_dwordx4 v4, s[8:11], s43 offen offset:0 lds
    buffer_load_dwordx4 v5, s[8:11], s43 offen offset:1024 lds
    buffer_load_dwordx4 v6, s[8:11], s43 offen offset:2048 lds
    buffer_load_dwordx4 v7, s[8:11], s43 offen offset:3072 lds
    s_waitcnt lgkmcnt(0)
    s_nop 0
    v_mfma_f32_16x16x32_bf16 v[16:19], v[156:159], v[208:211], v[16:19]
    s_add_u32 m0, s59, 4096
    s_mov_b32 s50, 167936
    s_waitcnt vmcnt(17)
    s_nop 0
    buffer_load_dwordx4 v129, s[20:23], s50 offen offset:1024 nt lds
    v_mfma_f32_16x16x32_bf16 v[20:23], v[160:163], v[208:211], v[20:23]
    v_mfma_f32_16x16x32_bf16 v[24:27], v[164:167], v[208:211], v[24:27]
    v_mfma_f32_16x16x32_bf16 v[28:31], v[168:171], v[208:211], v[28:31]
    v_mfma_f32_16x16x32_bf16 v[32:35], v[156:159], v[212:215], v[32:35]
    s_add_u32 m0, s59, 4096
    s_mov_b32 s50, 167936
    s_waitcnt vmcnt(17)
    s_nop 0
    buffer_load_dwordx4 v130, s[20:23], s50 offen offset:2048 nt lds
    v_mfma_f32_16x16x32_bf16 v[36:39], v[160:163], v[212:215], v[36:39]
    v_mfma_f32_16x16x32_bf16 v[40:43], v[164:167], v[212:215], v[40:43]
    v_mfma_f32_16x16x32_bf16 v[44:47], v[168:171], v[212:215], v[44:47]
    s_add_u32 m0, s59, 4096
    s_mov_b32 s50, 167936
    s_waitcnt vmcnt(17)
    s_nop 0
    buffer_load_dwordx4 v131, s[20:23], s50 offen offset:3072 nt lds
    v_mfma_f32_16x16x32_bf16 v[48:51], v[156:159], v[216:219], v[48:51]
    v_mfma_f32_16x16x32_bf16 v[52:55], v[160:163], v[216:219], v[52:55]
    v_mfma_f32_16x16x32_bf16 v[56:59], v[164:167], v[216:219], v[56:59]
    s_add_u32 m0, s59, 8192
    s_mov_b32 s50, 172032
    s_waitcnt vmcnt(17)
    s_nop 0
    buffer_load_dwordx4 v132, s[20:23], s50 offen offset:0 nt lds
    v_mfma_f32_16x16x32_bf16 v[60:63], v[168:171], v[216:219], v[60:63]
    v_mfma_f32_16x16x32_bf16 v[64:67], v[156:159], v[220:223], v[64:67]
    v_mfma_f32_16x16x32_bf16 v[68:71], v[160:163], v[220:223], v[68:71]
    v_mfma_f32_16x16x32_bf16 v[72:75], v[164:167], v[220:223], v[72:75]
    s_add_u32 m0, s59, 8192
    s_mov_b32 s50, 172032
    s_waitcnt vmcnt(17)
    s_nop 0
    buffer_load_dwordx4 v133, s[20:23], s50 offen offset:1024 nt lds
    v_mfma_f32_16x16x32_bf16 v[76:79], v[168:171], v[220:223], v[76:79]
    v_mfma_f32_16x16x32_bf16 v[80:83], v[156:159], v[224:227], v[80:83]
    v_mfma_f32_16x16x32_bf16 v[84:87], v[160:163], v[224:227], v[84:87]
    s_add_u32 m0, s59, 8192
    s_mov_b32 s50, 172032
    s_waitcnt vmcnt(17)
    s_nop 0
    buffer_load_dwordx4 v134, s[20:23], s50 offen offset:2048 nt lds
    v_mfma_f32_16x16x32_bf16 v[88:91], v[164:167], v[224:227], v[88:91]
    v_mfma_f32_16x16x32_bf16 v[92:95], v[168:171], v[224:227], v[92:95]
    v_mfma_f32_16x16x32_bf16 v[96:99], v[156:159], v[228:231], v[96:99]
    s_add_u32 m0, s59, 8192
    s_mov_b32 s50, 172032
    s_waitcnt vmcnt(17)
    s_nop 0
    buffer_load_dwordx4 v135, s[20:23], s50 offen offset:3072 nt lds
    v_mfma_f32_16x16x32_bf16 v[100:103], v[160:163], v[228:231], v[100:103]
    v_mfma_f32_16x16x32_bf16 v[104:107], v[164:167], v[228:231], v[104:107]
    v_mfma_f32_16x16x32_bf16 v[108:111], v[168:171], v[228:231], v[108:111]
    s_add_u32 m0, s59, 12288
    s_mov_b32 s50, 176128
    s_waitcnt vmcnt(17)
    s_nop 0
    buffer_load_dwordx4 v132, s[20:23], s50 offen offset:0 nt lds
    v_mfma_f32_16x16x32_bf16 v[112:115], v[156:159], v[232:235], v[112:115]
    v_mfma_f32_16x16x32_bf16 v[116:119], v[160:163], v[232:235], v[116:119]
    v_mfma_f32_16x16x32_bf16 v[120:123], v[164:167], v[232:235], v[120:123]
    v_mfma_f32_16x16x32_bf16 v[124:127], v[168:171], v[232:235], v[124:127]
    s_add_u32 m0, s59, 12288
    s_mov_b32 s50, 176128
    s_waitcnt vmcnt(17)
    s_nop 0
    buffer_load_dwordx4 v133, s[20:23], s50 offen offset:1024 nt lds
    v_mfma_f32_16x16x32_bf16 v[176:179], v[156:159], v[236:239], v[176:179]
    v_mfma_f32_16x16x32_bf16 v[180:183], v[160:163], v[236:239], v[180:183]
    v_mfma_f32_16x16x32_bf16 v[184:187], v[164:167], v[236:239], v[184:187]
    s_add_u32 m0, s59, 12288
    s_mov_b32 s50, 176128
    s_waitcnt vmcnt(17)
    s_nop 0
    buffer_load_dwordx4 v134, s[20:23], s50 offen offset:2048 nt lds
    v_mfma_f32_16x16x32_bf16 v[188:191], v[168:171], v[236:239], v[188:191]
    v_mfma_f32_16x16x32_bf16 v[192:195], v[156:159], v[240:243], v[192:195]
    v_mfma_f32_16x16x32_bf16 v[196:199], v[160:163], v[240:243], v[196:199]
    s_add_u32 m0, s59, 12288
    s_mov_b32 s50, 176128
    s_waitcnt vmcnt(17)
    s_nop 0
    buffer_load_dwordx4 v135, s[20:23], s50 offen offset:3072 nt lds
    v_mfma_f32_16x16x32_bf16 v[200:203], v[164:167], v[240:243], v[200:203]
    v_mfma_f32_16x16x32_bf16 v[204:207], v[168:171], v[240:243], v[204:207]
    s_barrier
    s_nop 0
    s_add_u32 m0, s59, 32768
    s_mov_b32 s50, 180224
    s_waitcnt vmcnt(17)
    s_nop 0
    buffer_load_dwordx4 v128, s[20:23], s50 offen offset:0 nt lds
    s_add_u32 m0, s59, 32768
    s_mov_b32 s50, 180224
    s_waitcnt vmcnt(17)
    s_nop 0
    buffer_load_dwordx4 v129, s[20:23], s50 offen offset:1024 nt lds
    s_add_u32 m0, s59, 32768
    s_mov_b32 s50, 180224
    s_waitcnt vmcnt(17)
    s_nop 0
    buffer_load_dwordx4 v130, s[20:23], s50 offen offset:2048 nt lds
    s_add_u32 s44, s41, 4
    s_and_b32 s44, s44, 7
    s_lshl_b32 s44, s44, 7
    s_lshl_b32 s43, s61, 13
    s_add_u32 s44, s44, s43
    s_lshl_b32 s63, s61, 10
    s_add_u32 m0, s63, 98304
    s_add_u32 s43, s44, 0
    s_nop 0
    buffer_load_dwordx4 v8, s[12:15], s43 offen lds
    s_add_u32 m0, s63, 99328
    s_add_u32 s43, s44, 8192
    buffer_load_dwordx4 v9, s[12:15], s43 offen lds
    s_add_u32 m0, s63, 100352
    s_add_u32 s43, s44, 16384
    buffer_load_dwordx4 v8, s[12:15], s43 offen lds
    s_add_u32 m0, s63, 101376
    s_add_u32 s43, s44, 24576
    buffer_load_dwordx4 v9, s[12:15], s43 offen lds
    s_add_u32 m0, s63, 102400
    s_add_u32 s43, s44, 32768
    buffer_load_dwordx4 v8, s[12:15], s43 offen lds
    s_add_u32 m0, s63, 103424
    s_add_u32 s43, s44, 40960
    buffer_load_dwordx4 v9, s[12:15], s43 offen lds
    s_add_u32 m0, s63, 104448
    s_add_u32 s43, s44, 49152
    buffer_load_dwordx4 v8, s[12:15], s43 offen lds
    s_add_u32 m0, s63, 105472
    s_add_u32 s43, s44, 57344
    buffer_load_dwordx4 v9, s[12:15], s43 offen lds
    s_add_u32 m0, s63, 106496
    s_add_u32 s43, s44, 65536
    buffer_load_dwordx4 v8, s[12:15], s43 offen lds
    ds_read_b64_tr_b16 v[156:157], v2 offset:4096
    ds_read_b64_tr_b16 v[158:159], v2 offset:4608
    ds_read_b64_tr_b16 v[160:161], v3 offset:4096
    ds_read_b64_tr_b16 v[162:163], v3 offset:4608
    ds_read_b64_tr_b16 v[164:165], v2 offset:4352
    ds_read_b64_tr_b16 v[166:167], v2 offset:4864
    ds_read_b64_tr_b16 v[168:169], v3 offset:4352
    ds_read_b64_tr_b16 v[170:171], v3 offset:4864
    ds_read_b128 v[208:211], v1 offset:18432
    ds_read_b128 v[212:215], v1 offset:20480
    ds_read_b128 v[216:219], v1 offset:22528
    ds_read_b128 v[220:223], v1 offset:24576
    ds_read_b128 v[224:227], v1 offset:26624
    ds_read_b128 v[228:231], v1 offset:28672
    ds_read_b128 v[232:235], v1 offset:30720
    ds_read_b128 v[236:239], v1 offset:32768
    ds_read_b128 v[240:243], v1 offset:34816
    s_add_u32 m0, s59, 32768
    s_mov_b32 s50, 180224
    s_waitcnt vmcnt(22)
    s_nop 0
    buffer_load_dwordx4 v131, s[20:23], s50 offen offset:3072 nt lds
    s_add_u32 m0, s59, 36864
    s_mov_b32 s50, 184320
    s_waitcnt vmcnt(22)
    s_nop 0
    buffer_load_dwordx4 v128, s[20:23], s50 offen offset:0 nt lds
    s_waitcnt lgkmcnt(9)
    s_add_u32 s44, s41, 4
    s_and_b32 s44, s44, 7
    s_lshl_b32 s43, s44, 19
    s_add_u32 s43, s43, 262144
    s_add_u32 m0, s58, 4096
    s_nop 0
    s_nop 0
    buffer_load_dwordx4 v4, s[8:11], s43 offen offset:0 lds
    buffer_load_dwordx4 v5, s[8:11], s43 offen offset:1024 lds
    buffer_load_dwordx4 v6, s[8:11], s43 offen offset:2048 lds
    buffer_load_dwordx4 v7, s[8:11], s43 offen offset:3072 lds
    s_waitcnt lgkmcnt(0)
    s_nop 0
    v_mfma_f32_16x16x32_bf16 v[16:19], v[156:159], v[208:211], v[16:19]
    s_add_u32 m0, s59, 36864
    s_mov_b32 s50, 184320
    s_waitcnt vmcnt(26)
    s_nop 0
    buffer_load_dwordx4 v129, s[20:23], s50 offen offset:1024 nt lds
    v_mfma_f32_16x16x32_bf16 v[20:23], v[160:163], v[208:211], v[20:23]
    v_mfma_f32_16x16x32_bf16 v[24:27], v[164:167], v[208:211], v[24:27]
    v_mfma_f32_16x16x32_bf16 v[28:31], v[168:171], v[208:211], v[28:31]
    v_mfma_f32_16x16x32_bf16 v[32:35], v[156:159], v[212:215], v[32:35]
    s_add_u32 m0, s59, 36864
    s_mov_b32 s50, 184320
    s_waitcnt vmcnt(26)
    s_nop 0
    buffer_load_dwordx4 v130, s[20:23], s50 offen offset:2048 nt lds
    v_mfma_f32_16x16x32_bf16 v[36:39], v[160:163], v[212:215], v[36:39]
    v_mfma_f32_16x16x32_bf16 v[40:43], v[164:167], v[212:215], v[40:43]
    v_mfma_f32_16x16x32_bf16 v[44:47], v[168:171], v[212:215], v[44:47]
    s_add_u32 m0, s59, 36864
    s_mov_b32 s50, 184320
    s_waitcnt vmcnt(26)
    s_nop 0
    buffer_load_dwordx4 v131, s[20:23], s50 offen offset:3072 nt lds
    v_mfma_f32_16x16x32_bf16 v[48:51], v[156:159], v[216:219], v[48:51]
    v_mfma_f32_16x16x32_bf16 v[52:55], v[160:163], v[216:219], v[52:55]
    v_mfma_f32_16x16x32_bf16 v[56:59], v[164:167], v[216:219], v[56:59]
    s_add_u32 m0, s59, 40960
    s_mov_b32 s50, 188416
    s_waitcnt vmcnt(26)
    s_nop 0
    buffer_load_dwordx4 v132, s[20:23], s50 offen offset:0 nt lds
    v_mfma_f32_16x16x32_bf16 v[60:63], v[168:171], v[216:219], v[60:63]
    v_mfma_f32_16x16x32_bf16 v[64:67], v[156:159], v[220:223], v[64:67]
    v_mfma_f32_16x16x32_bf16 v[68:71], v[160:163], v[220:223], v[68:71]
    v_mfma_f32_16x16x32_bf16 v[72:75], v[164:167], v[220:223], v[72:75]
    s_add_u32 m0, s59, 40960
    s_mov_b32 s50, 188416
    s_waitcnt vmcnt(26)
    s_nop 0
    buffer_load_dwordx4 v133, s[20:23], s50 offen offset:1024 nt lds
    v_mfma_f32_16x16x32_bf16 v[76:79], v[168:171], v[220:223], v[76:79]
    v_mfma_f32_16x16x32_bf16 v[80:83], v[156:159], v[224:227], v[80:83]
    v_mfma_f32_16x16x32_bf16 v[84:87], v[160:163], v[224:227], v[84:87]
    s_add_u32 m0, s59, 40960
    s_mov_b32 s50, 188416
    s_waitcnt vmcnt(26)
    s_nop 0
    buffer_load_dwordx4 v134, s[20:23], s50 offen offset:2048 nt lds
    v_mfma_f32_16x16x32_bf16 v[88:91], v[164:167], v[224:227], v[88:91]
    v_mfma_f32_16x16x32_bf16 v[92:95], v[168:171], v[224:227], v[92:95]
    v_mfma_f32_16x16x32_bf16 v[96:99], v[156:159], v[228:231], v[96:99]
    s_add_u32 m0, s59, 40960
    s_mov_b32 s50, 188416
    s_waitcnt vmcnt(26)
    s_nop 0
    buffer_load_dwordx4 v135, s[20:23], s50 offen offset:3072 nt lds
    v_mfma_f32_16x16x32_bf16 v[100:103], v[160:163], v[228:231], v[100:103]
    v_mfma_f32_16x16x32_bf16 v[104:107], v[164:167], v[228:231], v[104:107]
    v_mfma_f32_16x16x32_bf16 v[108:111], v[168:171], v[228:231], v[108:111]
    s_add_u32 m0, s59, 45056
    s_mov_b32 s50, 192512
    s_waitcnt vmcnt(26)
    s_nop 0
    buffer_load_dwordx4 v132, s[20:23], s50 offen offset:0 nt lds
    v_mfma_f32_16x16x32_bf16 v[112:115], v[156:159], v[232:235], v[112:115]
    v_mfma_f32_16x16x32_bf16 v[116:119], v[160:163], v[232:235], v[116:119]
    v_mfma_f32_16x16x32_bf16 v[120:123], v[164:167], v[232:235], v[120:123]
    v_mfma_f32_16x16x32_bf16 v[124:127], v[168:171], v[232:235], v[124:127]
    s_add_u32 m0, s59, 45056
    s_mov_b32 s50, 192512
    s_waitcnt vmcnt(26)
    s_nop 0
    buffer_load_dwordx4 v133, s[20:23], s50 offen offset:1024 nt lds
    v_mfma_f32_16x16x32_bf16 v[176:179], v[156:159], v[236:239], v[176:179]
    v_mfma_f32_16x16x32_bf16 v[180:183], v[160:163], v[236:239], v[180:183]
    v_mfma_f32_16x16x32_bf16 v[184:187], v[164:167], v[236:239], v[184:187]
    s_add_u32 m0, s59, 45056
    s_mov_b32 s50, 192512
    s_waitcnt vmcnt(26)
    s_nop 0
    buffer_load_dwordx4 v134, s[20:23], s50 offen offset:2048 nt lds
    v_mfma_f32_16x16x32_bf16 v[188:191], v[168:171], v[236:239], v[188:191]
    v_mfma_f32_16x16x32_bf16 v[192:195], v[156:159], v[240:243], v[192:195]
    v_mfma_f32_16x16x32_bf16 v[196:199], v[160:163], v[240:243], v[196:199]
    s_add_u32 m0, s59, 45056
    s_mov_b32 s50, 192512
    s_waitcnt vmcnt(26)
    s_nop 0
    buffer_load_dwordx4 v135, s[20:23], s50 offen offset:3072 nt lds
    v_mfma_f32_16x16x32_bf16 v[200:203], v[164:167], v[240:243], v[200:203]
    v_mfma_f32_16x16x32_bf16 v[204:207], v[168:171], v[240:243], v[204:207]
    buffer_load_dword v139, v137, s[32:35], 0 offen sc1
    s_barrier
    s_nop 0
    s_add_u32 m0, s59, 65536
    s_mov_b32 s50, 196608
    s_waitcnt vmcnt(27)
    s_nop 0
    buffer_load_dwordx4 v128, s[20:23], s50 offen offset:0 nt lds
    s_add_u32 m0, s59, 65536
    s_mov_b32 s50, 196608
    s_waitcnt vmcnt(18)
    s_nop 0
    buffer_load_dwordx4 v129, s[20:23], s50 offen offset:1024 nt lds
    s_add_u32 m0, s59, 65536
    s_mov_b32 s50, 196608
    s_waitcnt vmcnt(18)
    s_nop 0
    buffer_load_dwordx4 v130, s[20:23], s50 offen offset:2048 nt lds
    ds_read_b64_tr_b16 v[156:157], v2 offset:8192
    ds_read_b64_tr_b16 v[158:159], v2 offset:8704
    ds_read_b64_tr_b16 v[160:161], v3 offset:8192
    ds_read_b64_tr_b16 v[162:163], v3 offset:8704
    ds_read_b64_tr_b16 v[164:165], v2 offset:8448
    ds_read_b64_tr_b16 v[166:167], v2 offset:8960
    ds_read_b64_tr_b16 v[168:169], v3 offset:8448
    ds_read_b64_tr_b16 v[170:171], v3 offset:8960
    ds_read_b128 v[208:211], v1 offset:18688
    ds_read_b128 v[212:215], v1 offset:20736
    ds_read_b128 v[216:219], v1 offset:22784
    ds_read_b128 v[220:223], v1 offset:24832
    ds_read_b128 v[224:227], v1 offset:26880
    ds_read_b128 v[228:231], v1 offset:28928
    ds_read_b128 v[232:235], v1 offset:30976
    ds_read_b128 v[236:239], v1 offset:33024
    ds_read_b128 v[240:243], v1 offset:35072
    s_add_u32 m0, s59, 65536
    s_mov_b32 s50, 196608
    s_waitcnt vmcnt(14)
    s_nop 0
    buffer_load_dwordx4 v131, s[20:23], s50 offen offset:3072 nt lds
    s_add_u32 m0, s59, 69632
    s_mov_b32 s50, 200704
    s_waitcnt vmcnt(14)
    s_nop 0
    buffer_load_dwordx4 v128, s[20:23], s50 offen offset:0 nt lds
    s_waitcnt lgkmcnt(9)
    s_add_u32 s44, s41, 5
    s_and_b32 s44, s44, 7
    s_lshl_b32 s43, s44, 19
    s_add_u32 s43, s43, 0
    s_nop 0
    s_add_u32 m0, s58, 8192
    s_nop 0
    s_nop 0
    buffer_load_dwordx4 v4, s[8:11], s43 offen offset:0 lds
    buffer_load_dwordx4 v5, s[8:11], s43 offen offset:1024 lds
    buffer_load_dwordx4 v6, s[8:11], s43 offen offset:2048 lds
    buffer_load_dwordx4 v7, s[8:11], s43 offen offset:3072 lds
    s_waitcnt lgkmcnt(0)
    s_nop 0
    v_mfma_f32_16x16x32_bf16 v[16:19], v[156:159], v[208:211], v[16:19]
    s_add_u32 m0, s59, 69632
    s_mov_b32 s50, 200704
    s_waitcnt vmcnt(18)
    s_nop 0
    buffer_load_dwordx4 v129, s[20:23], s50 offen offset:1024 nt lds
    v_mfma_f32_16x16x32_bf16 v[20:23], v[160:163], v[208:211], v[20:23]
    v_mfma_f32_16x16x32_bf16 v[24:27], v[164:167], v[208:211], v[24:27]
    v_mfma_f32_16x16x32_bf16 v[28:31], v[168:171], v[208:211], v[28:31]
    v_mfma_f32_16x16x32_bf16 v[32:35], v[156:159], v[212:215], v[32:35]
    s_add_u32 m0, s59, 69632
    s_mov_b32 s50, 200704
    s_waitcnt vmcnt(18)
    s_nop 0
    buffer_load_dwordx4 v130, s[20:23], s50 offen offset:2048 nt lds
    v_mfma_f32_16x16x32_bf16 v[36:39], v[160:163], v[212:215], v[36:39]
    v_mfma_f32_16x16x32_bf16 v[40:43], v[164:167], v[212:215], v[40:43]
    v_mfma_f32_16x16x32_bf16 v[44:47], v[168:171], v[212:215], v[44:47]
    s_add_u32 m0, s59, 69632
    s_mov_b32 s50, 200704
    s_waitcnt vmcnt(18)
    s_nop 0
    buffer_load_dwordx4 v131, s[20:23], s50 offen offset:3072 nt lds
    v_mfma_f32_16x16x32_bf16 v[48:51], v[156:159], v[216:219], v[48:51]
    v_mfma_f32_16x16x32_bf16 v[52:55], v[160:163], v[216:219], v[52:55]
    v_mfma_f32_16x16x32_bf16 v[56:59], v[164:167], v[216:219], v[56:59]
    s_add_u32 m0, s59, 73728
    s_mov_b32 s50, 204800
    s_waitcnt vmcnt(18)
    s_nop 0
    buffer_load_dwordx4 v132, s[20:23], s50 offen offset:0 nt lds
    v_mfma_f32_16x16x32_bf16 v[60:63], v[168:171], v[216:219], v[60:63]
    v_mfma_f32_16x16x32_bf16 v[64:67], v[156:159], v[220:223], v[64:67]
    v_mfma_f32_16x16x32_bf16 v[68:71], v[160:163], v[220:223], v[68:71]
    v_mfma_f32_16x16x32_bf16 v[72:75], v[164:167], v[220:223], v[72:75]
    s_add_u32 m0, s59, 73728
    s_mov_b32 s50, 204800
    s_waitcnt vmcnt(18)
    s_nop 0
    buffer_load_dwordx4 v133, s[20:23], s50 offen offset:1024 nt lds
    v_mfma_f32_16x16x32_bf16 v[76:79], v[168:171], v[220:223], v[76:79]
    v_mfma_f32_16x16x32_bf16 v[80:83], v[156:159], v[224:227], v[80:83]
    v_mfma_f32_16x16x32_bf16 v[84:87], v[160:163], v[224:227], v[84:87]
    s_add_u32 m0, s59, 73728
    s_mov_b32 s50, 204800
    s_waitcnt vmcnt(18)
    s_nop 0
    buffer_load_dwordx4 v134, s[20:23], s50 offen offset:2048 nt lds
    v_mfma_f32_16x16x32_bf16 v[88:91], v[164:167], v[224:227], v[88:91]
    v_mfma_f32_16x16x32_bf16 v[92:95], v[168:171], v[224:227], v[92:95]
    v_mfma_f32_16x16x32_bf16 v[96:99], v[156:159], v[228:231], v[96:99]
    s_add_u32 m0, s59, 73728
    s_mov_b32 s50, 204800
    s_waitcnt vmcnt(18)
    s_nop 0
    buffer_load_dwordx4 v135, s[20:23], s50 offen offset:3072 nt lds
    v_mfma_f32_16x16x32_bf16 v[100:103], v[160:163], v[228:231], v[100:103]
    v_mfma_f32_16x16x32_bf16 v[104:107], v[164:167], v[228:231], v[104:107]
    v_mfma_f32_16x16x32_bf16 v[108:111], v[168:171], v[228:231], v[108:111]
    s_add_u32 m0, s59, 77824
    s_mov_b32 s50, 208896
    s_waitcnt vmcnt(18)
    s_nop 0
    buffer_load_dwordx4 v132, s[20:23], s50 offen offset:0 nt lds
    v_mfma_f32_16x16x32_bf16 v[112:115], v[156:159], v[232:235], v[112:115]
    v_mfma_f32_16x16x32_bf16 v[116:119], v[160:163], v[232:235], v[116:119]
    v_mfma_f32_16x16x32_bf16 v[120:123], v[164:167], v[232:235], v[120:123]
    v_mfma_f32_16x16x32_bf16 v[124:127], v[168:171], v[232:235], v[124:127]
    s_add_u32 m0, s59, 77824
    s_mov_b32 s50, 208896
    s_waitcnt vmcnt(18)
    s_nop 0
    buffer_load_dwordx4 v133, s[20:23], s50 offen offset:1024 nt lds
    v_mfma_f32_16x16x32_bf16 v[176:179], v[156:159], v[236:239], v[176:179]
    v_mfma_f32_16x16x32_bf16 v[180:183], v[160:163], v[236:239], v[180:183]
    v_mfma_f32_16x16x32_bf16 v[184:187], v[164:167], v[236:239], v[184:187]
    s_add_u32 m0, s59, 77824
    s_mov_b32 s50, 208896
    s_waitcnt vmcnt(17)
    s_nop 0
    buffer_load_dwordx4 v134, s[20:23], s50 offen offset:2048 nt lds
    v_mfma_f32_16x16x32_bf16 v[188:191], v[168:171], v[236:239], v[188:191]
    v_mfma_f32_16x16x32_bf16 v[192:195], v[156:159], v[240:243], v[192:195]
    v_mfma_f32_16x16x32_bf16 v[196:199], v[160:163], v[240:243], v[196:199]
    s_add_u32 m0, s59, 77824
    s_mov_b32 s50, 208896
    s_waitcnt vmcnt(17)
    s_nop 0
    buffer_load_dwordx4 v135, s[20:23], s50 offen offset:3072 nt lds
    v_mfma_f32_16x16x32_bf16 v[200:203], v[164:167], v[240:243], v[200:203]
    v_mfma_f32_16x16x32_bf16 v[204:207], v[168:171], v[240:243], v[204:207]
    s_barrier
    s_add_u32 m0, s59, 0
    s_mov_b32 s50, 212992
    s_waitcnt vmcnt(17)
    s_nop 0
    buffer_load_dwordx4 v128, s[20:23], s50 offen offset:0 nt lds
    s_add_u32 m0, s59, 0
    s_nop 0
    s_mov_b32 s50, 212992
    s_waitcnt vmcnt(17)
    s_nop 0
    buffer_load_dwordx4 v129, s[20:23], s50 offen offset:1024 nt lds
    s_add_u32 m0, s59, 0
    s_nop 0
    s_mov_b32 s50, 212992
    s_waitcnt vmcnt(17)
    s_nop 0
    buffer_load_dwordx4 v130, s[20:23], s50 offen offset:2048 nt lds
    s_add_u32 s44, s41, 5
    s_and_b32 s44, s44, 7
    s_lshl_b32 s44, s44, 7
    s_lshl_b32 s43, s61, 13
    s_add_u32 s44, s44, s43
    s_lshl_b32 s63, s61, 10
    s_add_u32 m0, s63, 116736
    s_add_u32 s43, s44, 0
    s_nop 0
    buffer_load_dwordx4 v8, s[12:15], s43 offen lds
    s_add_u32 m0, s63, 117760
    s_add_u32 s43, s44, 8192
    buffer_load_dwordx4 v9, s[12:15], s43 offen lds
    s_add_u32 m0, s63, 118784
    s_add_u32 s43, s44, 16384
    buffer_load_dwordx4 v8, s[12:15], s43 offen lds
    s_add_u32 m0, s63, 119808
    s_add_u32 s43, s44, 24576
    buffer_load_dwordx4 v9, s[12:15], s43 offen lds
    s_add_u32 m0, s63, 120832
    s_add_u32 s43, s44, 32768
    buffer_load_dwordx4 v8, s[12:15], s43 offen lds
    s_add_u32 m0, s63, 121856
    s_add_u32 s43, s44, 40960
    buffer_load_dwordx4 v9, s[12:15], s43 offen lds
    s_add_u32 m0, s63, 122880
    s_add_u32 s43, s44, 49152
    buffer_load_dwordx4 v8, s[12:15], s43 offen lds
    s_add_u32 m0, s63, 123904
    s_add_u32 s43, s44, 57344
    buffer_load_dwordx4 v9, s[12:15], s43 offen lds
    s_add_u32 m0, s63, 124928
    s_add_u32 s43, s44, 65536
    buffer_load_dwordx4 v8, s[12:15], s43 offen lds
    ds_read_b64_tr_b16 v[156:157], v2 offset:0
    ds_read_b64_tr_b16 v[158:159], v2 offset:512
    ds_read_b64_tr_b16 v[160:161], v3 offset:0
    ds_read_b64_tr_b16 v[162:163], v3 offset:512
    ds_read_b64_tr_b16 v[164:165], v2 offset:256
    ds_read_b64_tr_b16 v[166:167], v2 offset:768
    ds_read_b64_tr_b16 v[168:169], v3 offset:256
    ds_read_b64_tr_b16 v[170:171], v3 offset:768
    ds_read_b128 v[208:211], v1 offset:0
    ds_read_b128 v[212:215], v1 offset:2048
    ds_read_b128 v[216:219], v1 offset:4096
    ds_read_b128 v[220:223], v1 offset:6144
    ds_read_b128 v[224:227], v1 offset:8192
    ds_read_b128 v[228:231], v1 offset:10240
    ds_read_b128 v[232:235], v1 offset:12288
    ds_read_b128 v[236:239], v1 offset:14336
    ds_read_b128 v[240:243], v1 offset:16384
    s_add_u32 m0, s59, 0
    s_nop 0
    s_mov_b32 s50, 212992
    s_waitcnt vmcnt(22)
    s_nop 0
    buffer_load_dwordx4 v131, s[20:23], s50 offen offset:3072 nt lds
    s_add_u32 m0, s59, 4096
    s_mov_b32 s50, 217088
    s_waitcnt vmcnt(22)
    s_nop 0
    buffer_load_dwordx4 v128, s[20:23], s50 offen offset:0 nt lds
    s_waitcnt lgkmcnt(9)
    s_add_u32 s44, s41, 5
    s_and_b32 s44, s44, 7
    s_lshl_b32 s43, s44, 19
    s_add_u32 s43, s43, 262144
    s_add_u32 m0, s58, 0
    s_nop 0
    buffer_load_dwordx4 v4, s[8:11], s43 offen offset:0 lds
    buffer_load_dwordx4 v5, s[8:11], s43 offen offset:1024 lds
    buffer_load_dwordx4 v6, s[8:11], s43 offen offset:2048 lds
    buffer_load_dwordx4 v7, s[8:11], s43 offen offset:3072 lds
    s_waitcnt lgkmcnt(0)
    s_nop 0
    v_mfma_f32_16x16x32_bf16 v[16:19], v[156:159], v[208:211], v[16:19]
    s_add_u32 m0, s59, 4096
    s_mov_b32 s50, 217088
    s_waitcnt vmcnt(26)
    s_nop 0
    buffer_load_dwordx4 v129, s[20:23], s50 offen offset:1024 nt lds
    v_mfma_f32_16x16x32_bf16 v[20:23], v[160:163], v[208:211], v[20:23]
    v_mfma_f32_16x16x32_bf16 v[24:27], v[164:167], v[208:211], v[24:27]
    v_mfma_f32_16x16x32_bf16 v[28:31], v[168:171], v[208:211], v[28:31]
    v_mfma_f32_16x16x32_bf16 v[32:35], v[156:159], v[212:215], v[32:35]
    s_add_u32 m0, s59, 4096
    s_mov_b32 s50, 217088
    s_waitcnt vmcnt(26)
    s_nop 0
    buffer_load_dwordx4 v130, s[20:23], s50 offen offset:2048 nt lds
    v_mfma_f32_16x16x32_bf16 v[36:39], v[160:163], v[212:215], v[36:39]
    v_mfma_f32_16x16x32_bf16 v[40:43], v[164:167], v[212:215], v[40:43]
    v_mfma_f32_16x16x32_bf16 v[44:47], v[168:171], v[212:215], v[44:47]
    s_add_u32 m0, s59, 4096
    s_mov_b32 s50, 217088
    s_waitcnt vmcnt(26)
    s_nop 0
    buffer_load_dwordx4 v131, s[20:23], s50 offen offset:3072 nt lds
    v_mfma_f32_16x16x32_bf16 v[48:51], v[156:159], v[216:219], v[48:51]
    v_mfma_f32_16x16x32_bf16 v[52:55], v[160:163], v[216:219], v[52:55]
    v_mfma_f32_16x16x32_bf16 v[56:59], v[164:167], v[216:219], v[56:59]
    s_add_u32 m0, s59, 8192
    s_mov_b32 s50, 221184
    s_waitcnt vmcnt(26)
    s_nop 0
    buffer_load_dwordx4 v132, s[20:23], s50 offen offset:0 nt lds
    v_mfma_f32_16x16x32_bf16 v[60:63], v[168:171], v[216:219], v[60:63]
    v_mfma_f32_16x16x32_bf16 v[64:67], v[156:159], v[220:223], v[64:67]
    v_mfma_f32_16x16x32_bf16 v[68:71], v[160:163], v[220:223], v[68:71]
    v_mfma_f32_16x16x32_bf16 v[72:75], v[164:167], v[220:223], v[72:75]
    s_add_u32 m0, s59, 8192
    s_mov_b32 s50, 221184
    s_waitcnt vmcnt(26)
    s_nop 0
    buffer_load_dwordx4 v133, s[20:23], s50 offen offset:1024 nt lds
    v_mfma_f32_16x16x32_bf16 v[76:79], v[168:171], v[220:223], v[76:79]
    v_mfma_f32_16x16x32_bf16 v[80:83], v[156:159], v[224:227], v[80:83]
    v_mfma_f32_16x16x32_bf16 v[84:87], v[160:163], v[224:227], v[84:87]
    s_add_u32 m0, s59, 8192
    s_mov_b32 s50, 221184
    s_waitcnt vmcnt(26)
    s_nop 0
    buffer_load_dwordx4 v134, s[20:23], s50 offen offset:2048 nt lds
    v_mfma_f32_16x16x32_bf16 v[88:91], v[164:167], v[224:227], v[88:91]
    v_mfma_f32_16x16x32_bf16 v[92:95], v[168:171], v[224:227], v[92:95]
    v_mfma_f32_16x16x32_bf16 v[96:99], v[156:159], v[228:231], v[96:99]
    s_add_u32 m0, s59, 8192
    s_mov_b32 s50, 221184
    s_waitcnt vmcnt(26)
    s_nop 0
    buffer_load_dwordx4 v135, s[20:23], s50 offen offset:3072 nt lds
    v_mfma_f32_16x16x32_bf16 v[100:103], v[160:163], v[228:231], v[100:103]
    v_mfma_f32_16x16x32_bf16 v[104:107], v[164:167], v[228:231], v[104:107]
    v_mfma_f32_16x16x32_bf16 v[108:111], v[168:171], v[228:231], v[108:111]
    s_add_u32 m0, s59, 12288
    s_mov_b32 s50, 225280
    s_waitcnt vmcnt(26)
    s_nop 0
    buffer_load_dwordx4 v132, s[20:23], s50 offen offset:0 nt lds
    v_mfma_f32_16x16x32_bf16 v[112:115], v[156:159], v[232:235], v[112:115]
    v_mfma_f32_16x16x32_bf16 v[116:119], v[160:163], v[232:235], v[116:119]
    v_mfma_f32_16x16x32_bf16 v[120:123], v[164:167], v[232:235], v[120:123]
    v_mfma_f32_16x16x32_bf16 v[124:127], v[168:171], v[232:235], v[124:127]
    s_add_u32 m0, s59, 12288
    s_mov_b32 s50, 225280
    s_waitcnt vmcnt(26)
    s_nop 0
    buffer_load_dwordx4 v133, s[20:23], s50 offen offset:1024 nt lds
    v_mfma_f32_16x16x32_bf16 v[176:179], v[156:159], v[236:239], v[176:179]
    v_mfma_f32_16x16x32_bf16 v[180:183], v[160:163], v[236:239], v[180:183]
    v_mfma_f32_16x16x32_bf16 v[184:187], v[164:167], v[236:239], v[184:187]
    s_add_u32 m0, s59, 12288
    s_mov_b32 s50, 225280
    s_waitcnt vmcnt(26)
    s_nop 0
    buffer_load_dwordx4 v134, s[20:23], s50 offen offset:2048 nt lds
    v_mfma_f32_16x16x32_bf16 v[188:191], v[168:171], v[236:239], v[188:191]
    v_mfma_f32_16x16x32_bf16 v[192:195], v[156:159], v[240:243], v[192:195]
    v_mfma_f32_16x16x32_bf16 v[196:199], v[160:163], v[240:243], v[196:199]
    s_add_u32 m0, s59, 12288
    s_mov_b32 s50, 225280
    s_waitcnt vmcnt(26)
    s_nop 0
    buffer_load_dwordx4 v135, s[20:23], s50 offen offset:3072 nt lds
    v_mfma_f32_16x16x32_bf16 v[200:203], v[164:167], v[240:243], v[200:203]
    v_mfma_f32_16x16x32_bf16 v[204:207], v[168:171], v[240:243], v[204:207]
    s_barrier
    s_nop 0
    s_add_u32 m0, s59, 32768
    s_mov_b32 s50, 229376
    s_waitcnt vmcnt(26)
    s_nop 0
    buffer_load_dwordx4 v128, s[20:23], s50 offen offset:0 nt lds
    s_add_u32 m0, s59, 32768
    s_mov_b32 s50, 229376
    s_waitcnt vmcnt(17)
    s_nop 0
    buffer_load_dwordx4 v129, s[20:23], s50 offen offset:1024 nt lds
    s_add_u32 m0, s59, 32768
    s_mov_b32 s50, 229376
    s_waitcnt vmcnt(17)
    s_nop 0
    buffer_load_dwordx4 v130, s[20:23], s50 offen offset:2048 nt lds
    ds_read_b64_tr_b16 v[156:157], v2 offset:4096
    ds_read_b64_tr_b16 v[158:159], v2 offset:4608
    ds_read_b64_tr_b16 v[160:161], v3 offset:4096
    ds_read_b64_tr_b16 v[162:163], v3 offset:4608
    ds_read_b64_tr_b16 v[164:165], v2 offset:4352
    ds_read_b64_tr_b16 v[166:167], v2 offset:4864
    ds_read_b64_tr_b16 v[168:169], v3 offset:4352
    ds_read_b64_tr_b16 v[170:171], v3 offset:4864
    ds_read_b128 v[208:211], v1 offset:256
    ds_read_b128 v[212:215], v1 offset:2304
    ds_read_b128 v[216:219], v1 offset:4352
    ds_read_b128 v[220:223], v1 offset:6400
    ds_read_b128 v[224:227], v1 offset:8448
    ds_read_b128 v[228:231], v1 offset:10496
    ds_read_b128 v[232:235], v1 offset:12544
    ds_read_b128 v[236:239], v1 offset:14592
    ds_read_b128 v[240:243], v1 offset:16640
    s_add_u32 m0, s59, 32768
    s_mov_b32 s50, 229376
    s_waitcnt vmcnt(13)
    s_nop 0
    buffer_load_dwordx4 v131, s[20:23], s50 offen offset:3072 nt lds
    s_add_u32 m0, s59, 36864
    s_mov_b32 s50, 233472
    s_waitcnt vmcnt(13)
    s_nop 0
    buffer_load_dwordx4 v128, s[20:23], s50 offen offset:0 nt lds
    s_waitcnt lgkmcnt(9)
    s_waitcnt lgkmcnt(0)
    v_mfma_f32_16x16x32_bf16 v[16:19], v[156:159], v[208:211], v[16:19]
    s_add_u32 m0, s59, 36864
    s_mov_b32 s50, 233472
    s_waitcnt vmcnt(13)
    s_nop 0
    buffer_load_dwordx4 v129, s[20:23], s50 offen offset:1024 nt lds
    v_mfma_f32_16x16x32_bf16 v[20:23], v[160:163], v[208:211], v[20:23]
    v_mfma_f32_16x16x32_bf16 v[24:27], v[164:167], v[208:211], v[24:27]
    v_mfma_f32_16x16x32_bf16 v[28:31], v[168:171], v[208:211], v[28:31]
    v_mfma_f32_16x16x32_bf16 v[32:35], v[156:159], v[212:215], v[32:35]
    s_add_u32 m0, s59, 36864
    s_mov_b32 s50, 233472
    s_waitcnt vmcnt(13)
    s_nop 0
    buffer_load_dwordx4 v130, s[20:23], s50 offen offset:2048 nt lds
    v_mfma_f32_16x16x32_bf16 v[36:39], v[160:163], v[212:215], v[36:39]
    v_mfma_f32_16x16x32_bf16 v[40:43], v[164:167], v[212:215], v[40:43]
    v_mfma_f32_16x16x32_bf16 v[44:47], v[168:171], v[212:215], v[44:47]
    s_add_u32 m0, s59, 36864
    s_mov_b32 s50, 233472
    s_waitcnt vmcnt(13)
    s_nop 0
    buffer_load_dwordx4 v131, s[20:23], s50 offen offset:3072 nt lds
    v_mfma_f32_16x16x32_bf16 v[48:51], v[156:159], v[216:219], v[48:51]
    v_mfma_f32_16x16x32_bf16 v[52:55], v[160:163], v[216:219], v[52:55]
    v_mfma_f32_16x16x32_bf16 v[56:59], v[164:167], v[216:219], v[56:59]
    s_add_u32 m0, s59, 40960
    s_mov_b32 s50, 237568
    s_waitcnt vmcnt(13)
    s_nop 0
    buffer_load_dwordx4 v132, s[20:23], s50 offen offset:0 nt lds
    v_mfma_f32_16x16x32_bf16 v[60:63], v[168:171], v[216:219], v[60:63]
    v_mfma_f32_16x16x32_bf16 v[64:67], v[156:159], v[220:223], v[64:67]
    v_mfma_f32_16x16x32_bf16 v[68:71], v[160:163], v[220:223], v[68:71]
    v_mfma_f32_16x16x32_bf16 v[72:75], v[164:167], v[220:223], v[72:75]
    s_add_u32 m0, s59, 40960
    s_mov_b32 s50, 237568
    s_waitcnt vmcnt(13)
    s_nop 0
    buffer_load_dwordx4 v133, s[20:23], s50 offen offset:1024 nt lds
    v_mfma_f32_16x16x32_bf16 v[76:79], v[168:171], v[220:223], v[76:79]
    v_mfma_f32_16x16x32_bf16 v[80:83], v[156:159], v[224:227], v[80:83]
    v_mfma_f32_16x16x32_bf16 v[84:87], v[160:163], v[224:227], v[84:87]
    s_add_u32 m0, s59, 40960
    s_mov_b32 s50, 237568
    s_waitcnt vmcnt(13)
    s_nop 0
    buffer_load_dwordx4 v134, s[20:23], s50 offen offset:2048 nt lds
    v_mfma_f32_16x16x32_bf16 v[88:91], v[164:167], v[224:227], v[88:91]
    v_mfma_f32_16x16x32_bf16 v[92:95], v[168:171], v[224:227], v[92:95]
    v_mfma_f32_16x16x32_bf16 v[96:99], v[156:159], v[228:231], v[96:99]
    s_add_u32 m0, s59, 40960
    s_mov_b32 s50, 237568
    s_waitcnt vmcnt(13)
    s_nop 0
    buffer_load_dwordx4 v135, s[20:23], s50 offen offset:3072 nt lds
    v_mfma_f32_16x16x32_bf16 v[100:103], v[160:163], v[228:231], v[100:103]
    v_mfma_f32_16x16x32_bf16 v[104:107], v[164:167], v[228:231], v[104:107]
    v_mfma_f32_16x16x32_bf16 v[108:111], v[168:171], v[228:231], v[108:111]
    s_add_u32 m0, s59, 45056
    s_mov_b32 s50, 241664
    s_waitcnt vmcnt(13)
    s_nop 0
    buffer_load_dwordx4 v132, s[20:23], s50 offen offset:0 nt lds
    v_mfma_f32_16x16x32_bf16 v[112:115], v[156:159], v[232:235], v[112:115]
    v_mfma_f32_16x16x32_bf16 v[116:119], v[160:163], v[232:235], v[116:119]
    v_mfma_f32_16x16x32_bf16 v[120:123], v[164:167], v[232:235], v[120:123]
    v_mfma_f32_16x16x32_bf16 v[124:127], v[168:171], v[232:235], v[124:127]
    s_add_u32 m0, s59, 45056
    s_mov_b32 s50, 241664
    s_waitcnt vmcnt(13)
    s_nop 0
    buffer_load_dwordx4 v133, s[20:23], s50 offen offset:1024 nt lds
    v_mfma_f32_16x16x32_bf16 v[176:179], v[156:159], v[236:239], v[176:179]
    v_mfma_f32_16x16x32_bf16 v[180:183], v[160:163], v[236:239], v[180:183]
    v_mfma_f32_16x16x32_bf16 v[184:187], v[164:167], v[236:239], v[184:187]
    s_add_u32 m0, s59, 45056
    s_mov_b32 s50, 241664
    s_waitcnt vmcnt(13)
    s_nop 0
    buffer_load_dwordx4 v134, s[20:23], s50 offen offset:2048 nt lds
    v_mfma_f32_16x16x32_bf16 v[188:191], v[168:171], v[236:239], v[188:191]
    v_mfma_f32_16x16x32_bf16 v[192:195], v[156:159], v[240:243], v[192:195]
    v_mfma_f32_16x16x32_bf16 v[196:199], v[160:163], v[240:243], v[196:199]
    s_add_u32 m0, s59, 45056
    s_mov_b32 s50, 241664
    s_waitcnt vmcnt(13)
    s_nop 0
    buffer_load_dwordx4 v135, s[20:23], s50 offen offset:3072 nt lds
    v_mfma_f32_16x16x32_bf16 v[200:203], v[164:167], v[240:243], v[200:203]
    v_mfma_f32_16x16x32_bf16 v[204:207], v[168:171], v[240:243], v[204:207]
L_tag:
    v_cmp_eq_u32_e64 vcc, 0, v139
    s_cbranch_vccz L_tag_ok
    s_sleep 8
    buffer_load_dword v139, v137, s[32:35], 0 offen sc1
    s_waitcnt vmcnt(0)
    s_branch L_tag
L_tag_ok:
    v_readfirstlane_b32 s84, v139
    s_nop 0
    v_mov_b32 v140, 163720
    ds_write_b32 v140, v139
    s_or_b32 s85, s84, 0x60000000
    s_waitcnt lgkmcnt(0)
    s_barrier
    s_add_u32 m0, s59, 65536
    s_mov_b32 s50, 245760
    s_waitcnt vmcnt(13)
    s_nop 0
    buffer_load_dwordx4 v128, s[20:23], s50 offen offset:0 nt lds
    s_add_u32 m0, s59, 65536
    s_mov_b32 s50, 245760
    s_waitcnt vmcnt(13)
    s_nop 0
    buffer_load_dwordx4 v129, s[20:23], s50 offen offset:1024 nt lds
    s_add_u32 m0, s59, 65536
    s_mov_b32 s50, 245760
    s_waitcnt vmcnt(13)
    s_nop 0
    buffer_load_dwordx4 v130, s[20:23], s50 offen offset:2048 nt lds
    ds_read_b64_tr_b16 v[156:157], v2 offset:8192
    ds_read_b64_tr_b16 v[158:159], v2 offset:8704
    ds_read_b64_tr_b16 v[160:161], v3 offset:8192
    ds_read_b64_tr_b16 v[162:163], v3 offset:8704
    ds_read_b64_tr_b16 v[164:165], v2 offset:8448
    ds_read_b64_tr_b16 v[166:167], v2 offset:8960
    ds_read_b64_tr_b16 v[168:169], v3 offset:8448
    ds_read_b64_tr_b16 v[170:171], v3 offset:8960
    ds_read_b128 v[208:211], v1 offset:18432
    ds_read_b128 v[212:215], v1 offset:20480
    ds_read_b128 v[216:219], v1 offset:22528
    ds_read_b128 v[220:223], v1 offset:24576
    ds_read_b128 v[224:227], v1 offset:26624
    ds_read_b128 v[228:231], v1 offset:28672
    ds_read_b128 v[232:235], v1 offset:30720
    ds_read_b128 v[236:239], v1 offset:32768
    ds_read_b128 v[240:243], v1 offset:34816
    s_add_u32 m0, s59, 65536
    s_mov_b32 s50, 245760
    s_waitcnt vmcnt(13)
    s_nop 0
    buffer_load_dwordx4 v131, s[20:23], s50 offen offset:3072 nt lds
    s_add_u32 m0, s59, 69632
    s_mov_b32 s50, 249856
    s_waitcnt vmcnt(13)
    s_nop 0
    buffer_load_dwordx4 v128, s[20:23], s50 offen offset:0 nt lds
    s_waitcnt lgkmcnt(9)
    s_waitcnt lgkmcnt(0)
    v_mfma_f32_16x16x32_bf16 v[16:19], v[156:159], v[208:211], v[16:19]
    s_add_u32 m0, s59, 69632
    s_mov_b32 s50, 249856
    s_waitcnt vmcnt(13)
    s_nop 0
    buffer_load_dwordx4 v129, s[20:23], s50 offen offset:1024 nt lds
    v_mfma_f32_16x16x32_bf16 v[20:23], v[160:163], v[208:211], v[20:23]
    v_mfma_f32_16x16x32_bf16 v[24:27], v[164:167], v[208:211], v[24:27]
    v_mfma_f32_16x16x32_bf16 v[28:31], v[168:171], v[208:211], v[28:31]
    v_mfma_f32_16x16x32_bf16 v[32:35], v[156:159], v[212:215], v[32:35]
    s_add_u32 m0, s59, 69632
    s_mov_b32 s50, 249856
    s_waitcnt vmcnt(13)
    s_nop 0
    buffer_load_dwordx4 v130, s[20:23], s50 offen offset:2048 nt lds
    v_mfma_f32_16x16x32_bf16 v[36:39], v[160:163], v[212:215], v[36:39]
    v_mfma_f32_16x16x32_bf16 v[40:43], v[164:167], v[212:215], v[40:43]
    v_mfma_f32_16x16x32_bf16 v[44:47], v[168:171], v[212:215], v[44:47]
    s_add_u32 m0, s59, 69632
    s_mov_b32 s50, 249856
    s_waitcnt vmcnt(13)
    s_nop 0
    buffer_load_dwordx4 v131, s[20:23], s50 offen offset:3072 nt lds
    v_mfma_f32_16x16x32_bf16 v[48:51], v[156:159], v[216:219], v[48:51]
    v_mfma_f32_16x16x32_bf16 v[52:55], v[160:163], v[216:219], v[52:55]
    v_mfma_f32_16x16x32_bf16 v[56:59], v[164:167], v[216:219], v[56:59]
    s_add_u32 m0, s59, 73728
    s_mov_b32 s50, 253952
    s_waitcnt vmcnt(13)
    s_nop 0
    buffer_load_dwordx4 v132, s[20:23], s50 offen offset:0 nt lds
    v_mfma_f32_16x16x32_bf16 v[60:63], v[168:171], v[216:219], v[60:63]
    v_mfma_f32_16x16x32_bf16 v[64:67], v[156:159], v[220:223], v[64:67]
    v_mfma_f32_16x16x32_bf16 v[68:71], v[160:163], v[220:223], v[68:71]
    v_mfma_f32_16x16x32_bf16 v[72:75], v[164:167], v[220:223], v[72:75]
    s_add_u32 m0, s59, 73728
    s_mov_b32 s50, 253952
    s_waitcnt vmcnt(13)
    s_nop 0
    buffer_load_dwordx4 v133, s[20:23], s50 offen offset:1024 nt lds
    v_mfma_f32_16x16x32_bf16 v[76:79], v[168:171], v[220:223], v[76:79]
    v_mfma_f32_16x16x32_bf16 v[80:83], v[156:159], v[224:227], v[80:83]
    v_mfma_f32_16x16x32_bf16 v[84:87], v[160:163], v[224:227], v[84:87]
    s_add_u32 m0, s59, 73728
    s_mov_b32 s50, 253952
    s_waitcnt vmcnt(13)
    s_nop 0
    buffer_load_dwordx4 v134, s[20:23], s50 offen offset:2048 nt lds
    v_mfma_f32_16x16x32_bf16 v[88:91], v[164:167], v[224:227], v[88:91]
    v_mfma_f32_16x16x32_bf16 v[92:95], v[168:171], v[224:227], v[92:95]
    v_mfma_f32_16x16x32_bf16 v[96:99], v[156:159], v[228:231], v[96:99]
    s_add_u32 m0, s59, 73728
    s_mov_b32 s50, 253952
    s_waitcnt vmcnt(13)
    s_nop 0
    buffer_load_dwordx4 v135, s[20:23], s50 offen offset:3072 nt lds
    v_mfma_f32_16x16x32_bf16 v[100:103], v[160:163], v[228:231], v[100:103]
    v_mfma_f32_16x16x32_bf16 v[104:107], v[164:167], v[228:231], v[104:107]
    v_mfma_f32_16x16x32_bf16 v[108:111], v[168:171], v[228:231], v[108:111]
    s_add_u32 m0, s59, 77824
    s_mov_b32 s50, 258048
    s_waitcnt vmcnt(13)
    s_nop 0
    buffer_load_dwordx4 v132, s[20:23], s50 offen offset:0 nt lds
    v_mfma_f32_16x16x32_bf16 v[112:115], v[156:159], v[232:235], v[112:115]
    v_mfma_f32_16x16x32_bf16 v[116:119], v[160:163], v[232:235], v[116:119]
    v_mfma_f32_16x16x32_bf16 v[120:123], v[164:167], v[232:235], v[120:123]
    v_mfma_f32_16x16x32_bf16 v[124:127], v[168:171], v[232:235], v[124:127]
    s_add_u32 m0, s59, 77824
    s_mov_b32 s50, 258048
    s_waitcnt vmcnt(13)
    s_nop 0
    buffer_load_dwordx4 v133, s[20:23], s50 offen offset:1024 nt lds
    v_mfma_f32_16x16x32_bf16 v[176:179], v[156:159], v[236:239], v[176:179]
    v_mfma_f32_16x16x32_bf16 v[180:183], v[160:163], v[236:239], v[180:183]
    v_mfma_f32_16x16x32_bf16 v[184:187], v[164:167], v[236:239], v[184:187]
    s_add_u32 m0, s59, 77824
    s_mov_b32 s50, 258048
    s_waitcnt vmcnt(13)
    s_nop 0
    buffer_load_dwordx4 v134, s[20:23], s50 offen offset:2048 nt lds
    v_mfma_f32_16x16x32_bf16 v[188:191], v[168:171], v[236:239], v[188:191]
    v_mfma_f32_16x16x32_bf16 v[192:195], v[156:159], v[240:243], v[192:195]
    v_mfma_f32_16x16x32_bf16 v[196:199], v[160:163], v[240:243], v[196:199]
    s_add_u32 m0, s59, 77824
    s_mov_b32 s50, 258048
    s_waitcnt vmcnt(13)
    s_nop 0
    buffer_load_dwordx4 v135, s[20:23], s50 offen offset:3072 nt lds
    v_mfma_f32_16x16x32_bf16 v[200:203], v[164:167], v[240:243], v[200:203]
    v_mfma_f32_16x16x32_bf16 v[204:207], v[168:171], v[240:243], v[204:207]
    s_barrier
    s_add_u32 m0, s59, 0
    s_mov_b32 s50, 262144
    s_waitcnt vmcnt(13)
    s_nop 0
    buffer_load_dwordx4 v128, s[20:23], s50 offen offset:0 nt lds
    s_add_u32 m0, s59, 0
    s_nop 0
    s_mov_b32 s50, 262144
    s_waitcnt vmcnt(13)
    s_nop 0
    buffer_load_dwordx4 v129, s[20:23], s50 offen offset:1024 nt lds
    s_add_u32 m0, s59, 0
    s_nop 0
    s_mov_b32 s50, 262144
    s_waitcnt vmcnt(13)
    s_nop 0
    buffer_load_dwordx4 v130, s[20:23], s50 offen offset:2048 nt lds
    ds_read_b64_tr_b16 v[156:157], v2 offset:0
    ds_read_b64_tr_b16 v[158:159], v2 offset:512
    ds_read_b64_tr_b16 v[160:161], v3 offset:0
    ds_read_b64_tr_b16 v[162:163], v3 offset:512
    ds_read_b64_tr_b16 v[164:165], v2 offset:256
    ds_read_b64_tr_b16 v[166:167], v2 offset:768
    ds_read_b64_tr_b16 v[168:169], v3 offset:256
    ds_read_b64_tr_b16 v[170:171], v3 offset:768
    ds_read_b128 v[208:211], v1 offset:18688
    ds_read_b128 v[212:215], v1 offset:20736
    ds_read_b128 v[216:219], v1 offset:22784
    ds_read_b128 v[220:223], v1 offset:24832
    ds_read_b128 v[224:227], v1 offset:26880
    ds_read_b128 v[228:231], v1 offset:28928
    ds_read_b128 v[232:235], v1 offset:30976
    ds_read_b128 v[236:239], v1 offset:33024
    ds_read_b128 v[240:243], v1 offset:35072
    s_add_u32 m0, s59, 0
    s_nop 0
    s_mov_b32 s50, 262144
    s_waitcnt vmcnt(13)
    s_nop 0
    buffer_load_dwordx4 v131, s[20:23], s50 offen offset:3072 nt lds
    s_add_u32 m0, s59, 4096
    s_mov_b32 s50, 266240
    s_waitcnt vmcnt(13)
    s_nop 0
    buffer_load_dwordx4 v128, s[20:23], s50 offen offset:0 nt lds
    s_waitcnt lgkmcnt(9)
    s_waitcnt lgkmcnt(0)
    s_setprio 1
    s_nop 0
    v_mfma_f32_16x16x32_bf16 v[16:19], v[156:159], v[208:211], v[16:19]
    s_add_u32 m0, s59, 4096
    s_mov_b32 s50, 266240
    s_waitcnt vmcnt(13)
    s_nop 0
    buffer_load_dwordx4 v129, s[20:23], s50 offen offset:1024 nt lds
    v_mfma_f32_16x16x32_bf16 v[20:23], v[160:163], v[208:211], v[20:23]
    v_mfma_f32_16x16x32_bf16 v[24:27], v[164:167], v[208:211], v[24:27]
    v_mfma_f32_16x16x32_bf16 v[28:31], v[168:171], v[208:211], v[28:31]
    v_mfma_f32_16x16x32_bf16 v[32:35], v[156:159], v[212:215], v[32:35]
    s_add_u32 m0, s59, 4096
    s_mov_b32 s50, 266240
    s_waitcnt vmcnt(13)
    s_nop 0
    buffer_load_dwordx4 v130, s[20:23], s50 offen offset:2048 nt lds
    v_mfma_f32_16x16x32_bf16 v[36:39], v[160:163], v[212:215], v[36:39]
    v_mfma_f32_16x16x32_bf16 v[40:43], v[164:167], v[212:215], v[40:43]
    v_mfma_f32_16x16x32_bf16 v[44:47], v[168:171], v[212:215], v[44:47]
    s_add_u32 m0, s59, 4096
    s_mov_b32 s50, 266240
    s_waitcnt vmcnt(13)
    s_nop 0
    buffer_load_dwordx4 v131, s[20:23], s50 offen offset:3072 nt lds
    v_mfma_f32_16x16x32_bf16 v[48:51], v[156:159], v[216:219], v[48:51]
    v_mul_f32 v16, v10, v16
    v_mul_f32 v17, v10, v17
    v_mul_f32 v18, v10, v18
    v_mul_f32 v19, v10, v19
    v_mul_f32 v20, v10, v20
    v_mul_f32 v21, v10, v21
    v_mul_f32_e64 v22, v10, v22
    v_mfma_f32_16x16x32_bf16 v[52:55], v[160:163], v[216:219], v[52:55]
    v_mul_f32_e64 v23, v10, v23
    v_cvt_pk_bf16_f32 v16, v16, v17
    v_cvt_pk_bf16_f32 v17, v18, v19
    v_cvt_pk_bf16_f32 v18, v20, v21
    v_cvt_pk_bf16_f32 v19, v22, v23
    v_mul_f32 v24, v10, v24
    v_mul_f32 v25, v10, v25
    v_mfma_f32_16x16x32_bf16 v[56:59], v[164:167], v[216:219], v[56:59]
    s_add_u32 m0, s59, 8192
    s_mov_b32 s50, 270336
    s_waitcnt vmcnt(13)
    s_nop 0
    buffer_load_dwordx4 v132, s[20:23], s50 offen offset:0 nt lds
    v_mul_f32 v26, v10, v26
    v_mul_f32 v27, v10, v27
    v_mul_f32 v28, v10, v28
    v_mul_f32 v29, v10, v29
    v_mul_f32 v30, v10, v30
    v_mul_f32 v31, v10, v31
    v_cvt_pk_bf16_f32 v24, v24, v25
    v_mfma_f32_16x16x32_bf16 v[60:63], v[168:171], v[216:219], v[60:63]
    v_cvt_pk_bf16_f32 v25, v26, v27
    v_cvt_pk_bf16_f32 v26, v28, v29
    v_cvt_pk_bf16_f32 v27, v30, v31
    v_permlane16_swap_b32 v16, v18
    v_permlane16_swap_b32 v17, v19
    v_permlane16_swap_b32 v24, v26
    v_permlane16_swap_b32 v25, v27
    v_mfma_f32_16x16x32_bf16 v[64:67], v[156:159], v[220:223], v[64:67]
    v_mul_f32 v32, v10, v32
    v_mul_f32 v33, v10, v33
    v_mul_f32 v34, v10, v34
    v_mul_f32 v35, v10, v35
    v_mul_f32 v36, v10, v36
    v_mul_f32 v37, v10, v37
    v_mul_f32_e64 v38, v10, v38
    v_mfma_f32_16x16x32_bf16 v[68:71], v[160:163], v[220:223], v[68:71]
    v_mul_f32_e64 v39, v10, v39
    v_cvt_pk_bf16_f32 v32, v32, v33
    v_cvt_pk_bf16_f32 v33, v34, v35
    v_cvt_pk_bf16_f32 v34, v36, v37
    v_cvt_pk_bf16_f32 v35, v38, v39
    v_mul_f32 v40, v10, v40
    v_mul_f32 v41, v10, v41
    v_mfma_f32_16x16x32_bf16 v[72:75], v[164:167], v[220:223], v[72:75]
    s_add_u32 m0, s59, 8192
    s_mov_b32 s50, 270336
    s_waitcnt vmcnt(13)
    s_nop 0
    buffer_load_dwordx4 v133, s[20:23], s50 offen offset:1024 nt lds
    v_mul_f32 v42, v10, v42
    v_mul_f32 v43, v10, v43
    v_mul_f32 v44, v10, v44
    v_mul_f32 v45, v10, v45
    v_mul_f32 v46, v10, v46
    v_mul_f32 v47, v10, v47
    v_cvt_pk_bf16_f32 v40, v40, v41
    v_mfma_f32_16x16x32_bf16 v[76:79], v[168:171], v[220:223], v[76:79]
    v_cvt_pk_bf16_f32 v41, v42, v43
    v_cvt_pk_bf16_f32 v42, v44, v45
    v_cvt_pk_bf16_f32 v43, v46, v47
    v_permlane16_swap_b32 v32, v34
    v_permlane16_swap_b32 v33, v35
    v_permlane16_swap_b32 v40, v42
    v_permlane16_swap_b32 v41, v43
    v_mfma_f32_16x16x32_bf16 v[80:83], v[156:159], v[224:227], v[80:83]
    v_mul_f32 v48, v10, v48
    v_mul_f32 v49, v10, v49
    v_mul_f32 v50, v10, v50
    v_mul_f32 v51, v10, v51
    v_mul_f32 v52, v10, v52
    v_mul_f32 v53, v10, v53
    v_mul_f32_e64 v54, v10, v54
    v_mfma_f32_16x16x32_bf16 v[84:87], v[160:163], v[224:227], v[84:87]
    s_add_u32 m0, s59, 8192
    s_mov_b32 s50, 270336
    s_waitcnt vmcnt(13)
    s_nop 0
    buffer_load_dwordx4 v134, s[20:23], s50 offen offset:2048 nt lds
    v_mul_f32_e64 v55, v10, v55
    v_cvt_pk_bf16_f32 v48, v48, v49
    v_cvt_pk_bf16_f32 v49, v50, v51
    v_cvt_pk_bf16_f32 v50, v52, v53
    v_cvt_pk_bf16_f32 v51, v54, v55
    v_mul_f32 v56, v10, v56
    v_mul_f32 v57, v10, v57
    v_mfma_f32_16x16x32_bf16 v[88:91], v[164:167], v[224:227], v[88:91]
    v_mul_f32 v58, v10, v58
    v_mul_f32 v59, v10, v59
    v_mul_f32 v60, v10, v60
    v_mul_f32 v61, v10, v61
    v_mul_f32 v62, v10, v62
    v_mul_f32 v63, v10, v63
    v_cvt_pk_bf16_f32 v56, v56, v57
    v_mfma_f32_16x16x32_bf16 v[92:95], v[168:171], v[224:227], v[92:95]
    v_cvt_pk_bf16_f32 v57, v58, v59
    v_cvt_pk_bf16_f32 v58, v60, v61
    v_cvt_pk_bf16_f32 v59, v62, v63
    v_permlane16_swap_b32 v48, v50
    v_permlane16_swap_b32 v49, v51
    v_permlane16_swap_b32 v56, v58
    v_permlane16_swap_b32 v57, v59
    v_mfma_f32_16x16x32_bf16 v[96:99], v[156:159], v[228:231], v[96:99]
    s_add_u32 m0, s59, 8192
    s_mov_b32 s50, 270336
    s_waitcnt vmcnt(13)
    s_nop 0
    buffer_load_dwordx4 v135, s[20:23], s50 offen offset:3072 nt lds
    v_mul_f32 v64, v10, v64
    v_mul_f32 v65, v10, v65
    v_mul_f32 v66, v10, v66
    v_mul_f32 v67, v10, v67
    v_mul_f32 v68, v10, v68
    v_mul_f32 v69, v10, v69
    v_mul_f32_e64 v70, v10, v70
    v_mfma_f32_16x16x32_bf16 v[100:103], v[160:163], v[228:231], v[100:103]
    v_mul_f32_e64 v71, v10, v71
    v_cvt_pk_bf16_f32 v64, v64, v65
    v_cvt_pk_bf16_f32 v65, v66, v67
    v_cvt_pk_bf16_f32 v66, v68, v69
    v_cvt_pk_bf16_f32 v67, v70, v71
    v_mul_f32 v72, v10, v72
    v_mul_f32 v73, v10, v73
    v_mfma_f32_16x16x32_bf16 v[104:107], v[164:167], v[228:231], v[104:107]
    v_mul_f32 v74, v10, v74
    v_mul_f32 v75, v10, v75
    v_mul_f32 v76, v10, v76
    v_mul_f32 v77, v10, v77
    v_mul_f32 v78, v10, v78
    v_mul_f32 v79, v10, v79
    v_cvt_pk_bf16_f32 v72, v72, v73
    v_mfma_f32_16x16x32_bf16 v[108:111], v[168:171], v[228:231], v[108:111]
    s_add_u32 m0, s59, 12288
    s_mov_b32 s50, 274432
    s_waitcnt vmcnt(13)
    s_nop 0
    buffer_load_dwordx4 v132, s[20:23], s50 offen offset:0 nt lds
    v_cvt_pk_bf16_f32 v73, v74, v75
    v_cvt_pk_bf16_f32 v74, v76, v77
    v_cvt_pk_bf16_f32 v75, v78, v79
    v_permlane16_swap_b32 v64, v66
    v_permlane16_swap_b32 v65, v67
    v_permlane16_swap_b32 v72, v74
    v_permlane16_swap_b32 v73, v75
    v_mfma_f32_16x16x32_bf16 v[112:115], v[156:159], v[232:235], v[112:115]
    v_mul_f32 v80, v10, v80
    v_mul_f32 v81, v10, v81
    v_mul_f32 v82, v10, v82
    v_mul_f32 v83, v10, v83
    v_mul_f32 v84, v10, v84
    v_mul_f32 v85, v10, v85
    v_mul_f32_e64 v86, v10, v86
    v_mfma_f32_16x16x32_bf16 v[116:119], v[160:163], v[232:235], v[116:119]
    v_mul_f32_e64 v87, v10, v87
    v_cvt_pk_bf16_f32 v80, v80, v81
    v_cvt_pk_bf16_f32 v81, v82, v83
    v_cvt_pk_bf16_f32 v82, v84, v85
    v_cvt_pk_bf16_f32 v83, v86, v87
    v_mul_f32 v88, v10, v88
    v_mul_f32 v89, v10, v89
    v_mfma_f32_16x16x32_bf16 v[120:123], v[164:167], v[232:235], v[120:123]
    v_mul_f32 v90, v10, v90
    v_mul_f32 v91, v10, v91
    v_mul_f32 v92, v10, v92
    v_mul_f32 v93, v10, v93
    v_mul_f32 v94, v10, v94
    v_mul_f32 v95, v10, v95
    v_cvt_pk_bf16_f32 v88, v88, v89
    v_mfma_f32_16x16x32_bf16 v[124:127], v[168:171], v[232:235], v[124:127]
    s_add_u32 m0, s59, 12288
    s_mov_b32 s50, 274432
    s_waitcnt vmcnt(13)
    s_nop 0
    buffer_load_dwordx4 v133, s[20:23], s50 offen offset:1024 nt lds
    v_cvt_pk_bf16_f32 v89, v90, v91
    v_cvt_pk_bf16_f32 v90, v92, v93
    v_cvt_pk_bf16_f32 v91, v94, v95
    v_permlane16_swap_b32 v80, v82
    v_permlane16_swap_b32 v81, v83
    v_permlane16_swap_b32 v88, v90
    v_permlane16_swap_b32 v89, v91
    v_mfma_f32_16x16x32_bf16 v[176:179], v[156:159], v[236:239], v[176:179]
    v_mul_f32 v96, v10, v96
    v_mul_f32 v97, v10, v97
    v_mul_f32 v98, v10, v98
    v_mul_f32 v99, v10, v99
    v_mul_f32 v100, v10, v100
    v_mul_f32 v101, v10, v101
    v_mul_f32_e64 v102, v10, v102
    v_mfma_f32_16x16x32_bf16 v[180:183], v[160:163], v[236:239], v[180:183]
    v_mul_f32_e64 v103, v10, v103
    v_cvt_pk_bf16_f32 v96, v96, v97
    v_cvt_pk_bf16_f32 v97, v98, v99
    v_cvt_pk_bf16_f32 v98, v100, v101
    v_cvt_pk_bf16_f32 v99, v102, v103
    v_mul_f32 v104, v10, v104
    v_mul_f32 v105, v10, v105
    v_mfma_f32_16x16x32_bf16 v[184:187], v[164:167], v[236:239], v[184:187]
    s_add_u32 m0, s59, 12288
    s_mov_b32 s50, 274432
    s_waitcnt vmcnt(13)
    s_nop 0
    buffer_load_dwordx4 v134, s[20:23], s50 offen offset:2048 nt lds
    v_mul_f32 v106, v10, v106
    v_mul_f32 v107, v10, v107
    v_mul_f32 v108, v10, v108
    v_mul_f32 v109, v10, v109
    v_mul_f32 v110, v10, v110
    v_mul_f32 v111, v10, v111
    v_cvt_pk_bf16_f32 v104, v104, v105
    v_mfma_f32_16x16x32_bf16 v[188:191], v[168:171], v[236:239], v[188:191]
    v_cvt_pk_bf16_f32 v105, v106, v107
    v_cvt_pk_bf16_f32 v106, v108, v109
    v_cvt_pk_bf16_f32 v107, v110, v111
    v_permlane16_swap_b32 v96, v98
    v_permlane16_swap_b32 v97, v99
    v_permlane16_swap_b32 v104, v106
    v_permlane16_swap_b32 v105, v107
    v_mfma_f32_16x16x32_bf16 v[192:195], v[156:159], v[240:243], v[192:195]
    v_mul_f32 v112, v10, v112
    v_mul_f32 v113, v10, v113
    v_mul_f32 v114, v10, v114
    v_mul_f32 v115, v10, v115
    v_mul_f32 v116, v10, v116
    v_mul_f32 v117, v10, v117
    v_mul_f32_e64 v118, v10, v118
    v_mfma_f32_16x16x32_bf16 v[196:199], v[160:163], v[240:243], v[196:199]
    s_add_u32 m0, s59, 12288
    s_mov_b32 s50, 274432
    s_waitcnt vmcnt(13)
    s_nop 0
    buffer_load_dwordx4 v135, s[20:23], s50 offen offset:3072 nt lds
    v_mul_f32_e64 v119, v10, v119
    v_cvt_pk_bf16_f32 v112, v112, v113
    v_cvt_pk_bf16_f32 v113, v114, v115
    v_cvt_pk_bf16_f32 v114, v116, v117
    v_cvt_pk_bf16_f32 v115, v118, v119
    v_mul_f32 v120, v10, v120
    v_mul_f32 v121, v10, v121
    v_mfma_f32_16x16x32_bf16 v[200:203], v[164:167], v[240:243], v[200:203]
    v_mul_f32 v122, v10, v122
    v_mul_f32 v123, v10, v123
    v_mul_f32 v124, v10, v124
    v_mul_f32 v125, v10, v125
    v_mul_f32 v126, v10, v126
    v_mul_f32 v127, v10, v127
    v_cvt_pk_bf16_f32 v120, v120, v121
    v_mfma_f32_16x16x32_bf16 v[204:207], v[168:171], v[240:243], v[204:207]
    v_cvt_pk_bf16_f32 v121, v122, v123
    v_cvt_pk_bf16_f32 v122, v124, v125
    v_cvt_pk_bf16_f32 v123, v126, v127
    v_permlane16_swap_b32 v112, v114
    v_permlane16_swap_b32 v113, v115
    v_permlane16_swap_b32 v120, v122
    v_permlane16_swap_b32 v121, v123
    v_mul_f32 v176, v10, v176
    v_mul_f32 v177, v10, v177
    v_mul_f32 v178, v10, v178
    v_mul_f32 v179, v10, v179
    v_mul_f32 v180, v10, v180
    v_mul_f32 v181, v10, v181
    v_mul_f32 v182, v10, v182
    v_mul_f32 v183, v10, v183
    v_cvt_pk_bf16_f32 v176, v176, v177
    v_cvt_pk_bf16_f32 v177, v178, v179
    v_cvt_pk_bf16_f32 v178, v180, v181
    v_cvt_pk_bf16_f32 v179, v182, v183
    v_mul_f32 v184, v10, v184
    v_mul_f32 v185, v10, v185
    v_mul_f32 v186, v10, v186
    v_mul_f32 v187, v10, v187
    v_mul_f32 v188, v10, v188
    v_mul_f32 v189, v10, v189
    v_mul_f32 v190, v10, v190
    v_mul_f32 v191, v10, v191
    v_cvt_pk_bf16_f32 v184, v184, v185
    v_cvt_pk_bf16_f32 v185, v186, v187
    v_cvt_pk_bf16_f32 v186, v188, v189
    v_cvt_pk_bf16_f32 v187, v190, v191
    v_permlane16_swap_b32 v176, v178
    v_permlane16_swap_b32 v177, v179
    v_permlane16_swap_b32 v184, v186
    v_permlane16_swap_b32 v185, v187
    v_mul_f32 v192, v10, v192
    v_mul_f32 v193, v10, v193
    v_mul_f32 v194, v10, v194
    v_mul_f32 v195, v10, v195
    v_mul_f32 v196, v10, v196
    v_mul_f32 v197, v10, v197
    v_mul_f32 v198, v10, v198
    v_mul_f32 v199, v10, v199
    v_cvt_pk_bf16_f32 v192, v192, v193
    v_cvt_pk_bf16_f32 v193, v194, v195
    v_cvt_pk_bf16_f32 v194, v196, v197
    v_cvt_pk_bf16_f32 v195, v198, v199
    v_mul_f32 v200, v10, v200
    v_mul_f32 v201, v10, v201
    v_mul_f32 v202, v10, v202
    v_mul_f32 v203, v10, v203
    v_mul_f32 v204, v10, v204
    v_mul_f32 v205, v10, v205
    v_mul_f32 v206, v10, v206
    v_mul_f32 v207, v10, v207
    v_cvt_pk_bf16_f32 v200, v200, v201
    v_cvt_pk_bf16_f32 v201, v202, v203
    v_cvt_pk_bf16_f32 v202, v204, v205
    v_cvt_pk_bf16_f32 v203, v206, v207
    v_permlane16_swap_b32 v192, v194
    v_permlane16_swap_b32 v193, v195
    v_permlane16_swap_b32 v200, v202
    v_permlane16_swap_b32 v201, v203
    s_barrier
    s_nop 0
    s_add_u32 m0, s59, 32768
    s_mov_b32 s50, 278528
    s_waitcnt vmcnt(13)
    s_nop 0
    buffer_load_dwordx4 v128, s[20:23], s50 offen offset:0 nt lds
    s_add_u32 m0, s59, 32768
    s_mov_b32 s50, 278528
    s_waitcnt vmcnt(13)
    s_nop 0
    buffer_load_dwordx4 v129, s[20:23], s50 offen offset:1024 nt lds
    s_add_u32 m0, s59, 32768
    s_mov_b32 s50, 278528
    s_waitcnt vmcnt(13)
    s_nop 0
    buffer_load_dwordx4 v130, s[20:23], s50 offen offset:2048 nt lds
    s_lshr_b32 s42, s40, 1
    s_and_b32 s43, s38, 12
    s_add_u32 s42, s42, s43
    s_lshl_b32 s42, s42, 18
    s_and_b32 s43, s40, 1
    s_lshl_b32 s43, s43, 16
    s_add_u32 s42, s42, s43
    s_and_b32 s43, s38, 3
    s_lshl_b32 s43, s43, 14
    s_add_u32 s42, s42, s43
    s_and_b32 s43, s36, 1
    s_lshl_b32 s43, s43, 13
    s_add_u32 s42, s42, s43
    s_add_u32 s43, s42, 0
    buffer_load_dword v147, v146, s[24:27], s43 offen
    s_lshr_b32 s42, s40, 1
    s_and_b32 s43, s38, 12
    s_add_u32 s42, s42, s43
    s_lshl_b32 s42, s42, 18
    s_and_b32 s43, s40, 1
    s_lshl_b32 s43, s43, 16
    s_add_u32 s42, s42, s43
    s_and_b32 s43, s38, 3
    s_lshl_b32 s43, s43, 14
    s_add_u32 s42, s42, s43
    s_and_b32 s43, s36, 1
    s_lshl_b32 s43, s43, 13
    s_add_u32 s42, s42, s43
    s_nop 0
    s_add_u32 s43, s42, 131072
    buffer_load_dword v147, v146, s[24:27], s43 offen
    s_and_b32 s42, s36, 1
    s_lshl_b32 s42, s42, 11
    s_add_u32 s42, s42, 98304
    v_lshlrev_b32 v1, 4, v12
    v_add_u32 v2, s42, v1
    ds_write_b128 v2, v[16:19] offset:0
    ds_write_b128 v2, v[24:27] offset:1024
    ds_write_b128 v2, v[32:35] offset:4096
    ds_write_b128 v2, v[40:43] offset:5120
    ds_write_b128 v2, v[48:51] offset:8192
    ds_write_b128 v2, v[56:59] offset:9216
    ds_write_b128 v2, v[64:67] offset:12288
    ds_write_b128 v2, v[72:75] offset:13312
    ds_write_b128 v2, v[80:83] offset:16384
    ds_write_b128 v2, v[88:91] offset:17408
    ds_write_b128 v2, v[96:99] offset:20480
    ds_write_b128 v2, v[104:107] offset:21504
    ds_write_b128 v2, v[112:115] offset:24576
    ds_write_b128 v2, v[120:123] offset:25600
    ds_write_b128 v2, v[176:179] offset:28672
    ds_write_b128 v2, v[184:187] offset:29696
    ds_write_b128 v2, v[192:195] offset:32768
    ds_write_b128 v2, v[200:203] offset:33792
    s_mov_b64 exec, 1
    s_nop 0
    v_mov_b32 v140, 163712
    v_mov_b32_e64 v141, 1
    ds_add_u32 v140, v141 offset:24
    s_mov_b64 exec, -1
    s_setprio 0
    s_add_u32 m0, s59, 32768
    s_mov_b32 s50, 278528
    s_waitcnt vmcnt(15)
    s_nop 0
    buffer_load_dwordx4 v131, s[20:23], s50 offen offset:3072 nt lds
    s_add_u32 m0, s59, 36864
    s_mov_b32 s50, 282624
    s_waitcnt vmcnt(15)
    s_nop 0
    buffer_load_dwordx4 v128, s[20:23], s50 offen offset:0 nt lds
    s_add_u32 m0, s59, 36864
    s_mov_b32 s50, 282624
    s_waitcnt vmcnt(15)
    s_nop 0
    buffer_load_dwordx4 v129, s[20:23], s50 offen offset:1024 nt lds
    s_add_u32 m0, s59, 36864
    s_mov_b32 s50, 282624
    s_waitcnt vmcnt(15)
    s_nop 0
    buffer_load_dwordx4 v130, s[20:23], s50 offen offset:2048 nt lds
    s_add_u32 m0, s59, 36864
    s_mov_b32 s50, 282624
    s_waitcnt vmcnt(15)
    s_nop 0
    buffer_load_dwordx4 v131, s[20:23], s50 offen offset:3072 nt lds
    s_add_u32 m0, s59, 40960
    s_mov_b32 s50, 286720
    s_waitcnt vmcnt(15)
    s_nop 0
    buffer_load_dwordx4 v132, s[20:23], s50 offen offset:0 nt lds
    s_add_u32 m0, s59, 40960
    s_mov_b32 s50, 286720
    s_waitcnt vmcnt(15)
    s_nop 0
    buffer_load_dwordx4 v133, s[20:23], s50 offen offset:1024 nt lds
    s_add_u32 m0, s59, 40960
    s_mov_b32 s50, 286720
    s_waitcnt vmcnt(15)
    s_nop 0
    buffer_load_dwordx4 v134, s[20:23], s50 offen offset:2048 nt lds
    s_add_u32 m0, s59, 40960
    s_mov_b32 s50, 286720
    s_waitcnt vmcnt(15)
    s_nop 0
    buffer_load_dwordx4 v135, s[20:23], s50 offen offset:3072 nt lds
    s_add_u32 m0, s59, 45056
    s_mov_b32 s50, 290816
    s_waitcnt vmcnt(15)
    s_nop 0
    buffer_load_dwordx4 v132, s[20:23], s50 offen offset:0 nt lds
    s_add_u32 m0, s59, 45056
    s_mov_b32 s50, 290816
    s_waitcnt vmcnt(15)
    s_nop 0
    buffer_load_dwordx4 v133, s[20:23], s50 offen offset:1024 nt lds
    s_add_u32 m0, s59, 45056
    s_mov_b32 s50, 290816
    s_waitcnt vmcnt(15)
    s_nop 0
    buffer_load_dwordx4 v134, s[20:23], s50 offen offset:2048 nt lds
    s_add_u32 m0, s59, 45056
    s_mov_b32 s50, 290816
    s_waitcnt vmcnt(15)
    s_nop 0
    buffer_load_dwordx4 v135, s[20:23], s50 offen offset:3072 nt lds
    s_waitcnt lgkmcnt(0)
    s_nop 0
    v_mov_b32 v140, 163712
L_mxw:
    s_sleep 1
    s_nop 0
    ds_read_b32 v141, v140 offset:20
    s_waitcnt lgkmcnt(0)
    v_readfirstlane_b32 s42, v141
    s_nop 0
    s_cmp_lt_u32 s42, 6
    s_cbranch_scc1 L_mxw
    s_nop 0
    s_add_u32 m0, s59, 65536
    s_mov_b32 s50, 294912
    s_waitcnt vmcnt(15)
    s_nop 0
    buffer_load_dwordx4 v128, s[20:23], s50 offen offset:0 nt lds
    s_add_u32 m0, s59, 65536
    s_mov_b32 s50, 294912
    s_waitcnt vmcnt(13)
    s_nop 0
    buffer_load_dwordx4 v129, s[20:23], s50 offen offset:1024 nt lds
    s_add_u32 m0, s59, 65536
    s_mov_b32 s50, 294912
    s_waitcnt vmcnt(13)
    s_nop 0
    buffer_load_dwordx4 v130, s[20:23], s50 offen offset:2048 nt lds
    s_add_u32 m0, s59, 65536
    s_mov_b32 s50, 294912
    s_waitcnt vmcnt(13)
    s_nop 0
    buffer_load_dwordx4 v131, s[20:23], s50 offen offset:3072 nt lds
    s_add_u32 m0, s59, 69632
    s_mov_b32 s50, 299008
    s_waitcnt vmcnt(13)
    s_nop 0
    buffer_load_dwordx4 v128, s[20:23], s50 offen offset:0 nt lds
    s_add_u32 m0, s59, 69632
    s_mov_b32 s50, 299008
    s_waitcnt vmcnt(13)
    s_nop 0
    buffer_load_dwordx4 v129, s[20:23], s50 offen offset:1024 nt lds
    s_add_u32 m0, s59, 69632
    s_mov_b32 s50, 299008
    s_waitcnt vmcnt(13)
    s_nop 0
    buffer_load_dwordx4 v130, s[20:23], s50 offen offset:2048 nt lds
    s_add_u32 m0, s59, 69632
    s_mov_b32 s50, 299008
    s_waitcnt vmcnt(13)
    s_nop 0
    buffer_load_dwordx4 v131, s[20:23], s50 offen offset:3072 nt lds
    s_barrier
    s_nop 0
    s_add_u32 m0, s59, 73728
    s_mov_b32 s50, 303104
    s_waitcnt vmcnt(13)
    s_nop 0
    buffer_load_dwordx4 v132, s[20:23], s50 offen offset:0 nt lds
    s_add_u32 m0, s59, 73728
    s_mov_b32 s50, 303104
    s_waitcnt vmcnt(13)
    s_nop 0
    buffer_load_dwordx4 v133, s[20:23], s50 offen offset:1024 nt lds
    s_add_u32 m0, s59, 73728
    s_mov_b32 s50, 303104
    s_waitcnt vmcnt(13)
    s_nop 0
    buffer_load_dwordx4 v134, s[20:23], s50 offen offset:2048 nt lds
    s_add_u32 m0, s59, 73728
    s_mov_b32 s50, 303104
    s_waitcnt vmcnt(13)
    s_nop 0
    buffer_load_dwordx4 v135, s[20:23], s50 offen offset:3072 nt lds
    s_add_u32 m0, s59, 77824
    s_mov_b32 s50, 307200
    s_waitcnt vmcnt(13)
    s_nop 0
    buffer_load_dwordx4 v132, s[20:23], s50 offen offset:0 nt lds
    s_add_u32 m0, s59, 77824
    s_mov_b32 s50, 307200
    s_waitcnt vmcnt(13)
    s_nop 0
    buffer_load_dwordx4 v133, s[20:23], s50 offen offset:1024 nt lds
    s_add_u32 m0, s59, 77824
    s_mov_b32 s50, 307200
    s_waitcnt vmcnt(13)
    s_nop 0
    buffer_load_dwordx4 v134, s[20:23], s50 offen offset:2048 nt lds
    s_add_u32 m0, s59, 77824
    s_mov_b32 s50, 307200
    s_waitcnt vmcnt(13)
    s_nop 0
    buffer_load_dwordx4 v135, s[20:23], s50 offen offset:3072 nt lds
    s_and_b32 s44, s36, 1
    s_nop 0
    s_mul_i32 s42, s44, 4096
    s_add_u32 s42, s42, 135168
    v_add_u32 v140, s42, v1
    s_lshl_b32 s42, s44, 11
    s_add_u32 s42, s42, 98304
    v_add_u32_e64 v141, s42, v1
    ds_read_b128 v[16:19], v140 offset:0
    ds_read_b128 v[20:23], v140 offset:1024
    ds_read_b128 v[24:27], v140 offset:2048
    ds_read_b128 v[28:31], v140 offset:3072
    ds_read_b128 v[32:35], v141 offset:0
    ds_read_b128 v[36:39], v141 offset:1024
    ds_read_b128 v[40:43], v140 offset:8192
    ds_read_b128 v[44:47], v140 offset:9216
    ds_read_b128 v[48:51], v140 offset:10240
    ds_read_b128 v[52:55], v140 offset:11264
    ds_read_b128 v[56:59], v141 offset:12288
    ds_read_b128 v[60:63], v141 offset:13312
    ds_read_b128 v[64:67], v140 offset:16384
    ds_read_b128 v[68:71], v140 offset:17408
    ds_read_b128 v[72:75], v140 offset:18432
    ds_read_b128 v[76:79], v140 offset:19456
    ds_read_b128 v[80:83], v141 offset:24576
    ds_read_b128 v[84:87], v141 offset:25600
    s_mul_i32 s43, s38, 73728
    s_mul_i32 s44, s44, 18432
    s_add_u32 s43, s43, 18432
    s_sub_u32 s43, s43, s44
    s_add_u32 s42, s43, 0
    s_waitcnt lgkmcnt(14)
    s_nop 0
    buffer_store_dwordx4 v[16:19], v1, s[16:19], s42 offen sc1
    s_add_u32 s42, s43, 9216
    buffer_store_dwordx4 v[20:23], v1, s[16:19], s42 offen sc1
    s_add_u32 s42, s43, 1024
    buffer_store_dwordx4 v[24:27], v1, s[16:19], s42 offen sc1
    s_add_u32 s42, s43, 10240
    buffer_store_dwordx4 v[28:31], v1, s[16:19], s42 offen sc1
    s_add_u32 s42, s43, 2048
    s_waitcnt lgkmcnt(13)
    s_nop 0
    buffer_store_dwordx4 v[32:35], v1, s[16:19], s42 offen sc1
    s_add_u32 s42, s43, 11264
    s_waitcnt lgkmcnt(12)
    s_nop 0
    buffer_store_dwordx4 v[36:39], v1, s[16:19], s42 offen sc1
    s_add_u32 s42, s43, 3072
    s_waitcnt lgkmcnt(11)
    s_nop 0
    buffer_store_dwordx4 v[40:43], v1, s[16:19], s42 offen sc1
    s_add_u32 s42, s43, 12288
    s_waitcnt lgkmcnt(10)
    s_nop 0
    buffer_store_dwordx4 v[44:47], v1, s[16:19], s42 offen sc1
    s_add_u32 s42, s43, 4096
    s_waitcnt lgkmcnt(9)
    s_nop 0
    buffer_store_dwordx4 v[48:51], v1, s[16:19], s42 offen sc1
    s_add_u32 s42, s43, 13312
    s_waitcnt lgkmcnt(8)
    s_nop 0
    buffer_store_dwordx4 v[52:55], v1, s[16:19], s42 offen sc1
    s_add_u32 s42, s43, 5120
    s_waitcnt lgkmcnt(7)
    s_nop 0
    buffer_store_dwordx4 v[56:59], v1, s[16:19], s42 offen sc1
    s_add_u32 s42, s43, 14336
    s_waitcnt lgkmcnt(6)
    s_nop 0
    buffer_store_dwordx4 v[60:63], v1, s[16:19], s42 offen sc1
    s_add_u32 s42, s43, 6144
    s_waitcnt lgkmcnt(5)
    s_nop 0
    buffer_store_dwordx4 v[64:67], v1, s[16:19], s42 offen sc1
    s_add_u32 s42, s43, 15360
    s_waitcnt lgkmcnt(4)
    s_nop 0
    buffer_store_dwordx4 v[68:71], v1, s[16:19], s42 offen sc1
    s_add_u32 s42, s43, 7168
    s_waitcnt lgkmcnt(3)
    s_nop 0
    buffer_store_dwordx4 v[72:75], v1, s[16:19], s42 offen sc1
    s_add_u32 s42, s43, 16384
    s_waitcnt lgkmcnt(2)
    s_nop 0
    buffer_store_dwordx4 v[76:79], v1, s[16:19], s42 offen sc1
    s_add_u32 s42, s43, 8192
    s_waitcnt lgkmcnt(1)
    s_nop 0
    buffer_store_dwordx4 v[80:83], v1, s[16:19], s42 offen sc1
    s_add_u32 s42, s43, 17408
    s_waitcnt lgkmcnt(0)
    s_nop 0
    buffer_store_dwordx4 v[84:87], v1, s[16:19], s42 offen sc1
    s_mov_b32 s49, s58
    v_and_b32 v12, 63, v0
    v_lshrrev_b32 v13, 4, v12
    v_and_b32 v14, 15, v12
    v_bfe_u32 v15, v12, 2, 2
    v_lshlrev_b32_e64 v1, 4, v12
    v_add_u32 v8, 4096, v1
    v_lshrrev_b32 v9, 5, v12
    v_and_b32 v4, 3, v12
    v_lshlrev_b32 v5, 1, v9
    v_xor_b32 v4, v4, v5
    v_lshlrev_b32 v4, 4, v4
    v_and_b32 v5, 1, v13
    v_lshl_add_u32 v4, v5, 6, v4
    v_lshl_add_u32 v4, v15, 10, v4
    v_lshl_add_u32 v4, v9, 12, v4
    s_and_b32 s42, s38, 3
    s_lshl_b32 s42, s42, 8
    s_and_b32 s43, s36, 1
    s_lshl_b32 s43, s43, 7
    s_add_u32 s42, s42, s43
    v_add_u32 v4, s42, v4
    v_and_b32 v2, 3, v12
    v_lshlrev_b32 v2, 3, v2
    v_lshl_add_u32 v2, v15, 6, v2
    v_lshl_add_u32 v2, v5, 5, v2
    v_lshl_add_u32 v2, v13, 9, v2
    v_add_u32 v2, s49, v2
    v_xor_b32 v3, 32, v2
    v_add_u32 v5, 7168, v4
    v_add_u32 v6, 14336, v4
    v_add_u32 v7, 21504, v4
    v_add_u32 v9, 8192, v1
    v_lshlrev_b32 v11, 7, v14
    s_lshr_b32 s42, s38, 2
    v_mov_b32 v10, 0x10000
    v_cmp_eq_u32 vcc, s42, v15
    s_nop 1
    v_cndmask_b32 v11, v10, v11, vcc
    v_mov_b32 v15, 3
    v_lshrrev_b32 v15, v13, v15
    v_lshlrev_b32 v15, 29, v15
    s_and_b32 s83, s36, 1
    s_lshl_b32 s83, s83, 1
    s_add_u32 s83, s83, 0
    v_mov_b32 v8, v1
    v_add_u32 v9, 69632, v1
    s_barrier
    s_add_u32 m0, s59, 0
    s_mov_b32 s50, 311296
    s_waitcnt vmcnt(31)
    s_nop 0
    buffer_load_dwordx4 v128, s[20:23], s50 offen offset:0 nt lds
    s_add_u32 m0, s59, 0
    s_nop 0
    s_mov_b32 s50, 311296
    s_waitcnt vmcnt(31)
    s_nop 0
    buffer_load_dwordx4 v129, s[20:23], s50 offen offset:1024 nt lds
    s_add_u32 m0, s59, 0
    s_nop 0
    s_mov_b32 s50, 311296
    s_waitcnt vmcnt(31)
    s_nop 0
    buffer_load_dwordx4 v130, s[20:23], s50 offen offset:2048 nt lds
    s_and_b32 s42, s36, 1
    s_xor_b32 s42, s42, 1
    s_mul_i32 s42, s42, 18432
    s_add_u32 s42, s42, 98304
    v_add_u32_e64 v140, s42, v1
    ds_write_b128 v140, v[16:19] offset:0
    ds_write_b128 v140, v[20:23] offset:9216
    ds_write_b128 v140, v[24:27] offset:1024
    ds_write_b128 v140, v[28:31] offset:10240
    ds_write_b128 v140, v[32:35] offset:2048
    ds_write_b128 v140, v[36:39] offset:11264
    ds_write_b128 v140, v[40:43] offset:3072
    ds_write_b128 v140, v[44:47] offset:12288
    ds_write_b128 v140, v[48:51] offset:4096
    ds_write_b128 v140, v[52:55] offset:13312
    ds_write_b128 v140, v[56:59] offset:5120
    ds_write_b128 v140, v[60:63] offset:14336
    ds_write_b128 v140, v[64:67] offset:6144
    ds_write_b128 v140, v[68:71] offset:15360
    ds_write_b128 v140, v[72:75] offset:7168
    ds_write_b128 v140, v[76:79] offset:16384
    ds_write_b128 v140, v[80:83] offset:8192
    ds_write_b128 v140, v[84:87] offset:17408
    s_add_u32 s44, s38, 0
    s_and_b32 s44, s44, 3
    s_and_b32 s43, s38, 12
    s_add_u32 s44, s44, s43
    s_lshl_b32 s44, s44, 3
    s_lshl_b32 s43, s44, 15
    s_add_u32 s43, s43, 0
    s_add_u32 m0, s58, 0
    s_nop 0
    s_nop 0
    buffer_load_dwordx4 v4, s[24:27], s43 offen offset:0 lds
    buffer_load_dwordx4 v5, s[24:27], s43 offen offset:1024 lds
    buffer_load_dwordx4 v6, s[24:27], s43 offen offset:2048 lds
    buffer_load_dwordx4 v7, s[24:27], s43 offen offset:3072 lds
    s_add_u32 s44, s38, 0
    s_and_b32 s44, s44, 3
    s_and_b32 s43, s38, 12
    s_add_u32 s44, s44, s43
    s_lshl_b32 s44, s44, 3
    s_lshl_b32 s43, s44, 15
    s_add_u32 s43, s43, 32768
    s_add_u32 m0, s58, 4096
    s_nop 0
    s_nop 0
    buffer_load_dwordx4 v4, s[24:27], s43 offen offset:0 lds
    buffer_load_dwordx4 v5, s[24:27], s43 offen offset:1024 lds
    buffer_load_dwordx4 v6, s[24:27], s43 offen offset:2048 lds
    buffer_load_dwordx4 v7, s[24:27], s43 offen offset:3072 lds
    s_add_u32 s44, s38, 0
    s_and_b32 s44, s44, 3
    s_and_b32 s43, s38, 12
    s_add_u32 s44, s44, s43
    s_lshl_b32 s44, s44, 3
    s_lshl_b32 s43, s44, 15
    s_add_u32 s43, s43, 65536
    s_add_u32 m0, s58, 8192
    s_nop 0
    s_nop 0
    buffer_load_dwordx4 v4, s[24:27], s43 offen offset:0 lds
    buffer_load_dwordx4 v5, s[24:27], s43 offen offset:1024 lds
    buffer_load_dwordx4 v6, s[24:27], s43 offen offset:2048 lds
    buffer_load_dwordx4 v7, s[24:27], s43 offen offset:3072 lds
    s_waitcnt lgkmcnt(0)
    s_add_u32 m0, s59, 0
    s_mov_b32 s50, 311296
    s_waitcnt vmcnt(43)
    s_nop 0
    buffer_load_dwordx4 v131, s[20:23], s50 offen offset:3072 nt lds
    s_add_u32 m0, s59, 4096
    s_mov_b32 s50, 315392
    s_waitcnt vmcnt(43)
    s_nop 0
    buffer_load_dwordx4 v128, s[20:23], s50 offen offset:0 nt lds
    s_add_u32 m0, s59, 4096
    s_mov_b32 s50, 315392
    s_waitcnt vmcnt(43)
    s_nop 0
    buffer_load_dwordx4 v129, s[20:23], s50 offen offset:1024 nt lds
    s_add_u32 m0, s59, 4096
    s_mov_b32 s50, 315392
    s_waitcnt vmcnt(43)
    s_nop 0
    buffer_load_dwordx4 v130, s[20:23], s50 offen offset:2048 nt lds
    s_add_u32 m0, s59, 4096
    s_mov_b32 s50, 315392
    s_waitcnt vmcnt(43)
    s_nop 0
    buffer_load_dwordx4 v131, s[20:23], s50 offen offset:3072 nt lds
    s_add_u32 m0, s59, 8192
    s_mov_b32 s50, 319488
    s_waitcnt vmcnt(43)
    s_nop 0
    buffer_load_dwordx4 v132, s[20:23], s50 offen offset:0 nt lds
    s_add_u32 m0, s59, 8192
    s_mov_b32 s50, 319488
    s_waitcnt vmcnt(43)
    s_nop 0
    buffer_load_dwordx4 v133, s[20:23], s50 offen offset:1024 nt lds
    s_add_u32 m0, s59, 8192
    s_mov_b32 s50, 319488
    s_waitcnt vmcnt(43)
    s_nop 0
    buffer_load_dwordx4 v134, s[20:23], s50 offen offset:2048 nt lds
    s_add_u32 m0, s59, 8192
    s_mov_b32 s50, 319488
    s_waitcnt vmcnt(43)
    s_nop 0
    buffer_load_dwordx4 v135, s[20:23], s50 offen offset:3072 nt lds
    s_add_u32 m0, s59, 12288
    s_mov_b32 s50, 323584
    s_waitcnt vmcnt(43)
    s_nop 0
    buffer_load_dwordx4 v132, s[20:23], s50 offen offset:0 nt lds
    s_add_u32 m0, s59, 12288
    s_mov_b32 s50, 323584
    s_waitcnt vmcnt(43)
    s_nop 0
    buffer_load_dwordx4 v133, s[20:23], s50 offen offset:1024 nt lds
    s_add_u32 m0, s59, 12288
    s_mov_b32 s50, 323584
    s_waitcnt vmcnt(25)
    s_nop 0
    buffer_load_dwordx4 v134, s[20:23], s50 offen offset:2048 nt lds
    s_add_u32 m0, s59, 12288
    s_mov_b32 s50, 323584
    s_waitcnt vmcnt(25)
    s_nop 0
    buffer_load_dwordx4 v135, s[20:23], s50 offen offset:3072 nt lds
    s_barrier
    s_nop 0
    s_add_u32 m0, s59, 32768
    s_mov_b32 s50, 327680
    s_waitcnt vmcnt(25)
    s_nop 0
    buffer_load_dwordx4 v128, s[20:23], s50 offen offset:0 nt lds
    s_add_u32 m0, s59, 32768
    s_mov_b32 s50, 327680
    s_waitcnt vmcnt(13)
    s_nop 0
    buffer_load_dwordx4 v129, s[20:23], s50 offen offset:1024 nt lds
    s_add_u32 m0, s59, 32768
    s_mov_b32 s50, 327680
    s_waitcnt vmcnt(13)
    s_nop 0
    buffer_load_dwordx4 v130, s[20:23], s50 offen offset:2048 nt lds
    ds_read_b64_tr_b16 v[156:157], v2 offset:0
    ds_read_b64_tr_b16 v[158:159], v2 offset:2048
    ds_read_b64_tr_b16 v[160:161], v3 offset:0
    ds_read_b64_tr_b16 v[162:163], v3 offset:2048
    ds_read_b64_tr_b16 v[164:165], v2 offset:256
    ds_read_b64_tr_b16 v[166:167], v2 offset:2304
    ds_read_b64_tr_b16 v[168:169], v3 offset:256
    ds_read_b64_tr_b16 v[170:171], v3 offset:2304
    ds_read_b128 v[208:211], v9 offset:28672
    ds_read_b128 v[212:215], v9 offset:29696
    ds_read_b128 v[216:219], v9 offset:30720
    ds_read_b128 v[220:223], v9 offset:31744
    ds_read_b128 v[224:227], v9 offset:32768
    ds_read_b128 v[228:231], v9 offset:33792
    ds_read_b128 v[232:235], v9 offset:34816
    ds_read_b128 v[236:239], v9 offset:35840
    ds_read_b128 v[240:243], v9 offset:36864
    s_add_u32 m0, s59, 32768
    s_mov_b32 s50, 327680
    s_waitcnt vmcnt(13)
    s_nop 0
    buffer_load_dwordx4 v131, s[20:23], s50 offen offset:3072 nt lds
    s_add_u32 m0, s59, 36864
    s_mov_b32 s50, 331776
    s_waitcnt vmcnt(13)
    s_nop 0
    buffer_load_dwordx4 v128, s[20:23], s50 offen offset:0 nt lds
    s_waitcnt lgkmcnt(9)
    s_add_u32 s44, s38, 0
    s_and_b32 s44, s44, 3
    s_and_b32 s43, s38, 12
    s_add_u32 s44, s44, s43
    s_lshl_b32 s44, s44, 3
    s_lshl_b32 s43, s44, 15
    s_nop 0
    s_add_u32 s43, s43, 98304
    s_add_u32 m0, s58, 0
    s_nop 0
    buffer_load_dwordx4 v4, s[24:27], s43 offen offset:0 lds
    buffer_load_dwordx4 v5, s[24:27], s43 offen offset:1024 lds
    buffer_load_dwordx4 v6, s[24:27], s43 offen offset:2048 lds
    buffer_load_dwordx4 v7, s[24:27], s43 offen offset:3072 lds
    s_waitcnt lgkmcnt(0)
    s_nop 0
    v_mfma_f32_16x16x32_bf16 v[16:19], v[156:159], v[208:211], 0
    s_add_u32 m0, s59, 36864
    s_mov_b32 s50, 331776
    s_waitcnt vmcnt(17)
    s_nop 0
    buffer_load_dwordx4 v129, s[20:23], s50 offen offset:1024 nt lds
    v_mfma_f32_16x16x32_bf16 v[20:23], v[160:163], v[208:211], 0
    v_mfma_f32_16x16x32_bf16 v[24:27], v[164:167], v[208:211], 0
    v_mfma_f32_16x16x32_bf16 v[28:31], v[168:171], v[208:211], 0
    v_mfma_f32_16x16x32_bf16 v[32:35], v[156:159], v[212:215], 0
    s_add_u32 m0, s59, 36864
    s_mov_b32 s50, 331776
    s_waitcnt vmcnt(17)
    s_nop 0
    buffer_load_dwordx4 v130, s[20:23], s50 offen offset:2048 nt lds
    v_mfma_f32_16x16x32_bf16 v[36:39], v[160:163], v[212:215], 0
    v_mfma_f32_16x16x32_bf16 v[40:43], v[164:167], v[212:215], 0
    v_mfma_f32_16x16x32_bf16 v[44:47], v[168:171], v[212:215], 0
    s_add_u32 m0, s59, 36864
    s_mov_b32 s50, 331776
    s_waitcnt vmcnt(17)
    s_nop 0
    buffer_load_dwordx4 v131, s[20:23], s50 offen offset:3072 nt lds
    v_mfma_f32_16x16x32_bf16 v[48:51], v[156:159], v[216:219], 0
    v_mfma_f32_16x16x32_bf16 v[52:55], v[160:163], v[216:219], 0
    v_mfma_f32_16x16x32_bf16 v[56:59], v[164:167], v[216:219], 0
    s_add_u32 m0, s59, 40960
    s_mov_b32 s50, 335872
    s_waitcnt vmcnt(17)
    s_nop 0
    buffer_load_dwordx4 v132, s[20:23], s50 offen offset:0 nt lds
    v_mfma_f32_16x16x32_bf16 v[60:63], v[168:171], v[216:219], 0
    v_mfma_f32_16x16x32_bf16 v[64:67], v[156:159], v[220:223], 0
    v_mfma_f32_16x16x32_bf16 v[68:71], v[160:163], v[220:223], 0
    v_mfma_f32_16x16x32_bf16 v[72:75], v[164:167], v[220:223], 0
    s_add_u32 m0, s59, 40960
    s_mov_b32 s50, 335872
    s_waitcnt vmcnt(17)
    s_nop 0
    buffer_load_dwordx4 v133, s[20:23], s50 offen offset:1024 nt lds
    v_mfma_f32_16x16x32_bf16 v[76:79], v[168:171], v[220:223], 0
    v_mfma_f32_16x16x32_bf16 v[80:83], v[156:159], v[224:227], 0
    v_mfma_f32_16x16x32_bf16 v[84:87], v[160:163], v[224:227], 0
    s_add_u32 m0, s59, 40960
    s_mov_b32 s50, 335872
    s_waitcnt vmcnt(17)
    s_nop 0
    buffer_load_dwordx4 v134, s[20:23], s50 offen offset:2048 nt lds
    v_mfma_f32_16x16x32_bf16 v[88:91], v[164:167], v[224:227], 0
    v_mfma_f32_16x16x32_bf16 v[92:95], v[168:171], v[224:227], 0
    v_mfma_f32_16x16x32_bf16 v[96:99], v[156:159], v[228:231], 0
    s_add_u32 m0, s59, 40960
    s_mov_b32 s50, 335872
    s_waitcnt vmcnt(17)
    s_nop 0
    buffer_load_dwordx4 v135, s[20:23], s50 offen offset:3072 nt lds
    v_mfma_f32_16x16x32_bf16 v[100:103], v[160:163], v[228:231], 0
    v_mfma_f32_16x16x32_bf16 v[104:107], v[164:167], v[228:231], 0
    v_mfma_f32_16x16x32_bf16 v[108:111], v[168:171], v[228:231], 0
    s_add_u32 m0, s59, 45056
    s_mov_b32 s50, 339968
    s_waitcnt vmcnt(17)
    s_nop 0
    buffer_load_dwordx4 v132, s[20:23], s50 offen offset:0 nt lds
    v_mfma_f32_16x16x32_bf16 v[112:115], v[156:159], v[232:235], 0
    v_mfma_f32_16x16x32_bf16 v[116:119], v[160:163], v[232:235], 0
    v_mfma_f32_16x16x32_bf16 v[120:123], v[164:167], v[232:235], 0
    v_mfma_f32_16x16x32_bf16 v[124:127], v[168:171], v[232:235], 0
    s_add_u32 m0, s59, 45056
    s_mov_b32 s50, 339968
    s_waitcnt vmcnt(17)
    s_nop 0
    buffer_load_dwordx4 v133, s[20:23], s50 offen offset:1024 nt lds
    v_mfma_f32_16x16x32_bf16 v[176:179], v[156:159], v[236:239], 0
    v_mfma_f32_16x16x32_bf16 v[180:183], v[160:163], v[236:239], 0
    v_mfma_f32_16x16x32_bf16 v[184:187], v[164:167], v[236:239], 0
    s_add_u32 m0, s59, 45056
    s_mov_b32 s50, 339968
    s_waitcnt vmcnt(17)
    s_nop 0
    buffer_load_dwordx4 v134, s[20:23], s50 offen offset:2048 nt lds
    v_mfma_f32_16x16x32_bf16 v[188:191], v[168:171], v[236:239], 0
    v_mfma_f32_16x16x32_bf16 v[192:195], v[156:159], v[240:243], 0
    v_mfma_f32_16x16x32_bf16 v[196:199], v[160:163], v[240:243], 0
    s_add_u32 m0, s59, 45056
    s_mov_b32 s50, 339968
    s_waitcnt vmcnt(17)
    s_nop 0
    buffer_load_dwordx4 v135, s[20:23], s50 offen offset:3072 nt lds
    v_mfma_f32_16x16x32_bf16 v[200:203], v[164:167], v[240:243], 0
    v_mfma_f32_16x16x32_bf16 v[204:207], v[168:171], v[240:243], 0
    s_cmp_lg_u32 s36, 6
    s_cbranch_scc1 L_nopub
    s_lshl_b32 s42, s38, 7
    v_mov_b32 v140, s42
    v_mov_b32_e64 v141, s84
    buffer_store_dword v141, v140, s[4:7], 0 offen sc1
L_nopub:
    s_barrier
    s_nop 0
    s_add_u32 m0, s59, 65536
    s_mov_b32 s50, 344064
    s_waitcnt vmcnt(17)
    s_nop 0
    buffer_load_dwordx4 v128, s[20:23], s50 offen offset:0 nt lds
    s_add_u32 m0, s59, 65536
    s_mov_b32 s50, 344064
    s_waitcnt vmcnt(17)
    s_nop 0
    buffer_load_dwordx4 v129, s[20:23], s50 offen offset:1024 nt lds
    s_add_u32 m0, s59, 65536
    s_mov_b32 s50, 344064
    s_waitcnt vmcnt(17)
    s_nop 0
    buffer_load_dwordx4 v130, s[20:23], s50 offen offset:2048 nt lds
    ds_read_b64_tr_b16 v[156:157], v2 offset:4096
    ds_read_b64_tr_b16 v[158:159], v2 offset:6144
    ds_read_b64_tr_b16 v[160:161], v3 offset:4096
    ds_read_b64_tr_b16 v[162:163], v3 offset:6144
    ds_read_b64_tr_b16 v[164:165], v2 offset:4352
    ds_read_b64_tr_b16 v[166:167], v2 offset:6400
    ds_read_b64_tr_b16 v[168:169], v3 offset:4352
    ds_read_b64_tr_b16 v[170:171], v3 offset:6400
    ds_read_b128 v[208:211], v9 offset:37888
    ds_read_b128 v[212:215], v9 offset:38912
    ds_read_b128 v[216:219], v9 offset:39936
    ds_read_b128 v[220:223], v9 offset:40960
    ds_read_b128 v[224:227], v9 offset:41984
    ds_read_b128 v[228:231], v9 offset:43008
    ds_read_b128 v[232:235], v9 offset:44032
    ds_read_b128 v[236:239], v9 offset:45056
    ds_read_b128 v[240:243], v9 offset:46080
    s_add_u32 m0, s59, 65536
    s_mov_b32 s50, 344064
    s_waitcnt vmcnt(13)
    s_nop 0
    buffer_load_dwordx4 v131, s[20:23], s50 offen offset:3072 nt lds
    s_add_u32 m0, s59, 69632
    s_mov_b32 s50, 348160
    s_waitcnt vmcnt(13)
    s_nop 0
    buffer_load_dwordx4 v128, s[20:23], s50 offen offset:0 nt lds
    s_waitcnt lgkmcnt(9)
    s_add_u32 s44, s38, 1
    s_and_b32 s44, s44, 3
    s_and_b32 s43, s38, 12
    s_add_u32 s44, s44, s43
    s_lshl_b32 s44, s44, 3
    s_lshl_b32 s43, s44, 15
    s_add_u32 s43, s43, 0
    s_add_u32 m0, s58, 4096
    s_nop 0
    s_nop 0
    buffer_load_dwordx4 v4, s[24:27], s43 offen offset:0 lds
    buffer_load_dwordx4 v5, s[24:27], s43 offen offset:1024 lds
    buffer_load_dwordx4 v6, s[24:27], s43 offen offset:2048 lds
    buffer_load_dwordx4 v7, s[24:27], s43 offen offset:3072 lds
    s_waitcnt lgkmcnt(0)
    s_nop 0
    v_mfma_f32_16x16x32_bf16 v[16:19], v[156:159], v[208:211], v[16:19]
    s_add_u32 m0, s59, 69632
    s_mov_b32 s50, 348160
    s_waitcnt vmcnt(17)
    s_nop 0
    buffer_load_dwordx4 v129, s[20:23], s50 offen offset:1024 nt lds
    v_mfma_f32_16x16x32_bf16 v[20:23], v[160:163], v[208:211], v[20:23]
    v_mfma_f32_16x16x32_bf16 v[24:27], v[164:167], v[208:211], v[24:27]
    v_mfma_f32_16x16x32_bf16 v[28:31], v[168:171], v[208:211], v[28:31]
    v_mfma_f32_16x16x32_bf16 v[32:35], v[156:159], v[212:215], v[32:35]
    s_add_u32 m0, s59, 69632
    s_mov_b32 s50, 348160
    s_waitcnt vmcnt(17)
    s_nop 0
    buffer_load_dwordx4 v130, s[20:23], s50 offen offset:2048 nt lds
    v_mfma_f32_16x16x32_bf16 v[36:39], v[160:163], v[212:215], v[36:39]
    v_mfma_f32_16x16x32_bf16 v[40:43], v[164:167], v[212:215], v[40:43]
    v_mfma_f32_16x16x32_bf16 v[44:47], v[168:171], v[212:215], v[44:47]
    s_add_u32 m0, s59, 69632
    s_mov_b32 s50, 348160
    s_waitcnt vmcnt(17)
    s_nop 0
    buffer_load_dwordx4 v131, s[20:23], s50 offen offset:3072 nt lds
    v_mfma_f32_16x16x32_bf16 v[48:51], v[156:159], v[216:219], v[48:51]
    v_mfma_f32_16x16x32_bf16 v[52:55], v[160:163], v[216:219], v[52:55]
    v_mfma_f32_16x16x32_bf16 v[56:59], v[164:167], v[216:219], v[56:59]
    s_add_u32 m0, s59, 73728
    s_mov_b32 s50, 352256
    s_waitcnt vmcnt(17)
    s_nop 0
    buffer_load_dwordx4 v132, s[20:23], s50 offen offset:0 nt lds
    v_mfma_f32_16x16x32_bf16 v[60:63], v[168:171], v[216:219], v[60:63]
    v_mfma_f32_16x16x32_bf16 v[64:67], v[156:159], v[220:223], v[64:67]
    v_mfma_f32_16x16x32_bf16 v[68:71], v[160:163], v[220:223], v[68:71]
    v_mfma_f32_16x16x32_bf16 v[72:75], v[164:167], v[220:223], v[72:75]
    s_add_u32 m0, s59, 73728
    s_mov_b32 s50, 352256
    s_waitcnt vmcnt(17)
    s_nop 0
    buffer_load_dwordx4 v133, s[20:23], s50 offen offset:1024 nt lds
    v_mfma_f32_16x16x32_bf16 v[76:79], v[168:171], v[220:223], v[76:79]
    v_mfma_f32_16x16x32_bf16 v[80:83], v[156:159], v[224:227], v[80:83]
    v_mfma_f32_16x16x32_bf16 v[84:87], v[160:163], v[224:227], v[84:87]
    s_add_u32 m0, s59, 73728
    s_mov_b32 s50, 352256
    s_waitcnt vmcnt(17)
    s_nop 0
    buffer_load_dwordx4 v134, s[20:23], s50 offen offset:2048 nt lds
    v_mfma_f32_16x16x32_bf16 v[88:91], v[164:167], v[224:227], v[88:91]
    v_mfma_f32_16x16x32_bf16 v[92:95], v[168:171], v[224:227], v[92:95]
    v_mfma_f32_16x16x32_bf16 v[96:99], v[156:159], v[228:231], v[96:99]
    s_add_u32 m0, s59, 73728
    s_mov_b32 s50, 352256
    s_waitcnt vmcnt(17)
    s_nop 0
    buffer_load_dwordx4 v135, s[20:23], s50 offen offset:3072 nt lds
    v_mfma_f32_16x16x32_bf16 v[100:103], v[160:163], v[228:231], v[100:103]
    v_mfma_f32_16x16x32_bf16 v[104:107], v[164:167], v[228:231], v[104:107]
    v_mfma_f32_16x16x32_bf16 v[108:111], v[168:171], v[228:231], v[108:111]
    s_add_u32 m0, s59, 77824
    s_mov_b32 s50, 356352
    s_waitcnt vmcnt(17)
    s_nop 0
    buffer_load_dwordx4 v132, s[20:23], s50 offen offset:0 nt lds
    v_mfma_f32_16x16x32_bf16 v[112:115], v[156:159], v[232:235], v[112:115]
    v_mfma_f32_16x16x32_bf16 v[116:119], v[160:163], v[232:235], v[116:119]
    v_mfma_f32_16x16x32_bf16 v[120:123], v[164:167], v[232:235], v[120:123]
    v_mfma_f32_16x16x32_bf16 v[124:127], v[168:171], v[232:235], v[124:127]
    s_add_u32 m0, s59, 77824
    s_mov_b32 s50, 356352
    s_waitcnt vmcnt(17)
    s_nop 0
    buffer_load_dwordx4 v133, s[20:23], s50 offen offset:1024 nt lds
    v_mfma_f32_16x16x32_bf16 v[176:179], v[156:159], v[236:239], v[176:179]
    v_mfma_f32_16x16x32_bf16 v[180:183], v[160:163], v[236:239], v[180:183]
    v_mfma_f32_16x16x32_bf16 v[184:187], v[164:167], v[236:239], v[184:187]
    s_add_u32 m0, s59, 77824
    s_mov_b32 s50, 356352
    s_waitcnt vmcnt(17)
    s_nop 0
    buffer_load_dwordx4 v134, s[20:23], s50 offen offset:2048 nt lds
    v_mfma_f32_16x16x32_bf16 v[188:191], v[168:171], v[236:239], v[188:191]
    v_mfma_f32_16x16x32_bf16 v[192:195], v[156:159], v[240:243], v[192:195]
    v_mfma_f32_16x16x32_bf16 v[196:199], v[160:163], v[240:243], v[196:199]
    s_add_u32 m0, s59, 77824
    s_mov_b32 s50, 356352
    s_waitcnt vmcnt(17)
    s_nop 0
    buffer_load_dwordx4 v135, s[20:23], s50 offen offset:3072 nt lds
    v_mfma_f32_16x16x32_bf16 v[200:203], v[164:167], v[240:243], v[200:203]
    v_mfma_f32_16x16x32_bf16 v[204:207], v[168:171], v[240:243], v[204:207]
    s_barrier
    s_add_u32 m0, s59, 0
    s_mov_b32 s50, 360448
    s_waitcnt vmcnt(17)
    s_nop 0
    buffer_load_dwordx4 v128, s[20:23], s50 offen offset:0 nt lds
    s_add_u32 m0, s59, 0
    s_nop 0
    s_mov_b32 s50, 360448
    s_waitcnt vmcnt(17)
    s_nop 0
    buffer_load_dwordx4 v129, s[20:23], s50 offen offset:1024 nt lds
    s_add_u32 m0, s59, 0
    s_nop 0
    s_mov_b32 s50, 360448
    s_waitcnt vmcnt(17)
    s_nop 0
    buffer_load_dwordx4 v130, s[20:23], s50 offen offset:2048 nt lds
    ds_read_b64_tr_b16 v[156:157], v2 offset:8192
    ds_read_b64_tr_b16 v[158:159], v2 offset:10240
    ds_read_b64_tr_b16 v[160:161], v3 offset:8192
    ds_read_b64_tr_b16 v[162:163], v3 offset:10240
    ds_read_b64_tr_b16 v[164:165], v2 offset:8448
    ds_read_b64_tr_b16 v[166:167], v2 offset:10496
    ds_read_b64_tr_b16 v[168:169], v3 offset:8448
    ds_read_b64_tr_b16 v[170:171], v3 offset:10496
    ds_read_b128 v[208:211], v9 offset:47104
    ds_read_b128 v[212:215], v9 offset:48128
    ds_read_b128 v[216:219], v9 offset:49152
    ds_read_b128 v[220:223], v9 offset:50176
    ds_read_b128 v[224:227], v9 offset:51200
    ds_read_b128 v[228:231], v9 offset:52224
    ds_read_b128 v[232:235], v9 offset:53248
    ds_read_b128 v[236:239], v9 offset:54272
    ds_read_b128 v[240:243], v9 offset:55296
    s_add_u32 m0, s59, 0
    s_nop 0
    s_mov_b32 s50, 360448
    s_waitcnt vmcnt(13)
    s_nop 0
    buffer_load_dwordx4 v131, s[20:23], s50 offen offset:3072 nt lds
    s_add_u32 m0, s59, 4096
    s_mov_b32 s50, 364544
    s_waitcnt vmcnt(13)
    s_nop 0
    buffer_load_dwordx4 v128, s[20:23], s50 offen offset:0 nt lds
    s_waitcnt lgkmcnt(9)
    s_add_u32 s44, s38, 1
    s_and_b32 s44, s44, 3
    s_and_b32 s43, s38, 12
    s_add_u32 s44, s44, s43
    s_lshl_b32 s44, s44, 3
    s_lshl_b32 s43, s44, 15
    s_nop 0
    s_add_u32 s43, s43, 32768
    s_add_u32 m0, s58, 8192
    s_nop 0
    s_nop 0
    buffer_load_dwordx4 v4, s[24:27], s43 offen offset:0 lds
    buffer_load_dwordx4 v5, s[24:27], s43 offen offset:1024 lds
    buffer_load_dwordx4 v6, s[24:27], s43 offen offset:2048 lds
    buffer_load_dwordx4 v7, s[24:27], s43 offen offset:3072 lds
    s_waitcnt lgkmcnt(0)
    s_nop 0
    v_mfma_f32_16x16x32_bf16 v[16:19], v[156:159], v[208:211], v[16:19]
    s_add_u32 m0, s59, 4096
    s_mov_b32 s50, 364544
    s_waitcnt vmcnt(17)
    s_nop 0
    buffer_load_dwordx4 v129, s[20:23], s50 offen offset:1024 nt lds
    v_mfma_f32_16x16x32_bf16 v[20:23], v[160:163], v[208:211], v[20:23]
    v_mfma_f32_16x16x32_bf16 v[24:27], v[164:167], v[208:211], v[24:27]
    v_mfma_f32_16x16x32_bf16 v[28:31], v[168:171], v[208:211], v[28:31]
    v_mfma_f32_16x16x32_bf16 v[32:35], v[156:159], v[212:215], v[32:35]
    s_add_u32 m0, s59, 4096
    s_mov_b32 s50, 364544
    s_waitcnt vmcnt(17)
    s_nop 0
    buffer_load_dwordx4 v130, s[20:23], s50 offen offset:2048 nt lds
    v_mfma_f32_16x16x32_bf16 v[36:39], v[160:163], v[212:215], v[36:39]
    v_mfma_f32_16x16x32_bf16 v[40:43], v[164:167], v[212:215], v[40:43]
    v_mfma_f32_16x16x32_bf16 v[44:47], v[168:171], v[212:215], v[44:47]
    s_add_u32 m0, s59, 4096
    s_mov_b32 s50, 364544
    s_waitcnt vmcnt(17)
    s_nop 0
    buffer_load_dwordx4 v131, s[20:23], s50 offen offset:3072 nt lds
    v_mfma_f32_16x16x32_bf16 v[48:51], v[156:159], v[216:219], v[48:51]
    v_mfma_f32_16x16x32_bf16 v[52:55], v[160:163], v[216:219], v[52:55]
    v_mfma_f32_16x16x32_bf16 v[56:59], v[164:167], v[216:219], v[56:59]
    s_add_u32 m0, s59, 8192
    s_mov_b32 s50, 368640
    s_waitcnt vmcnt(17)
    s_nop 0
    buffer_load_dwordx4 v132, s[20:23], s50 offen offset:0 nt lds
    v_mfma_f32_16x16x32_bf16 v[60:63], v[168:171], v[216:219], v[60:63]
    v_mfma_f32_16x16x32_bf16 v[64:67], v[156:159], v[220:223], v[64:67]
    v_mfma_f32_16x16x32_bf16 v[68:71], v[160:163], v[220:223], v[68:71]
    v_mfma_f32_16x16x32_bf16 v[72:75], v[164:167], v[220:223], v[72:75]
    s_add_u32 m0, s59, 8192
    s_mov_b32 s50, 368640
    s_waitcnt vmcnt(17)
    s_nop 0
    buffer_load_dwordx4 v133, s[20:23], s50 offen offset:1024 nt lds
    v_mfma_f32_16x16x32_bf16 v[76:79], v[168:171], v[220:223], v[76:79]
    v_mfma_f32_16x16x32_bf16 v[80:83], v[156:159], v[224:227], v[80:83]
    v_mfma_f32_16x16x32_bf16 v[84:87], v[160:163], v[224:227], v[84:87]
    s_add_u32 m0, s59, 8192
    s_mov_b32 s50, 368640
    s_waitcnt vmcnt(17)
    s_nop 0
    buffer_load_dwordx4 v134, s[20:23], s50 offen offset:2048 nt lds
    v_mfma_f32_16x16x32_bf16 v[88:91], v[164:167], v[224:227], v[88:91]
    v_mfma_f32_16x16x32_bf16 v[92:95], v[168:171], v[224:227], v[92:95]
    v_mfma_f32_16x16x32_bf16 v[96:99], v[156:159], v[228:231], v[96:99]
    s_add_u32 m0, s59, 8192
    s_mov_b32 s50, 368640
    s_waitcnt vmcnt(17)
    s_nop 0
    buffer_load_dwordx4 v135, s[20:23], s50 offen offset:3072 nt lds
    v_mfma_f32_16x16x32_bf16 v[100:103], v[160:163], v[228:231], v[100:103]
    v_mfma_f32_16x16x32_bf16 v[104:107], v[164:167], v[228:231], v[104:107]
    v_mfma_f32_16x16x32_bf16 v[108:111], v[168:171], v[228:231], v[108:111]
    s_add_u32 m0, s59, 12288
    s_mov_b32 s50, 372736
    s_waitcnt vmcnt(17)
    s_nop 0
    buffer_load_dwordx4 v132, s[20:23], s50 offen offset:0 nt lds
    v_mfma_f32_16x16x32_bf16 v[112:115], v[156:159], v[232:235], v[112:115]
    v_mfma_f32_16x16x32_bf16 v[116:119], v[160:163], v[232:235], v[116:119]
    v_mfma_f32_16x16x32_bf16 v[120:123], v[164:167], v[232:235], v[120:123]
    v_mfma_f32_16x16x32_bf16 v[124:127], v[168:171], v[232:235], v[124:127]
    s_add_u32 m0, s59, 12288
    s_mov_b32 s50, 372736
    s_waitcnt vmcnt(17)
    s_nop 0
    buffer_load_dwordx4 v133, s[20:23], s50 offen offset:1024 nt lds
    v_mfma_f32_16x16x32_bf16 v[176:179], v[156:159], v[236:239], v[176:179]
    v_mfma_f32_16x16x32_bf16 v[180:183], v[160:163], v[236:239], v[180:183]
    v_mfma_f32_16x16x32_bf16 v[184:187], v[164:167], v[236:239], v[184:187]
    s_add_u32 m0, s59, 12288
    s_mov_b32 s50, 372736
    s_waitcnt vmcnt(17)
    s_nop 0
    buffer_load_dwordx4 v134, s[20:23], s50 offen offset:2048 nt lds
    v_mfma_f32_16x16x32_bf16 v[188:191], v[168:171], v[236:239], v[188:191]
    v_mfma_f32_16x16x32_bf16 v[192:195], v[156:159], v[240:243], v[192:195]
    v_mfma_f32_16x16x32_bf16 v[196:199], v[160:163], v[240:243], v[196:199]
    s_add_u32 m0, s59, 12288
    s_mov_b32 s50, 372736
    s_waitcnt vmcnt(17)
    s_nop 0
    buffer_load_dwordx4 v135, s[20:23], s50 offen offset:3072 nt lds
    v_mfma_f32_16x16x32_bf16 v[200:203], v[164:167], v[240:243], v[200:203]
    v_mfma_f32_16x16x32_bf16 v[204:207], v[168:171], v[240:243], v[204:207]
    s_barrier
    s_nop 0
    s_add_u32 m0, s59, 32768
    s_mov_b32 s50, 376832
    s_waitcnt vmcnt(17)
    s_nop 0
    buffer_load_dwordx4 v128, s[20:23], s50 offen offset:0 nt lds
    s_add_u32 m0, s59, 32768
    s_mov_b32 s50, 376832
    s_waitcnt vmcnt(17)
    s_nop 0
    buffer_load_dwordx4 v129, s[20:23], s50 offen offset:1024 nt lds
    s_add_u32 m0, s59, 32768
    s_mov_b32 s50, 376832
    s_waitcnt vmcnt(17)
    s_nop 0
    buffer_load_dwordx4 v130, s[20:23], s50 offen offset:2048 nt lds
    ds_read_b64_tr_b16 v[156:157], v2 offset:0
    ds_read_b64_tr_b16 v[158:159], v2 offset:2048
    ds_read_b64_tr_b16 v[160:161], v3 offset:0
    ds_read_b64_tr_b16 v[162:163], v3 offset:2048
    ds_read_b64_tr_b16 v[164:165], v2 offset:256
    ds_read_b64_tr_b16 v[166:167], v2 offset:2304
    ds_read_b64_tr_b16 v[168:169], v3 offset:256
    ds_read_b64_tr_b16 v[170:171], v3 offset:2304
    ds_read_b128 v[208:211], v9 offset:56320
    ds_read_b128 v[212:215], v9 offset:57344
    ds_read_b128 v[216:219], v9 offset:58368
    ds_read_b128 v[220:223], v9 offset:59392
    ds_read_b128 v[224:227], v9 offset:60416
    ds_read_b128 v[228:231], v9 offset:61440
    ds_read_b128 v[232:235], v9 offset:62464
    ds_read_b128 v[236:239], v9 offset:63488
    ds_read_b128 v[240:243], v9 offset:64512
    s_add_u32 m0, s59, 32768
    s_mov_b32 s50, 376832
    s_waitcnt vmcnt(13)
    s_nop 0
    buffer_load_dwordx4 v131, s[20:23], s50 offen offset:3072 nt lds
    s_add_u32 m0, s59, 36864
    s_mov_b32 s50, 380928
    s_waitcnt vmcnt(13)
    s_nop 0
    buffer_load_dwordx4 v128, s[20:23], s50 offen offset:0 nt lds
    s_waitcnt lgkmcnt(9)
    s_add_u32 s44, s38, 1
    s_and_b32 s44, s44, 3
    s_and_b32 s43, s38, 12
    s_add_u32 s44, s44, s43
    s_lshl_b32 s44, s44, 3
    s_lshl_b32 s43, s44, 15
    s_nop 0
    s_add_u32 s43, s43, 65536
    s_add_u32 m0, s58, 0
    s_nop 0
    buffer_load_dwordx4 v4, s[24:27], s43 offen offset:0 lds
    buffer_load_dwordx4 v5, s[24:27], s43 offen offset:1024 lds
    buffer_load_dwordx4 v6, s[24:27], s43 offen offset:2048 lds
    buffer_load_dwordx4 v7, s[24:27], s43 offen offset:3072 lds
    s_waitcnt lgkmcnt(0)
    s_nop 0
    v_mfma_f32_16x16x32_bf16 v[16:19], v[156:159], v[208:211], v[16:19]
    s_add_u32 m0, s59, 36864
    s_mov_b32 s50, 380928
    s_waitcnt vmcnt(17)
    s_nop 0
    buffer_load_dwordx4 v129, s[20:23], s50 offen offset:1024 nt lds
    v_mfma_f32_16x16x32_bf16 v[20:23], v[160:163], v[208:211], v[20:23]
    v_mfma_f32_16x16x32_bf16 v[24:27], v[164:167], v[208:211], v[24:27]
    v_mfma_f32_16x16x32_bf16 v[28:31], v[168:171], v[208:211], v[28:31]
    v_mfma_f32_16x16x32_bf16 v[32:35], v[156:159], v[212:215], v[32:35]
    s_add_u32 m0, s59, 36864
    s_mov_b32 s50, 380928
    s_waitcnt vmcnt(17)
    s_nop 0
    buffer_load_dwordx4 v130, s[20:23], s50 offen offset:2048 nt lds
    v_mfma_f32_16x16x32_bf16 v[36:39], v[160:163], v[212:215], v[36:39]
    v_mfma_f32_16x16x32_bf16 v[40:43], v[164:167], v[212:215], v[40:43]
    v_mfma_f32_16x16x32_bf16 v[44:47], v[168:171], v[212:215], v[44:47]
    s_add_u32 m0, s59, 36864
    s_mov_b32 s50, 380928
    s_waitcnt vmcnt(17)
    s_nop 0
    buffer_load_dwordx4 v131, s[20:23], s50 offen offset:3072 nt lds
    v_mfma_f32_16x16x32_bf16 v[48:51], v[156:159], v[216:219], v[48:51]
    v_mfma_f32_16x16x32_bf16 v[52:55], v[160:163], v[216:219], v[52:55]
    v_mfma_f32_16x16x32_bf16 v[56:59], v[164:167], v[216:219], v[56:59]
    s_add_u32 m0, s59, 40960
    s_mov_b32 s50, 385024
    s_waitcnt vmcnt(17)
    s_nop 0
    buffer_load_dwordx4 v132, s[20:23], s50 offen offset:0 nt lds
    v_mfma_f32_16x16x32_bf16 v[60:63], v[168:171], v[216:219], v[60:63]
    v_mfma_f32_16x16x32_bf16 v[64:67], v[156:159], v[220:223], v[64:67]
    v_mfma_f32_16x16x32_bf16 v[68:71], v[160:163], v[220:223], v[68:71]
    v_mfma_f32_16x16x32_bf16 v[72:75], v[164:167], v[220:223], v[72:75]
    s_add_u32 m0, s59, 40960
    s_mov_b32 s50, 385024
    s_waitcnt vmcnt(17)
    s_nop 0
    buffer_load_dwordx4 v133, s[20:23], s50 offen offset:1024 nt lds
    v_mfma_f32_16x16x32_bf16 v[76:79], v[168:171], v[220:223], v[76:79]
    v_mfma_f32_16x16x32_bf16 v[80:83], v[156:159], v[224:227], v[80:83]
    v_mfma_f32_16x16x32_bf16 v[84:87], v[160:163], v[224:227], v[84:87]
    s_add_u32 m0, s59, 40960
    s_mov_b32 s50, 385024
    s_waitcnt vmcnt(17)
    s_nop 0
    buffer_load_dwordx4 v134, s[20:23], s50 offen offset:2048 nt lds
    v_mfma_f32_16x16x32_bf16 v[88:91], v[164:167], v[224:227], v[88:91]
    v_mfma_f32_16x16x32_bf16 v[92:95], v[168:171], v[224:227], v[92:95]
    v_mfma_f32_16x16x32_bf16 v[96:99], v[156:159], v[228:231], v[96:99]
    s_add_u32 m0, s59, 40960
    s_mov_b32 s50, 385024
    s_waitcnt vmcnt(17)
    s_nop 0
    buffer_load_dwordx4 v135, s[20:23], s50 offen offset:3072 nt lds
    v_mfma_f32_16x16x32_bf16 v[100:103], v[160:163], v[228:231], v[100:103]
    v_mfma_f32_16x16x32_bf16 v[104:107], v[164:167], v[228:231], v[104:107]
    v_mfma_f32_16x16x32_bf16 v[108:111], v[168:171], v[228:231], v[108:111]
    s_add_u32 m0, s59, 45056
    s_mov_b32 s50, 389120
    s_waitcnt vmcnt(17)
    s_nop 0
    buffer_load_dwordx4 v132, s[20:23], s50 offen offset:0 nt lds
    v_mfma_f32_16x16x32_bf16 v[112:115], v[156:159], v[232:235], v[112:115]
    v_mfma_f32_16x16x32_bf16 v[116:119], v[160:163], v[232:235], v[116:119]
    v_mfma_f32_16x16x32_bf16 v[120:123], v[164:167], v[232:235], v[120:123]
    v_mfma_f32_16x16x32_bf16 v[124:127], v[168:171], v[232:235], v[124:127]
    s_add_u32 m0, s59, 45056
    s_mov_b32 s50, 389120
    s_waitcnt vmcnt(17)
    s_nop 0
    buffer_load_dwordx4 v133, s[20:23], s50 offen offset:1024 nt lds
    v_mfma_f32_16x16x32_bf16 v[176:179], v[156:159], v[236:239], v[176:179]
    v_mfma_f32_16x16x32_bf16 v[180:183], v[160:163], v[236:239], v[180:183]
    v_mfma_f32_16x16x32_bf16 v[184:187], v[164:167], v[236:239], v[184:187]
    s_add_u32 m0, s59, 45056
    s_mov_b32 s50, 389120
    s_waitcnt vmcnt(17)
    s_nop 0
    buffer_load_dwordx4 v134, s[20:23], s50 offen offset:2048 nt lds
    v_mfma_f32_16x16x32_bf16 v[188:191], v[168:171], v[236:239], v[188:191]
    v_mfma_f32_16x16x32_bf16 v[192:195], v[156:159], v[240:243], v[192:195]
    v_mfma_f32_16x16x32_bf16 v[196:199], v[160:163], v[240:243], v[196:199]
    s_add_u32 m0, s59, 45056
    s_mov_b32 s50, 389120
    s_waitcnt vmcnt(17)
    s_nop 0
    buffer_load_dwordx4 v135, s[20:23], s50 offen offset:3072 nt lds
    v_mfma_f32_16x16x32_bf16 v[200:203], v[164:167], v[240:243], v[200:203]
    v_mfma_f32_16x16x32_bf16 v[204:207], v[168:171], v[240:243], v[204:207]
    s_barrier
    s_nop 0
    s_add_u32 m0, s59, 65536
    s_mov_b32 s50, 393216
    s_waitcnt vmcnt(9)
    s_nop 0
    buffer_load_dwordx4 v128, s[20:23], s50 offen offset:0 nt lds
    s_add_u32 m0, s59, 65536
    s_mov_b32 s50, 393216
    s_waitcnt vmcnt(9)
    s_nop 0
    buffer_load_dwordx4 v129, s[20:23], s50 offen offset:1024 nt lds
    s_add_u32 m0, s59, 65536
    s_mov_b32 s50, 393216
    s_waitcnt vmcnt(9)
    s_nop 0
    buffer_load_dwordx4 v130, s[20:23], s50 offen offset:2048 nt lds
    s_add_u32 m0, s59, 65536
    s_mov_b32 s50, 393216
    s_waitcnt vmcnt(9)
    s_nop 0
    buffer_load_dwordx4 v131, s[20:23], s50 offen offset:3072 nt lds
    s_add_u32 m0, s59, 69632
    s_mov_b32 s50, 397312
    s_waitcnt vmcnt(9)
    s_nop 0
    buffer_load_dwordx4 v128, s[20:23], s50 offen offset:0 nt lds
    s_add_u32 m0, s59, 69632
    s_mov_b32 s50, 397312
    s_waitcnt vmcnt(9)
    s_nop 0
    buffer_load_dwordx4 v129, s[20:23], s50 offen offset:1024 nt lds
    s_add_u32 m0, s59, 69632
    s_mov_b32 s50, 397312
    s_waitcnt vmcnt(9)
    s_nop 0
    buffer_load_dwordx4 v130, s[20:23], s50 offen offset:2048 nt lds
    s_add_u32 m0, s59, 69632
    s_mov_b32 s50, 397312
    s_waitcnt vmcnt(9)
    s_nop 0
    buffer_load_dwordx4 v131, s[20:23], s50 offen offset:3072 nt lds
    s_add_u32 m0, s59, 73728
    s_mov_b32 s50, 401408
    s_waitcnt vmcnt(9)
    s_nop 0
    buffer_load_dwordx4 v132, s[20:23], s50 offen offset:0 nt lds
    s_add_u32 m0, s59, 73728
    s_mov_b32 s50, 401408
    s_waitcnt vmcnt(9)
    s_nop 0
    buffer_load_dwordx4 v133, s[20:23], s50 offen offset:1024 nt lds
    s_barrier
    s_nop 0
    s_add_u32 m0, s59, 73728
    s_mov_b32 s50, 401408
    s_waitcnt vmcnt(9)
    s_nop 0
    buffer_load_dwordx4 v134, s[20:23], s50 offen offset:2048 nt lds
    s_add_u32 m0, s59, 73728
    s_mov_b32 s50, 401408
    s_waitcnt vmcnt(9)
    s_nop 0
    buffer_load_dwordx4 v135, s[20:23], s50 offen offset:3072 nt lds
    s_add_u32 m0, s59, 77824
    s_mov_b32 s50, 405504
    s_waitcnt vmcnt(9)
    s_nop 0
    buffer_load_dwordx4 v132, s[20:23], s50 offen offset:0 nt lds
    s_add_u32 m0, s59, 77824
    s_mov_b32 s50, 405504
    s_waitcnt vmcnt(9)
    s_nop 0
    buffer_load_dwordx4 v133, s[20:23], s50 offen offset:1024 nt lds
    s_add_u32 m0, s59, 77824
    s_mov_b32 s50, 405504
    s_waitcnt vmcnt(9)
    s_nop 0
    buffer_load_dwordx4 v134, s[20:23], s50 offen offset:2048 nt lds
    s_add_u32 m0, s59, 77824
    s_mov_b32 s50, 405504
    s_waitcnt vmcnt(9)
    s_nop 0
    buffer_load_dwordx4 v135, s[20:23], s50 offen offset:3072 nt lds
    s_add_u32 m0, s59, 0
    s_nop 0
    s_mov_b32 s50, 409600
    s_waitcnt vmcnt(9)
    s_nop 0
    buffer_load_dwordx4 v128, s[20:23], s50 offen offset:0 nt lds
    s_add_u32 m0, s59, 0
    s_nop 0
    s_mov_b32 s50, 409600
    s_waitcnt vmcnt(9)
    s_nop 0
    buffer_load_dwordx4 v129, s[20:23], s50 offen offset:1024 nt lds
    s_add_u32 m0, s59, 0
    s_nop 0
    s_mov_b32 s50, 409600
    s_waitcnt vmcnt(9)
    s_nop 0
    buffer_load_dwordx4 v130, s[20:23], s50 offen offset:2048 nt lds
    s_add_u32 m0, s59, 0
    s_nop 0
    s_mov_b32 s50, 409600
    s_waitcnt vmcnt(9)
    s_nop 0
    buffer_load_dwordx4 v131, s[20:23], s50 offen offset:3072 nt lds
    s_add_u32 m0, s59, 4096
    s_mov_b32 s50, 413696
    s_waitcnt vmcnt(9)
    s_nop 0
    buffer_load_dwordx4 v128, s[20:23], s50 offen offset:0 nt lds
    s_add_u32 m0, s59, 4096
    s_mov_b32 s50, 413696
    s_waitcnt vmcnt(9)
    s_nop 0
    buffer_load_dwordx4 v129, s[20:23], s50 offen offset:1024 nt lds
    s_add_u32 m0, s59, 4096
    s_mov_b32 s50, 413696
    s_waitcnt vmcnt(9)
    s_nop 0
    buffer_load_dwordx4 v130, s[20:23], s50 offen offset:2048 nt lds
    s_add_u32 m0, s59, 4096
    s_mov_b32 s50, 413696
    s_waitcnt vmcnt(9)
    s_nop 0
    buffer_load_dwordx4 v131, s[20:23], s50 offen offset:3072 nt lds
    s_add_u32 m0, s59, 8192
    s_mov_b32 s50, 417792
    s_waitcnt vmcnt(9)
    s_nop 0
    buffer_load_dwordx4 v132, s[20:23], s50 offen offset:0 nt lds
    s_add_u32 m0, s59, 8192
    s_mov_b32 s50, 417792
    s_waitcnt vmcnt(9)
    s_nop 0
    buffer_load_dwordx4 v133, s[20:23], s50 offen offset:1024 nt lds
    s_barrier
    s_nop 0
    s_add_u32 m0, s59, 8192
    s_mov_b32 s50, 417792
    s_waitcnt vmcnt(9)
    s_nop 0
    buffer_load_dwordx4 v134, s[20:23], s50 offen offset:2048 nt lds
    s_add_u32 m0, s59, 8192
    s_mov_b32 s50, 417792
    s_waitcnt vmcnt(9)
    s_nop 0
    buffer_load_dwordx4 v135, s[20:23], s50 offen offset:3072 nt lds
    s_add_u32 m0, s59, 12288
    s_mov_b32 s50, 421888
    s_waitcnt vmcnt(9)
    s_nop 0
    buffer_load_dwordx4 v132, s[20:23], s50 offen offset:0 nt lds
    s_add_u32 m0, s59, 12288
    s_mov_b32 s50, 421888
    s_waitcnt vmcnt(9)
    s_nop 0
    buffer_load_dwordx4 v133, s[20:23], s50 offen offset:1024 nt lds
    s_add_u32 m0, s59, 12288
    s_mov_b32 s50, 421888
    s_waitcnt vmcnt(9)
    s_nop 0
    buffer_load_dwordx4 v134, s[20:23], s50 offen offset:2048 nt lds
    s_add_u32 m0, s59, 12288
    s_mov_b32 s50, 421888
    s_waitcnt vmcnt(9)
    s_nop 0
    buffer_load_dwordx4 v135, s[20:23], s50 offen offset:3072 nt lds
    s_add_u32 m0, s59, 32768
    s_mov_b32 s50, 425984
    s_waitcnt vmcnt(9)
    s_nop 0
    buffer_load_dwordx4 v128, s[20:23], s50 offen offset:0 nt lds
    s_add_u32 m0, s59, 32768
    s_mov_b32 s50, 425984
    s_waitcnt vmcnt(9)
    s_nop 0
    buffer_load_dwordx4 v129, s[20:23], s50 offen offset:1024 nt lds
    s_add_u32 m0, s59, 32768
    s_mov_b32 s50, 425984
    s_waitcnt vmcnt(9)
    s_nop 0
    buffer_load_dwordx4 v130, s[20:23], s50 offen offset:2048 nt lds
    s_add_u32 m0, s59, 32768
    s_mov_b32 s50, 425984
    s_waitcnt vmcnt(9)
    s_nop 0
    buffer_load_dwordx4 v131, s[20:23], s50 offen offset:3072 nt lds
    s_add_u32 m0, s59, 36864
    s_mov_b32 s50, 430080
    s_waitcnt vmcnt(9)
    s_nop 0
    buffer_load_dwordx4 v128, s[20:23], s50 offen offset:0 nt lds
    s_add_u32 m0, s59, 36864
    s_mov_b32 s50, 430080
    s_waitcnt vmcnt(9)
    s_nop 0
    buffer_load_dwordx4 v129, s[20:23], s50 offen offset:1024 nt lds
    s_add_u32 m0, s59, 36864
    s_mov_b32 s50, 430080
    s_waitcnt vmcnt(9)
    s_nop 0
    buffer_load_dwordx4 v130, s[20:23], s50 offen offset:2048 nt lds
    s_add_u32 m0, s59, 36864
    s_mov_b32 s50, 430080
    s_waitcnt vmcnt(9)
    s_nop 0
    buffer_load_dwordx4 v131, s[20:23], s50 offen offset:3072 nt lds
    s_add_u32 m0, s59, 40960
    s_mov_b32 s50, 434176
    s_waitcnt vmcnt(9)
    s_nop 0
    buffer_load_dwordx4 v132, s[20:23], s50 offen offset:0 nt lds
    s_add_u32 m0, s59, 40960
    s_mov_b32 s50, 434176
    s_waitcnt vmcnt(9)
    s_nop 0
    buffer_load_dwordx4 v133, s[20:23], s50 offen offset:1024 nt lds
    s_barrier
    s_nop 0
    s_add_u32 m0, s59, 40960
    s_mov_b32 s50, 434176
    s_waitcnt vmcnt(9)
    s_nop 0
    buffer_load_dwordx4 v134, s[20:23], s50 offen offset:2048 nt lds
    s_add_u32 m0, s59, 40960
    s_mov_b32 s50, 434176
    s_waitcnt vmcnt(9)
    s_nop 0
    buffer_load_dwordx4 v135, s[20:23], s50 offen offset:3072 nt lds
    s_add_u32 m0, s59, 45056
    s_mov_b32 s50, 438272
    s_waitcnt vmcnt(9)
    s_nop 0
    buffer_load_dwordx4 v132, s[20:23], s50 offen offset:0 nt lds
    s_add_u32 m0, s59, 45056
    s_mov_b32 s50, 438272
    s_waitcnt vmcnt(9)
    s_nop 0
    buffer_load_dwordx4 v133, s[20:23], s50 offen offset:1024 nt lds
    s_add_u32 m0, s59, 45056
    s_mov_b32 s50, 438272
    s_waitcnt vmcnt(9)
    s_nop 0
    buffer_load_dwordx4 v134, s[20:23], s50 offen offset:2048 nt lds
    s_add_u32 m0, s59, 45056
    s_mov_b32 s50, 438272
    s_waitcnt vmcnt(9)
    s_nop 0
    buffer_load_dwordx4 v135, s[20:23], s50 offen offset:3072 nt lds
    s_add_u32 m0, s59, 65536
    s_mov_b32 s50, 442368
    s_waitcnt vmcnt(9)
    s_nop 0
    buffer_load_dwordx4 v128, s[20:23], s50 offen offset:0 nt lds
    s_add_u32 m0, s59, 65536
    s_mov_b32 s50, 442368
    s_waitcnt vmcnt(9)
    s_nop 0
    buffer_load_dwordx4 v129, s[20:23], s50 offen offset:1024 nt lds
    s_add_u32 m0, s59, 65536
    s_mov_b32 s50, 442368
    s_waitcnt vmcnt(9)
    s_nop 0
    buffer_load_dwordx4 v130, s[20:23], s50 offen offset:2048 nt lds
    s_add_u32 m0, s59, 65536
    s_mov_b32 s50, 442368
    s_waitcnt vmcnt(9)
    s_nop 0
    buffer_load_dwordx4 v131, s[20:23], s50 offen offset:3072 nt lds
    s_add_u32 m0, s59, 69632
    s_mov_b32 s50, 446464
    s_waitcnt vmcnt(9)
    s_nop 0
    buffer_load_dwordx4 v128, s[20:23], s50 offen offset:0 nt lds
    s_add_u32 m0, s59, 69632
    s_mov_b32 s50, 446464
    s_waitcnt vmcnt(9)
    s_nop 0
    buffer_load_dwordx4 v129, s[20:23], s50 offen offset:1024 nt lds
    s_add_u32 m0, s59, 69632
    s_mov_b32 s50, 446464
    s_waitcnt vmcnt(9)
    s_nop 0
    buffer_load_dwordx4 v130, s[20:23], s50 offen offset:2048 nt lds
    s_add_u32 m0, s59, 69632
    s_mov_b32 s50, 446464
    s_waitcnt vmcnt(9)
    s_nop 0
    buffer_load_dwordx4 v131, s[20:23], s50 offen offset:3072 nt lds
    s_add_u32 m0, s59, 73728
    s_mov_b32 s50, 450560
    s_waitcnt vmcnt(9)
    s_nop 0
    buffer_load_dwordx4 v132, s[20:23], s50 offen offset:0 nt lds
    s_add_u32 m0, s59, 73728
    s_mov_b32 s50, 450560
    s_waitcnt vmcnt(9)
    s_nop 0
    buffer_load_dwordx4 v133, s[20:23], s50 offen offset:1024 nt lds
    s_barrier
    s_nop 0
    s_add_u32 m0, s59, 73728
    s_mov_b32 s50, 450560
    s_waitcnt vmcnt(9)
    s_nop 0
    buffer_load_dwordx4 v134, s[20:23], s50 offen offset:2048 nt lds
    s_add_u32 m0, s59, 73728
    s_mov_b32 s50, 450560
    s_waitcnt vmcnt(9)
    s_nop 0
    buffer_load_dwordx4 v135, s[20:23], s50 offen offset:3072 nt lds
    s_add_u32 m0, s59, 77824
    s_mov_b32 s50, 454656
    s_waitcnt vmcnt(9)
    s_nop 0
    buffer_load_dwordx4 v132, s[20:23], s50 offen offset:0 nt lds
    s_add_u32 m0, s59, 77824
    s_mov_b32 s50, 454656
    s_waitcnt vmcnt(9)
    s_nop 0
    buffer_load_dwordx4 v133, s[20:23], s50 offen offset:1024 nt lds
    s_add_u32 m0, s59, 77824
    s_mov_b32 s50, 454656
    s_waitcnt vmcnt(9)
    s_nop 0
    buffer_load_dwordx4 v134, s[20:23], s50 offen offset:2048 nt lds
    s_add_u32 m0, s59, 77824
    s_mov_b32 s50, 454656
    s_waitcnt vmcnt(9)
    s_nop 0
    buffer_load_dwordx4 v135, s[20:23], s50 offen offset:3072 nt lds
    s_add_u32 m0, s59, 0
    s_nop 0
    s_mov_b32 s50, 458752
    s_waitcnt vmcnt(9)
    s_nop 0
    buffer_load_dwordx4 v128, s[20:23], s50 offen offset:0 nt lds
    s_add_u32 m0, s59, 0
    s_nop 0
    s_mov_b32 s50, 458752
    s_waitcnt vmcnt(9)
    s_nop 0
    buffer_load_dwordx4 v129, s[20:23], s50 offen offset:1024 nt lds
    s_add_u32 m0, s59, 0
    s_nop 0
    s_mov_b32 s50, 458752
    s_waitcnt vmcnt(9)
    s_nop 0
    buffer_load_dwordx4 v130, s[20:23], s50 offen offset:2048 nt lds
    s_add_u32 m0, s59, 0
    s_nop 0
    s_mov_b32 s50, 458752
    s_waitcnt vmcnt(9)
    s_nop 0
    buffer_load_dwordx4 v131, s[20:23], s50 offen offset:3072 nt lds
    s_add_u32 m0, s59, 4096
    s_mov_b32 s50, 462848
    s_waitcnt vmcnt(9)
    s_nop 0
    buffer_load_dwordx4 v128, s[20:23], s50 offen offset:0 nt lds
    s_add_u32 m0, s59, 4096
    s_mov_b32 s50, 462848
    s_waitcnt vmcnt(9)
    s_nop 0
    buffer_load_dwordx4 v129, s[20:23], s50 offen offset:1024 nt lds
    s_add_u32 m0, s59, 4096
    s_mov_b32 s50, 462848
    s_waitcnt vmcnt(9)
    s_nop 0
    buffer_load_dwordx4 v130, s[20:23], s50 offen offset:2048 nt lds
    s_add_u32 m0, s59, 4096
    s_mov_b32 s50, 462848
    s_waitcnt vmcnt(9)
    s_nop 0
    buffer_load_dwordx4 v131, s[20:23], s50 offen offset:3072 nt lds
    s_add_u32 m0, s59, 8192
    s_mov_b32 s50, 466944
    s_waitcnt vmcnt(9)
    s_nop 0
    buffer_load_dwordx4 v132, s[20:23], s50 offen offset:0 nt lds
    s_add_u32 m0, s59, 8192
    s_mov_b32 s50, 466944
    s_waitcnt vmcnt(9)
    s_nop 0
    buffer_load_dwordx4 v133, s[20:23], s50 offen offset:1024 nt lds
    s_barrier
    s_nop 0
    s_add_u32 m0, s59, 8192
    s_mov_b32 s50, 466944
    s_waitcnt vmcnt(9)
    s_nop 0
    buffer_load_dwordx4 v134, s[20:23], s50 offen offset:2048 nt lds
    s_add_u32 m0, s59, 8192
    s_mov_b32 s50, 466944
    s_waitcnt vmcnt(9)
    s_nop 0
    buffer_load_dwordx4 v135, s[20:23], s50 offen offset:3072 nt lds
    s_add_u32 m0, s59, 12288
    s_mov_b32 s50, 471040
    s_waitcnt vmcnt(9)
    s_nop 0
    buffer_load_dwordx4 v132, s[20:23], s50 offen offset:0 nt lds
    s_add_u32 m0, s59, 12288
    s_mov_b32 s50, 471040
    s_waitcnt vmcnt(9)
    s_nop 0
    buffer_load_dwordx4 v133, s[20:23], s50 offen offset:1024 nt lds
    s_add_u32 m0, s59, 12288
    s_mov_b32 s50, 471040
    s_waitcnt vmcnt(9)
    s_nop 0
    buffer_load_dwordx4 v134, s[20:23], s50 offen offset:2048 nt lds
    s_add_u32 m0, s59, 12288
    s_mov_b32 s50, 471040
    s_waitcnt vmcnt(9)
    s_nop 0
    buffer_load_dwordx4 v135, s[20:23], s50 offen offset:3072 nt lds
    s_add_u32 m0, s59, 32768
    s_mov_b32 s50, 475136
    s_waitcnt vmcnt(9)
    s_nop 0
    buffer_load_dwordx4 v128, s[20:23], s50 offen offset:0 nt lds
    s_add_u32 m0, s59, 32768
    s_mov_b32 s50, 475136
    s_waitcnt vmcnt(9)
    s_nop 0
    buffer_load_dwordx4 v129, s[20:23], s50 offen offset:1024 nt lds
    s_add_u32 m0, s59, 32768
    s_mov_b32 s50, 475136
    s_waitcnt vmcnt(9)
    s_nop 0
    buffer_load_dwordx4 v130, s[20:23], s50 offen offset:2048 nt lds
    s_add_u32 m0, s59, 32768
    s_mov_b32 s50, 475136
    s_waitcnt vmcnt(9)
    s_nop 0
    buffer_load_dwordx4 v131, s[20:23], s50 offen offset:3072 nt lds
    s_add_u32 m0, s59, 36864
    s_mov_b32 s50, 479232
    s_waitcnt vmcnt(9)
    s_nop 0
    buffer_load_dwordx4 v128, s[20:23], s50 offen offset:0 nt lds
    s_add_u32 m0, s59, 36864
    s_mov_b32 s50, 479232
    s_waitcnt vmcnt(9)
    s_nop 0
    buffer_load_dwordx4 v129, s[20:23], s50 offen offset:1024 nt lds
    s_add_u32 m0, s59, 36864
    s_mov_b32 s50, 479232
    s_waitcnt vmcnt(9)
    s_nop 0
    buffer_load_dwordx4 v130, s[20:23], s50 offen offset:2048 nt lds
    s_add_u32 m0, s59, 36864
    s_mov_b32 s50, 479232
    s_waitcnt vmcnt(9)
    s_nop 0
    buffer_load_dwordx4 v131, s[20:23], s50 offen offset:3072 nt lds
    s_add_u32 m0, s59, 40960
    s_mov_b32 s50, 483328
    s_waitcnt vmcnt(9)
    s_nop 0
    buffer_load_dwordx4 v132, s[20:23], s50 offen offset:0 nt lds
    s_add_u32 m0, s59, 40960
    s_mov_b32 s50, 483328
    s_waitcnt vmcnt(9)
    s_nop 0
    buffer_load_dwordx4 v133, s[20:23], s50 offen offset:1024 nt lds
    s_barrier
    s_nop 0
    s_add_u32 m0, s59, 40960
    s_mov_b32 s50, 483328
    s_waitcnt vmcnt(9)
    s_nop 0
    buffer_load_dwordx4 v134, s[20:23], s50 offen offset:2048 nt lds
    s_add_u32 m0, s59, 40960
    s_mov_b32 s50, 483328
    s_waitcnt vmcnt(9)
    s_nop 0
    buffer_load_dwordx4 v135, s[20:23], s50 offen offset:3072 nt lds
    s_add_u32 m0, s59, 45056
    s_mov_b32 s50, 487424
    s_waitcnt vmcnt(9)
    s_nop 0
    buffer_load_dwordx4 v132, s[20:23], s50 offen offset:0 nt lds
    buffer_load_dword v10, v11, s[4:7], 0 offen sc1
    s_add_u32 m0, s59, 45056
    s_mov_b32 s50, 487424
    s_waitcnt vmcnt(10)
    s_nop 0
    buffer_load_dwordx4 v133, s[20:23], s50 offen offset:1024 nt lds
    s_add_u32 m0, s59, 45056
    s_mov_b32 s50, 487424
    s_waitcnt vmcnt(10)
    s_nop 0
    buffer_load_dwordx4 v134, s[20:23], s50 offen offset:2048 nt lds
    s_add_u32 m0, s59, 45056
    s_mov_b32 s50, 487424
    s_waitcnt vmcnt(10)
    s_nop 0
    buffer_load_dwordx4 v135, s[20:23], s50 offen offset:3072 nt lds
    s_add_u32 m0, s59, 65536
    s_mov_b32 s50, 491520
    s_waitcnt vmcnt(10)
    s_nop 0
    buffer_load_dwordx4 v128, s[20:23], s50 offen offset:0 nt lds
    s_add_u32 m0, s59, 65536
    s_mov_b32 s50, 491520
    s_waitcnt vmcnt(10)
    s_nop 0
    buffer_load_dwordx4 v129, s[20:23], s50 offen offset:1024 nt lds
    s_add_u32 m0, s59, 65536
    s_mov_b32 s50, 491520
    s_waitcnt vmcnt(10)
    s_nop 0
    buffer_load_dwordx4 v130, s[20:23], s50 offen offset:2048 nt lds
    s_add_u32 m0, s59, 65536
    s_mov_b32 s50, 491520
    s_waitcnt vmcnt(10)
    s_nop 0
    buffer_load_dwordx4 v131, s[20:23], s50 offen offset:3072 nt lds
    s_add_u32 m0, s59, 69632
    s_mov_b32 s50, 495616
    s_waitcnt vmcnt(10)
    s_nop 0
    buffer_load_dwordx4 v128, s[20:23], s50 offen offset:0 nt lds
    s_add_u32 m0, s59, 69632
    s_mov_b32 s50, 495616
    s_waitcnt vmcnt(10)
    s_nop 0
    buffer_load_dwordx4 v129, s[20:23], s50 offen offset:1024 nt lds
    s_add_u32 m0, s59, 69632
    s_mov_b32 s50, 495616
    s_waitcnt vmcnt(10)
    s_nop 0
    buffer_load_dwordx4 v130, s[20:23], s50 offen offset:2048 nt lds
    s_add_u32 m0, s59, 69632
    s_mov_b32 s50, 495616
    s_waitcnt vmcnt(9)
    s_nop 0
    buffer_load_dwordx4 v131, s[20:23], s50 offen offset:3072 nt lds
    s_add_u32 m0, s59, 73728
    s_mov_b32 s50, 499712
    s_waitcnt vmcnt(9)
    s_nop 0
    buffer_load_dwordx4 v132, s[20:23], s50 offen offset:0 nt lds
    s_add_u32 m0, s59, 73728
    s_mov_b32 s50, 499712
    s_waitcnt vmcnt(9)
    s_nop 0
    buffer_load_dwordx4 v133, s[20:23], s50 offen offset:1024 nt lds
    s_barrier
    s_nop 0
    s_add_u32 m0, s59, 73728
    s_mov_b32 s50, 499712
    s_waitcnt vmcnt(9)
    s_nop 0
    buffer_load_dwordx4 v134, s[20:23], s50 offen offset:2048 nt lds
    s_add_u32 m0, s59, 73728
    s_mov_b32 s50, 499712
    s_waitcnt vmcnt(9)
    s_nop 0
    buffer_load_dwordx4 v135, s[20:23], s50 offen offset:3072 nt lds
    s_add_u32 m0, s59, 77824
    s_mov_b32 s50, 503808
    s_waitcnt vmcnt(9)
    s_nop 0
    buffer_load_dwordx4 v132, s[20:23], s50 offen offset:0 nt lds
L_f2:
    v_or_b32 v10, v15, v10
    v_cmp_eq_u32 vcc, s85, v10
    s_nop 1
    s_mov_b64 s[60:61], vcc
    s_add_u32 s44, s38, 1
    s_and_b32 s44, s44, 3
    s_and_b32 s43, s38, 12
    s_add_u32 s44, s44, s43
    s_lshl_b32 s44, 15, s43
    s_andn2_b32 s44, s44, s60
    s_cbranch_scc0 L_f2ok
    s_sleep 4
    buffer_load_dword v10, v11, s[4:7], 0 offen sc1
    s_waitcnt vmcnt(0)
    s_branch L_f2
L_f2ok:
    s_add_u32 s44, s38, 1
    s_and_b32 s44, s44, 3
    s_and_b32 s43, s38, 12
    s_add_u32 s44, s44, s43
    s_lshl_b32 s44, s44, 3
    s_and_b32 s43, s36, 1
    s_add_u32 s44, s44, s43
    s_add_u32 s44, s44, 0
    s_mul_i32 s44, s44, 9216
    s_mul_i32 s63, s43, 9216
    s_add_u32 m0, s63, 98304
    s_add_u32 s43, s44, 0
    s_nop 0
    buffer_load_dwordx4 v8, s[16:19], s43 offen offset:0 sc1 lds
    buffer_load_dwordx4 v8, s[16:19], s43 offen offset:1024 sc1 lds
    buffer_load_dwordx4 v8, s[16:19], s43 offen offset:2048 sc1 lds
    buffer_load_dwordx4 v8, s[16:19], s43 offen offset:3072 sc1 lds
    s_add_u32 m0, s63, 102400
    s_add_u32 s43, s44, 4096
    buffer_load_dwordx4 v8, s[16:19], s43 offen offset:0 sc1 lds
    buffer_load_dwordx4 v8, s[16:19], s43 offen offset:1024 sc1 lds
    buffer_load_dwordx4 v8, s[16:19], s43 offen offset:2048 sc1 lds
    buffer_load_dwordx4 v8, s[16:19], s43 offen offset:3072 sc1 lds
    s_add_u32 m0, s63, 106496
    s_add_u32 s43, s44, 8192
    buffer_load_dwordx4 v8, s[16:19], s43 offen offset:0 sc1 lds
    s_add_u32 s44, s38, 1
    s_and_b32 s44, s44, 3
    s_and_b32 s43, s38, 12
    s_add_u32 s44, s44, s43
    s_lshl_b32 s44, s44, 3
    s_and_b32 s43, s36, 1
    s_add_u32 s44, s44, s43
    s_add_u32 s44, s44, 2
    s_mul_i32 s44, s44, 9216
    s_mul_i32 s63, s43, 9216
    s_add_u32 m0, s63, 116736
    s_add_u32 s43, s44, 0
    s_nop 0
    buffer_load_dwordx4 v8, s[16:19], s43 offen offset:0 sc1 lds
    buffer_load_dwordx4 v8, s[16:19], s43 offen offset:1024 sc1 lds
    buffer_load_dwordx4 v8, s[16:19], s43 offen offset:2048 sc1 lds
    buffer_load_dwordx4 v8, s[16:19], s43 offen offset:3072 sc1 lds
    s_add_u32 m0, s63, 120832
    s_add_u32 s43, s44, 4096
    buffer_load_dwordx4 v8, s[16:19], s43 offen offset:0 sc1 lds
    buffer_load_dwordx4 v8, s[16:19], s43 offen offset:1024 sc1 lds
    buffer_load_dwordx4 v8, s[16:19], s43 offen offset:2048 sc1 lds
    buffer_load_dwordx4 v8, s[16:19], s43 offen offset:3072 sc1 lds
    s_add_u32 m0, s63, 124928
    s_add_u32 s43, s44, 8192
    buffer_load_dwordx4 v8, s[16:19], s43 offen offset:0 sc1 lds
    s_add_u32 m0, s59, 77824
    s_mov_b32 s50, 503808
    s_waitcnt vmcnt(27)
    s_nop 0
    buffer_load_dwordx4 v133, s[20:23], s50 offen offset:1024 nt lds
    s_add_u32 m0, s59, 77824
    s_mov_b32 s50, 503808
    s_waitcnt vmcnt(27)
    s_nop 0
    buffer_load_dwordx4 v134, s[20:23], s50 offen offset:2048 nt lds
    s_add_u32 m0, s59, 77824
    s_mov_b32 s50, 503808
    s_waitcnt vmcnt(27)
    s_nop 0
    buffer_load_dwordx4 v135, s[20:23], s50 offen offset:3072 nt lds
    s_add_u32 m0, s59, 0
    s_nop 0
    s_mov_b32 s50, 507904
    s_waitcnt vmcnt(27)
    s_nop 0
    buffer_load_dwordx4 v128, s[20:23], s50 offen offset:0 nt lds
    s_add_u32 m0, s59, 0
    s_nop 0
    s_mov_b32 s50, 507904
    s_waitcnt vmcnt(27)
    s_nop 0
    buffer_load_dwordx4 v129, s[20:23], s50 offen offset:1024 nt lds
    s_add_u32 m0, s59, 0
    s_nop 0
    s_mov_b32 s50, 507904
    s_waitcnt vmcnt(27)
    s_nop 0
    buffer_load_dwordx4 v130, s[20:23], s50 offen offset:2048 nt lds
    s_add_u32 m0, s59, 0
    s_nop 0
    s_mov_b32 s50, 507904
    s_waitcnt vmcnt(27)
    s_nop 0
    buffer_load_dwordx4 v131, s[20:23], s50 offen offset:3072 nt lds
    s_add_u32 m0, s59, 4096
    s_mov_b32 s50, 512000
    s_waitcnt vmcnt(27)
    s_nop 0
    buffer_load_dwordx4 v128, s[20:23], s50 offen offset:0 nt lds
    s_add_u32 m0, s59, 4096
    s_mov_b32 s50, 512000
    s_waitcnt vmcnt(27)
    s_nop 0
    buffer_load_dwordx4 v129, s[20:23], s50 offen offset:1024 nt lds
    s_add_u32 m0, s59, 4096
    s_mov_b32 s50, 512000
    s_waitcnt vmcnt(27)
    s_nop 0
    buffer_load_dwordx4 v130, s[20:23], s50 offen offset:2048 nt lds
    s_add_u32 m0, s59, 4096
    s_mov_b32 s50, 512000
    s_waitcnt vmcnt(9)
    s_nop 0
    buffer_load_dwordx4 v131, s[20:23], s50 offen offset:3072 nt lds
    s_add_u32 m0, s59, 8192
    s_mov_b32 s50, 516096
    s_waitcnt vmcnt(9)
    s_nop 0
    buffer_load_dwordx4 v132, s[20:23], s50 offen offset:0 nt lds
    s_add_u32 m0, s59, 8192
    s_mov_b32 s50, 516096
    s_waitcnt vmcnt(9)
    s_nop 0
    buffer_load_dwordx4 v133, s[20:23], s50 offen offset:1024 nt lds
    s_barrier
    s_setprio 2
    s_add_u32 m0, s59, 8192
    s_mov_b32 s50, 516096
    s_waitcnt vmcnt(9)
    s_nop 0
    buffer_load_dwordx4 v134, s[20:23], s50 offen offset:2048 nt lds
    s_add_u32 m0, s59, 8192
    s_mov_b32 s50, 516096
    s_waitcnt vmcnt(9)
    s_nop 0
    buffer_load_dwordx4 v135, s[20:23], s50 offen offset:3072 nt lds
    s_add_u32 m0, s59, 12288
    s_mov_b32 s50, 520192
    s_waitcnt vmcnt(9)
    s_nop 0
    buffer_load_dwordx4 v132, s[20:23], s50 offen offset:0 nt lds
L_tailcode:
    ds_read_b64_tr_b16 v[156:157], v2 offset:4096
    ds_read_b64_tr_b16 v[158:159], v2 offset:6144
    ds_read_b64_tr_b16 v[160:161], v3 offset:4096
    ds_read_b64_tr_b16 v[162:163], v3 offset:6144
    ds_read_b64_tr_b16 v[164:165], v2 offset:4352
    ds_read_b64_tr_b16 v[166:167], v2 offset:6400
    ds_read_b64_tr_b16 v[168:169], v3 offset:4352
    ds_read_b64_tr_b16 v[170:171], v3 offset:6400
    ds_read_b128 v[208:211], v9 offset:28672
    ds_read_b128 v[212:215], v9 offset:29696
    ds_read_b128 v[216:219], v9 offset:30720
    ds_read_b128 v[220:223], v9 offset:31744
    ds_read_b128 v[224:227], v9 offset:32768
    ds_read_b128 v[228:231], v9 offset:33792
    ds_read_b128 v[232:235], v9 offset:34816
    ds_read_b128 v[236:239], v9 offset:35840
    ds_read_b128 v[240:243], v9 offset:36864
    s_lshl_b32 s42, s36, 2
    s_nop 0
    s_add_u32 s42, s42, 163744
    v_mov_b32_e64 v140, s42
    v_xor_b32 v143, 4, v140
    s_waitcnt lgkmcnt(3)
    v_mfma_f32_16x16x32_bf16 v[16:19], v[156:159], v[208:211], v[16:19]
    s_add_u32 s44, s38, 1
    s_nop 0
    v_mfma_f32_16x16x32_bf16 v[20:23], v[160:163], v[208:211], v[20:23]
    s_and_b32 s44, s44, 3
    s_nop 0
    v_mfma_f32_16x16x32_bf16 v[24:27], v[164:167], v[208:211], v[24:27]
    s_and_b32 s43, s38, 12
    s_nop 0
    v_mfma_f32_16x16x32_bf16 v[28:31], v[168:171], v[208:211], v[28:31]
    ds_read_b128 v[208:211], v9 offset:37888
    v_mfma_f32_16x16x32_bf16 v[32:35], v[156:159], v[212:215], v[32:35]
    s_add_u32 s44, s44, s43
    s_lshl_b32 s44, s44, 3
    v_mfma_f32_16x16x32_bf16 v[36:39], v[160:163], v[212:215], v[36:39]
    s_lshl_b32 s43, s44, 15
    s_nop 0
    v_mfma_f32_16x16x32_bf16 v[40:43], v[164:167], v[212:215], v[40:43]
    s_add_u32 s43, s43, 98304
    v_mfma_f32_16x16x32_bf16 v[44:47], v[168:171], v[212:215], v[44:47]
    ds_read_b128 v[212:215], v9 offset:38912
    v_mfma_f32_16x16x32_bf16 v[48:51], v[156:159], v[216:219], v[48:51]
    s_add_u32 m0, s58, 4096
    v_mfma_f32_16x16x32_bf16 v[52:55], v[160:163], v[216:219], v[52:55]
    buffer_load_dwordx4 v4, s[24:27], s43 offen offset:0 lds
    buffer_load_dwordx4 v5, s[24:27], s43 offen offset:1024 lds
    v_mfma_f32_16x16x32_bf16 v[56:59], v[164:167], v[216:219], v[56:59]
    buffer_load_dwordx4 v6, s[24:27], s43 offen offset:2048 lds
    v_mfma_f32_16x16x32_bf16 v[60:63], v[168:171], v[216:219], v[60:63]
    ds_read_b128 v[216:219], v9 offset:39936
    v_mfma_f32_16x16x32_bf16 v[64:67], v[156:159], v[220:223], v[64:67]
    buffer_load_dwordx4 v7, s[24:27], s43 offen offset:3072 lds
    v_mfma_f32_16x16x32_bf16 v[68:71], v[160:163], v[220:223], v[68:71]
    v_mfma_f32_16x16x32_bf16 v[72:75], v[164:167], v[220:223], v[72:75]
    ds_read_b64_tr_b16 v[172:173], v2 offset:8192
    ds_read_b64_tr_b16 v[174:175], v2 offset:10240
    v_mfma_f32_16x16x32_bf16 v[76:79], v[168:171], v[220:223], v[76:79]
    ds_read_b128 v[220:223], v9 offset:40960
    v_mfma_f32_16x16x32_bf16 v[80:83], v[156:159], v[224:227], v[80:83]
    ds_read_b64_tr_b16 v[244:245], v3 offset:8192
    v_mfma_f32_16x16x32_bf16 v[84:87], v[160:163], v[224:227], v[84:87]
    ds_read_b64_tr_b16 v[246:247], v3 offset:10240
    v_mfma_f32_16x16x32_bf16 v[88:91], v[164:167], v[224:227], v[88:91]
    ds_read_b64_tr_b16 v[248:249], v2 offset:8448
    ds_read_b64_tr_b16 v[250:251], v2 offset:10496
    v_mfma_f32_16x16x32_bf16 v[92:95], v[168:171], v[224:227], v[92:95]
    ds_read_b128 v[224:227], v9 offset:41984
    v_mfma_f32_16x16x32_bf16 v[96:99], v[156:159], v[228:231], v[96:99]
    ds_read_b64_tr_b16 v[252:253], v3 offset:8448
    v_mfma_f32_16x16x32_bf16 v[100:103], v[160:163], v[228:231], v[100:103]
    ds_read_b64_tr_b16 v[254:255], v3 offset:10496
    v_mfma_f32_16x16x32_bf16 v[104:107], v[164:167], v[228:231], v[104:107]
    s_add_u32 m0, s59, 12288
    v_mfma_f32_16x16x32_bf16 v[108:111], v[168:171], v[228:231], v[108:111]
    ds_read_b128 v[228:231], v9 offset:43008
    s_waitcnt lgkmcnt(14)
    s_nop 0
    v_mfma_f32_16x16x32_bf16 v[112:115], v[156:159], v[232:235], v[112:115]
    s_mov_b32 s50, 520192
    s_waitcnt vmcnt(13)
    s_nop 0
    v_mfma_f32_16x16x32_bf16 v[116:119], v[160:163], v[232:235], v[116:119]
    buffer_load_dwordx4 v133, s[20:23], s50 offen offset:1024 nt lds
    v_mfma_f32_16x16x32_bf16 v[120:123], v[164:167], v[232:235], v[120:123]
    s_add_u32 m0, s59, 12288
    v_mfma_f32_16x16x32_bf16 v[124:127], v[168:171], v[232:235], v[124:127]
    ds_read_b128 v[232:235], v9 offset:44032
    v_mfma_f32_16x16x32_bf16 v[176:179], v[156:159], v[236:239], v[176:179]
    s_mov_b32 s50, 520192
    v_mfma_f32_16x16x32_bf16 v[180:183], v[160:163], v[236:239], v[180:183]
    s_waitcnt vmcnt(13)
    s_nop 0
    buffer_load_dwordx4 v134, s[20:23], s50 offen offset:2048 nt lds
    v_mfma_f32_16x16x32_bf16 v[184:187], v[164:167], v[236:239], v[184:187]
    s_add_u32 m0, s59, 12288
    v_mfma_f32_16x16x32_bf16 v[188:191], v[168:171], v[236:239], v[188:191]
    ds_read_b128 v[236:239], v9 offset:45056
    v_mfma_f32_16x16x32_bf16 v[192:195], v[156:159], v[240:243], v[192:195]
    s_mov_b32 s50, 520192
    v_mfma_f32_16x16x32_bf16 v[196:199], v[160:163], v[240:243], v[196:199]
    s_waitcnt vmcnt(13)
    s_nop 0
    buffer_load_dwordx4 v135, s[20:23], s50 offen offset:3072 nt lds
    v_mfma_f32_16x16x32_bf16 v[200:203], v[164:167], v[240:243], v[200:203]
    v_mfma_f32_16x16x32_bf16 v[204:207], v[168:171], v[240:243], v[204:207]
    ds_read_b128 v[240:243], v9 offset:46080
    s_waitcnt lgkmcnt(3)
    v_mov_b32 v141, 5
    ds_write_b32 v140, v141
    ds_read_b32 v144, v143
    v_mfma_f32_16x16x32_bf16 v[16:19], v[172:175], v[208:211], v[16:19]
    s_add_u32 s44, s38, 2
    s_nop 0
    v_mfma_f32_16x16x32_bf16 v[20:23], v[244:247], v[208:211], v[20:23]
    s_and_b32 s44, s44, 3
    s_and_b32 s43, s38, 12
    v_mfma_f32_16x16x32_bf16 v[24:27], v[248:251], v[208:211], v[24:27]
    s_add_u32 s44, s44, s43
    s_lshl_b32 s44, s44, 3
    v_mfma_f32_16x16x32_bf16 v[28:31], v[252:255], v[208:211], v[28:31]
    s_waitcnt lgkmcnt(0)
L_fs5:
    v_readfirstlane_b32 s42, v144
    s_nop 0
    s_cmp_ge_u32 s42, 5
    s_cbranch_scc1 L_fs5k
    s_nop 0
    ds_read_b32 v144, v143
    s_waitcnt lgkmcnt(0)
    s_branch L_fs5
L_fs5k:
    ds_read_b128 v[208:211], v9 offset:47104
    v_mfma_f32_16x16x32_bf16 v[32:35], v[172:175], v[212:215], v[32:35]
    s_lshl_b32 s43, s44, 15
    s_add_u32 s43, s43, 0
    v_mfma_f32_16x16x32_bf16 v[36:39], v[244:247], v[212:215], v[36:39]
    s_add_u32 m0, s58, 8192
    v_mfma_f32_16x16x32_bf16 v[40:43], v[248:251], v[212:215], v[40:43]
    buffer_load_dwordx4 v4, s[24:27], s43 offen offset:0 lds
    buffer_load_dwordx4 v5, s[24:27], s43 offen offset:1024 lds
    v_mfma_f32_16x16x32_bf16 v[44:47], v[252:255], v[212:215], v[44:47]
    ds_read_b128 v[212:215], v9 offset:48128
    v_mfma_f32_16x16x32_bf16 v[48:51], v[172:175], v[216:219], v[48:51]
    buffer_load_dwordx4 v6, s[24:27], s43 offen offset:2048 lds
    buffer_load_dwordx4 v7, s[24:27], s43 offen offset:3072 lds
    v_mfma_f32_16x16x32_bf16 v[52:55], v[244:247], v[216:219], v[52:55]
    ds_read_b64_tr_b16 v[156:157], v2 offset:0
    v_mfma_f32_16x16x32_bf16 v[56:59], v[248:251], v[216:219], v[56:59]
    ds_read_b64_tr_b16 v[158:159], v2 offset:2048
    v_mfma_f32_16x16x32_bf16 v[60:63], v[252:255], v[216:219], v[60:63]
    ds_read_b128 v[216:219], v9 offset:49152
    v_mfma_f32_16x16x32_bf16 v[64:67], v[172:175], v[220:223], v[64:67]
    ds_read_b64_tr_b16 v[160:161], v3 offset:0
    ds_read_b64_tr_b16 v[162:163], v3 offset:2048
    v_mfma_f32_16x16x32_bf16 v[68:71], v[244:247], v[220:223], v[68:71]
    ds_read_b64_tr_b16 v[164:165], v2 offset:256
    ds_read_b64_tr_b16 v[166:167], v2 offset:2304
    v_mfma_f32_16x16x32_bf16 v[72:75], v[248:251], v[220:223], v[72:75]
    ds_read_b64_tr_b16 v[168:169], v3 offset:256
    ds_read_b64_tr_b16 v[170:171], v3 offset:2304
    v_mfma_f32_16x16x32_bf16 v[76:79], v[252:255], v[220:223], v[76:79]
    ds_read_b128 v[220:223], v9 offset:50176
    v_mfma_f32_16x16x32_bf16 v[80:83], v[172:175], v[224:227], v[80:83]
    s_add_u32 s44, s38, 2
    s_and_b32 s44, s44, 3
    v_mfma_f32_16x16x32_bf16 v[84:87], v[244:247], v[224:227], v[84:87]
    s_and_b32 s43, s38, 12
    s_nop 0
    v_mfma_f32_16x16x32_bf16 v[88:91], v[248:251], v[224:227], v[88:91]
    s_add_u32 s44, s44, s43
    s_lshl_b32 s44, s44, 3
    v_mfma_f32_16x16x32_bf16 v[92:95], v[252:255], v[224:227], v[92:95]
    ds_read_b128 v[224:227], v9 offset:51200
    v_mfma_f32_16x16x32_bf16 v[96:99], v[172:175], v[228:231], v[96:99]
    s_and_b32 s43, s36, 1
    s_add_u32 s44, s44, s43
    v_mfma_f32_16x16x32_bf16 v[100:103], v[244:247], v[228:231], v[100:103]
    s_add_u32 s44, s44, 0
    s_nop 0
    s_mul_i32 s44, s44, 9216
    v_mfma_f32_16x16x32_bf16 v[104:107], v[248:251], v[228:231], v[104:107]
    s_mul_i32 s63, s43, 9216
    v_mfma_f32_16x16x32_bf16 v[108:111], v[252:255], v[228:231], v[108:111]
    ds_read_b128 v[228:231], v9 offset:52224
    v_mfma_f32_16x16x32_bf16 v[112:115], v[172:175], v[232:235], v[112:115]
    s_add_u32 m0, s63, 98304
    s_add_u32 s43, s44, 0
    s_nop 0
    v_mfma_f32_16x16x32_bf16 v[116:119], v[244:247], v[232:235], v[116:119]
    buffer_load_dwordx4 v8, s[16:19], s43 offen offset:0 sc1 lds
    buffer_load_dwordx4 v8, s[16:19], s43 offen offset:1024 sc1 lds
    v_mfma_f32_16x16x32_bf16 v[120:123], v[248:251], v[232:235], v[120:123]
    buffer_load_dwordx4 v8, s[16:19], s43 offen offset:2048 sc1 lds
    buffer_load_dwordx4 v8, s[16:19], s43 offen offset:3072 sc1 lds
    v_mfma_f32_16x16x32_bf16 v[124:127], v[252:255], v[232:235], v[124:127]
    ds_read_b128 v[232:235], v9 offset:53248
    v_mfma_f32_16x16x32_bf16 v[176:179], v[172:175], v[236:239], v[176:179]
    s_add_u32 m0, s63, 102400
    v_mfma_f32_16x16x32_bf16 v[180:183], v[244:247], v[236:239], v[180:183]
    s_add_u32 s43, s44, 4096
    buffer_load_dwordx4 v8, s[16:19], s43 offen offset:0 sc1 lds
    v_mfma_f32_16x16x32_bf16 v[184:187], v[248:251], v[236:239], v[184:187]
    buffer_load_dwordx4 v8, s[16:19], s43 offen offset:1024 sc1 lds
    buffer_load_dwordx4 v8, s[16:19], s43 offen offset:2048 sc1 lds
    v_mfma_f32_16x16x32_bf16 v[188:191], v[252:255], v[236:239], v[188:191]
    ds_read_b128 v[236:239], v9 offset:54272
    v_mfma_f32_16x16x32_bf16 v[192:195], v[172:175], v[240:243], v[192:195]
    buffer_load_dwordx4 v8, s[16:19], s43 offen offset:3072 sc1 lds
    s_add_u32 m0, s63, 106496
    v_mfma_f32_16x16x32_bf16 v[196:199], v[244:247], v[240:243], v[196:199]
    s_add_u32 s43, s44, 8192
    buffer_load_dwordx4 v8, s[16:19], s43 offen offset:0 sc1 lds
    v_mfma_f32_16x16x32_bf16 v[200:203], v[248:251], v[240:243], v[200:203]
    v_mfma_f32_16x16x32_bf16 v[204:207], v[252:255], v[240:243], v[204:207]
    ds_read_b128 v[240:243], v9 offset:55296
    s_waitcnt vmcnt(13)
    s_barrier
    s_add_u32 s44, s38, 2
    s_and_b32 s44, s44, 3
    s_and_b32 s43, s38, 12
    s_add_u32 s44, s44, s43
    s_lshl_b32 s44, s44, 3
    s_and_b32 s43, s36, 1
    s_add_u32 s44, s44, s43
    s_add_u32 s44, s44, 2
    s_mul_i32 s44, s44, 9216
    s_mul_i32 s63, s43, 9216
    s_add_u32 m0, s63, 69632
    s_add_u32 s43, s44, 0
    s_nop 0
    buffer_load_dwordx4 v8, s[16:19], s43 offen offset:0 sc1 lds
    buffer_load_dwordx4 v8, s[16:19], s43 offen offset:1024 sc1 lds
    buffer_load_dwordx4 v8, s[16:19], s43 offen offset:2048 sc1 lds
    buffer_load_dwordx4 v8, s[16:19], s43 offen offset:3072 sc1 lds
    s_add_u32 m0, s63, 73728
    s_add_u32 s43, s44, 4096
    buffer_load_dwordx4 v8, s[16:19], s43 offen offset:0 sc1 lds
    buffer_load_dwordx4 v8, s[16:19], s43 offen offset:1024 sc1 lds
    buffer_load_dwordx4 v8, s[16:19], s43 offen offset:2048 sc1 lds
    buffer_load_dwordx4 v8, s[16:19], s43 offen offset:3072 sc1 lds
    s_add_u32 m0, s63, 77824
    s_add_u32 s43, s44, 8192
    buffer_load_dwordx4 v8, s[16:19], s43 offen offset:0 sc1 lds
    s_waitcnt lgkmcnt(3)
    s_nop 0
    v_mfma_f32_16x16x32_bf16 v[16:19], v[156:159], v[208:211], v[16:19]
    v_mfma_f32_16x16x32_bf16 v[20:23], v[160:163], v[208:211], v[20:23]
    s_add_u32 s44, s38, 2
    s_nop 0
    v_mfma_f32_16x16x32_bf16 v[24:27], v[164:167], v[208:211], v[24:27]
    s_and_b32 s44, s44, 3
    s_nop 0
    v_mfma_f32_16x16x32_bf16 v[28:31], v[168:171], v[208:211], v[28:31]
    ds_read_b128 v[208:211], v9 offset:56320
    v_mfma_f32_16x16x32_bf16 v[32:35], v[156:159], v[212:215], v[32:35]
    s_and_b32 s43, s38, 12
    s_nop 0
    v_mfma_f32_16x16x32_bf16 v[36:39], v[160:163], v[212:215], v[36:39]
    s_add_u32 s44, s44, s43
    s_nop 0
    v_mfma_f32_16x16x32_bf16 v[40:43], v[164:167], v[212:215], v[40:43]
    v_mfma_f32_16x16x32_bf16 v[44:47], v[168:171], v[212:215], v[44:47]
    ds_read_b128 v[212:215], v9 offset:57344
    v_mfma_f32_16x16x32_bf16 v[48:51], v[156:159], v[216:219], v[48:51]
    s_lshl_b32 s44, s44, 3
    s_nop 0
    v_mfma_f32_16x16x32_bf16 v[52:55], v[160:163], v[216:219], v[52:55]
    s_lshl_b32 s43, s44, 15
    s_nop 0
    v_mfma_f32_16x16x32_bf16 v[56:59], v[164:167], v[216:219], v[56:59]
    s_add_u32 s43, s43, 32768
    v_mfma_f32_16x16x32_bf16 v[60:63], v[168:171], v[216:219], v[60:63]
    ds_read_b128 v[216:219], v9 offset:58368
    v_mfma_f32_16x16x32_bf16 v[64:67], v[156:159], v[220:223], v[64:67]
    s_add_u32 m0, s58, 0
    s_nop 0
    v_mfma_f32_16x16x32_bf16 v[68:71], v[160:163], v[220:223], v[68:71]
    v_mfma_f32_16x16x32_bf16 v[72:75], v[164:167], v[220:223], v[72:75]
    buffer_load_dwordx4 v4, s[24:27], s43 offen offset:0 lds
    v_mfma_f32_16x16x32_bf16 v[76:79], v[168:171], v[220:223], v[76:79]
    ds_read_b128 v[220:223], v9 offset:59392
    v_mfma_f32_16x16x32_bf16 v[80:83], v[156:159], v[224:227], v[80:83]
    buffer_load_dwordx4 v5, s[24:27], s43 offen offset:1024 lds
    v_mfma_f32_16x16x32_bf16 v[84:87], v[160:163], v[224:227], v[84:87]
    buffer_load_dwordx4 v6, s[24:27], s43 offen offset:2048 lds
    v_mfma_f32_16x16x32_bf16 v[88:91], v[164:167], v[224:227], v[88:91]
    buffer_load_dwordx4 v7, s[24:27], s43 offen offset:3072 lds
    v_mfma_f32_16x16x32_bf16 v[92:95], v[168:171], v[224:227], v[92:95]
    ds_read_b128 v[224:227], v9 offset:60416
    v_mfma_f32_16x16x32_bf16 v[96:99], v[156:159], v[228:231], v[96:99]
    v_mfma_f32_16x16x32_bf16 v[100:103], v[160:163], v[228:231], v[100:103]
    v_mfma_f32_16x16x32_bf16 v[104:107], v[164:167], v[228:231], v[104:107]
    ds_read_b64_tr_b16 v[172:173], v2 offset:4096
    v_mfma_f32_16x16x32_bf16 v[108:111], v[168:171], v[228:231], v[108:111]
    ds_read_b128 v[228:231], v9 offset:61440
    s_waitcnt lgkmcnt(9)
    s_nop 0
    v_mfma_f32_16x16x32_bf16 v[112:115], v[156:159], v[232:235], v[112:115]
    ds_read_b64_tr_b16 v[174:175], v2 offset:6144
    v_mfma_f32_16x16x32_bf16 v[116:119], v[160:163], v[232:235], v[116:119]
    ds_read_b64_tr_b16 v[244:245], v3 offset:4096
    v_mfma_f32_16x16x32_bf16 v[120:123], v[164:167], v[232:235], v[120:123]
    v_mfma_f32_16x16x32_bf16 v[124:127], v[168:171], v[232:235], v[124:127]
    ds_read_b128 v[232:235], v9 offset:62464
    s_waitcnt lgkmcnt(11)
    s_nop 0
    v_mfma_f32_16x16x32_bf16 v[176:179], v[156:159], v[236:239], v[176:179]
    ds_read_b64_tr_b16 v[246:247], v3 offset:6144
    v_mfma_f32_16x16x32_bf16 v[180:183], v[160:163], v[236:239], v[180:183]
    ds_read_b64_tr_b16 v[248:249], v2 offset:4352
    v_mfma_f32_16x16x32_bf16 v[184:187], v[164:167], v[236:239], v[184:187]
    ds_read_b64_tr_b16 v[250:251], v2 offset:6400
    v_mfma_f32_16x16x32_bf16 v[188:191], v[168:171], v[236:239], v[188:191]
    ds_read_b128 v[236:239], v9 offset:63488
    s_waitcnt lgkmcnt(14)
    s_nop 0
    v_mfma_f32_16x16x32_bf16 v[192:195], v[156:159], v[240:243], v[192:195]
    ds_read_b64_tr_b16 v[252:253], v3 offset:4352
    v_mfma_f32_16x16x32_bf16 v[196:199], v[160:163], v[240:243], v[196:199]
    ds_read_b64_tr_b16 v[254:255], v3 offset:6400
    v_mfma_f32_16x16x32_bf16 v[200:203], v[164:167], v[240:243], v[200:203]
    v_mfma_f32_16x16x32_bf16 v[204:207], v[168:171], v[240:243], v[204:207]
    ds_read_b128 v[240:243], v9 offset:64512
    s_waitcnt lgkmcnt(1)
    s_waitcnt vmcnt(13)
    v_mov_b32_e64 v141, 7
    ds_write_b32 v140, v141
    ds_read_b32 v144, v143
    v_mfma_f32_16x16x32_bf16 v[16:19], v[172:175], v[208:211], v[16:19]
    s_add_u32 s44, s38, 2
    s_nop 0
    v_mfma_f32_16x16x32_bf16 v[20:23], v[244:247], v[208:211], v[20:23]
    s_and_b32 s44, s44, 3
    s_and_b32 s43, s38, 12
    v_mfma_f32_16x16x32_bf16 v[24:27], v[248:251], v[208:211], v[24:27]
    s_add_u32 s44, s44, s43
    s_lshl_b32 s44, s44, 3
    v_mfma_f32_16x16x32_bf16 v[28:31], v[252:255], v[208:211], v[28:31]
    s_waitcnt lgkmcnt(0)
L_fs7:
    v_readfirstlane_b32 s42, v144
    s_nop 0
    s_cmp_ge_u32 s42, 7
    s_cbranch_scc1 L_fs7k
    s_nop 0
    ds_read_b32 v144, v143
    s_waitcnt lgkmcnt(0)
    s_branch L_fs7
L_fs7k:
    ds_read_b128 v[208:211], v9 offset:28672
    v_mfma_f32_16x16x32_bf16 v[32:35], v[172:175], v[212:215], v[32:35]
    s_lshl_b32 s43, s44, 15
    s_nop 0
    s_add_u32 s43, s43, 65536
    v_mfma_f32_16x16x32_bf16 v[36:39], v[244:247], v[212:215], v[36:39]
    s_add_u32 m0, s58, 4096
    v_mfma_f32_16x16x32_bf16 v[40:43], v[248:251], v[212:215], v[40:43]
    buffer_load_dwordx4 v4, s[24:27], s43 offen offset:0 lds
    buffer_load_dwordx4 v5, s[24:27], s43 offen offset:1024 lds
    v_mfma_f32_16x16x32_bf16 v[44:47], v[252:255], v[212:215], v[44:47]
    ds_read_b128 v[212:215], v9 offset:29696
    v_mfma_f32_16x16x32_bf16 v[48:51], v[172:175], v[216:219], v[48:51]
    buffer_load_dwordx4 v6, s[24:27], s43 offen offset:2048 lds
    buffer_load_dwordx4 v7, s[24:27], s43 offen offset:3072 lds
    v_mfma_f32_16x16x32_bf16 v[52:55], v[244:247], v[216:219], v[52:55]
    ds_read_b64_tr_b16 v[156:157], v2 offset:8192
    v_mfma_f32_16x16x32_bf16 v[56:59], v[248:251], v[216:219], v[56:59]
    ds_read_b64_tr_b16 v[158:159], v2 offset:10240
    v_mfma_f32_16x16x32_bf16 v[60:63], v[252:255], v[216:219], v[60:63]
    ds_read_b128 v[216:219], v9 offset:30720
    v_mfma_f32_16x16x32_bf16 v[64:67], v[172:175], v[220:223], v[64:67]
    ds_read_b64_tr_b16 v[160:161], v3 offset:8192
    ds_read_b64_tr_b16 v[162:163], v3 offset:10240
    v_mfma_f32_16x16x32_bf16 v[68:71], v[244:247], v[220:223], v[68:71]
    ds_read_b64_tr_b16 v[164:165], v2 offset:8448
    ds_read_b64_tr_b16 v[166:167], v2 offset:10496
    v_mfma_f32_16x16x32_bf16 v[72:75], v[248:251], v[220:223], v[72:75]
    ds_read_b64_tr_b16 v[168:169], v3 offset:8448
    ds_read_b64_tr_b16 v[170:171], v3 offset:10496
    v_mfma_f32_16x16x32_bf16 v[76:79], v[252:255], v[220:223], v[76:79]
    ds_read_b128 v[220:223], v9 offset:31744
    v_mfma_f32_16x16x32_bf16 v[80:83], v[172:175], v[224:227], v[80:83]
    s_add_u32 s44, s38, 3
    s_and_b32 s44, s44, 3
    v_mfma_f32_16x16x32_bf16 v[84:87], v[244:247], v[224:227], v[84:87]
    s_and_b32 s43, s38, 12
    s_nop 0
    v_mfma_f32_16x16x32_bf16 v[88:91], v[248:251], v[224:227], v[88:91]
    s_add_u32 s44, s44, s43
    s_lshl_b32 s44, s44, 3
    v_mfma_f32_16x16x32_bf16 v[92:95], v[252:255], v[224:227], v[92:95]
    ds_read_b128 v[224:227], v9 offset:32768
    v_mfma_f32_16x16x32_bf16 v[96:99], v[172:175], v[228:231], v[96:99]
    s_and_b32 s43, s36, 1
    s_add_u32 s44, s44, s43
    v_mfma_f32_16x16x32_bf16 v[100:103], v[244:247], v[228:231], v[100:103]
    s_add_u32 s44, s44, 0
    s_nop 0
    s_mul_i32 s44, s44, 9216
    v_mfma_f32_16x16x32_bf16 v[104:107], v[248:251], v[228:231], v[104:107]
    s_mul_i32 s63, s43, 9216
    v_mfma_f32_16x16x32_bf16 v[108:111], v[252:255], v[228:231], v[108:111]
    ds_read_b128 v[228:231], v9 offset:33792
    v_mfma_f32_16x16x32_bf16 v[112:115], v[172:175], v[232:235], v[112:115]
    s_add_u32 m0, s63, 116736
    s_add_u32 s43, s44, 0
    s_nop 0
    v_mfma_f32_16x16x32_bf16 v[116:119], v[244:247], v[232:235], v[116:119]
    buffer_load_dwordx4 v8, s[16:19], s43 offen offset:0 sc1 lds
    buffer_load_dwordx4 v8, s[16:19], s43 offen offset:1024 sc1 lds
    v_mfma_f32_16x16x32_bf16 v[120:123], v[248:251], v[232:235], v[120:123]
    buffer_load_dwordx4 v8, s[16:19], s43 offen offset:2048 sc1 lds
    buffer_load_dwordx4 v8, s[16:19], s43 offen offset:3072 sc1 lds
    v_mfma_f32_16x16x32_bf16 v[124:127], v[252:255], v[232:235], v[124:127]
    ds_read_b128 v[232:235], v9 offset:34816
    v_mfma_f32_16x16x32_bf16 v[176:179], v[172:175], v[236:239], v[176:179]
    s_add_u32 m0, s63, 120832
    v_mfma_f32_16x16x32_bf16 v[180:183], v[244:247], v[236:239], v[180:183]
    s_add_u32 s43, s44, 4096
    buffer_load_dwordx4 v8, s[16:19], s43 offen offset:0 sc1 lds
    v_mfma_f32_16x16x32_bf16 v[184:187], v[248:251], v[236:239], v[184:187]
    buffer_load_dwordx4 v8, s[16:19], s43 offen offset:1024 sc1 lds
    buffer_load_dwordx4 v8, s[16:19], s43 offen offset:2048 sc1 lds
    v_mfma_f32_16x16x32_bf16 v[188:191], v[252:255], v[236:239], v[188:191]
    ds_read_b128 v[236:239], v9 offset:35840
    v_mfma_f32_16x16x32_bf16 v[192:195], v[172:175], v[240:243], v[192:195]
    buffer_load_dwordx4 v8, s[16:19], s43 offen offset:3072 sc1 lds
    s_add_u32 m0, s63, 124928
    v_mfma_f32_16x16x32_bf16 v[196:199], v[244:247], v[240:243], v[196:199]
    s_add_u32 s43, s44, 8192
    buffer_load_dwordx4 v8, s[16:19], s43 offen offset:0 sc1 lds
    v_mfma_f32_16x16x32_bf16 v[200:203], v[248:251], v[240:243], v[200:203]
    v_mfma_f32_16x16x32_bf16 v[204:207], v[252:255], v[240:243], v[204:207]
    ds_read_b128 v[240:243], v9 offset:36864
    s_waitcnt lgkmcnt(3)
    s_nop 0
    v_mfma_f32_16x16x32_bf16 v[16:19], v[156:159], v[208:211], v[16:19]
    v_mfma_f32_16x16x32_bf16 v[20:23], v[160:163], v[208:211], v[20:23]
    s_add_u32 s44, s38, 2
    s_nop 0
    v_mfma_f32_16x16x32_bf16 v[24:27], v[164:167], v[208:211], v[24:27]
    s_and_b32 s44, s44, 3
    s_nop 0
    v_mfma_f32_16x16x32_bf16 v[28:31], v[168:171], v[208:211], v[28:31]
    ds_read_b128 v[208:211], v9 offset:37888
    v_mfma_f32_16x16x32_bf16 v[32:35], v[156:159], v[212:215], v[32:35]
    s_and_b32 s43, s38, 12
    s_nop 0
    v_mfma_f32_16x16x32_bf16 v[36:39], v[160:163], v[212:215], v[36:39]
    s_add_u32 s44, s44, s43
    s_nop 0
    v_mfma_f32_16x16x32_bf16 v[40:43], v[164:167], v[212:215], v[40:43]
    v_mfma_f32_16x16x32_bf16 v[44:47], v[168:171], v[212:215], v[44:47]
    ds_read_b128 v[212:215], v9 offset:38912
    v_mfma_f32_16x16x32_bf16 v[48:51], v[156:159], v[216:219], v[48:51]
    s_lshl_b32 s44, s44, 3
    s_nop 0
    v_mfma_f32_16x16x32_bf16 v[52:55], v[160:163], v[216:219], v[52:55]
    s_lshl_b32 s43, s44, 15
    s_nop 0
    v_mfma_f32_16x16x32_bf16 v[56:59], v[164:167], v[216:219], v[56:59]
    s_add_u32 s43, s43, 98304
    v_mfma_f32_16x16x32_bf16 v[60:63], v[168:171], v[216:219], v[60:63]
    ds_read_b128 v[216:219], v9 offset:39936
    v_mfma_f32_16x16x32_bf16 v[64:67], v[156:159], v[220:223], v[64:67]
    s_add_u32 m0, s58, 8192
    v_mfma_f32_16x16x32_bf16 v[68:71], v[160:163], v[220:223], v[68:71]
    v_mfma_f32_16x16x32_bf16 v[72:75], v[164:167], v[220:223], v[72:75]
    buffer_load_dwordx4 v4, s[24:27], s43 offen offset:0 lds
    v_mfma_f32_16x16x32_bf16 v[76:79], v[168:171], v[220:223], v[76:79]
    ds_read_b128 v[220:223], v9 offset:40960
    v_mfma_f32_16x16x32_bf16 v[80:83], v[156:159], v[224:227], v[80:83]
    buffer_load_dwordx4 v5, s[24:27], s43 offen offset:1024 lds
    v_mfma_f32_16x16x32_bf16 v[84:87], v[160:163], v[224:227], v[84:87]
    buffer_load_dwordx4 v6, s[24:27], s43 offen offset:2048 lds
    v_mfma_f32_16x16x32_bf16 v[88:91], v[164:167], v[224:227], v[88:91]
    buffer_load_dwordx4 v7, s[24:27], s43 offen offset:3072 lds
    v_mfma_f32_16x16x32_bf16 v[92:95], v[168:171], v[224:227], v[92:95]
    ds_read_b128 v[224:227], v9 offset:41984
    v_mfma_f32_16x16x32_bf16 v[96:99], v[156:159], v[228:231], v[96:99]
    v_mfma_f32_16x16x32_bf16 v[100:103], v[160:163], v[228:231], v[100:103]
    s_waitcnt vmcnt(17)
    s_nop 0
    v_mfma_f32_16x16x32_bf16 v[104:107], v[164:167], v[228:231], v[104:107]
    ds_read_b64_tr_b16 v[172:173], v2 offset:0
    v_mfma_f32_16x16x32_bf16 v[108:111], v[168:171], v[228:231], v[108:111]
    ds_read_b128 v[228:231], v9 offset:43008
    s_waitcnt lgkmcnt(9)
    s_nop 0
    v_mfma_f32_16x16x32_bf16 v[112:115], v[156:159], v[232:235], v[112:115]
    ds_read_b64_tr_b16 v[174:175], v2 offset:2048
    v_mfma_f32_16x16x32_bf16 v[116:119], v[160:163], v[232:235], v[116:119]
    ds_read_b64_tr_b16 v[244:245], v3 offset:0
    v_mfma_f32_16x16x32_bf16 v[120:123], v[164:167], v[232:235], v[120:123]
    v_mfma_f32_16x16x32_bf16 v[124:127], v[168:171], v[232:235], v[124:127]
    ds_read_b128 v[232:235], v9 offset:44032
    s_waitcnt lgkmcnt(11)
    s_nop 0
    v_mfma_f32_16x16x32_bf16 v[176:179], v[156:159], v[236:239], v[176:179]
    ds_read_b64_tr_b16 v[246:247], v3 offset:2048
    v_mfma_f32_16x16x32_bf16 v[180:183], v[160:163], v[236:239], v[180:183]
    ds_read_b64_tr_b16 v[248:249], v2 offset:256
    v_mfma_f32_16x16x32_bf16 v[184:187], v[164:167], v[236:239], v[184:187]
    ds_read_b64_tr_b16 v[250:251], v2 offset:2304
    v_mfma_f32_16x16x32_bf16 v[188:191], v[168:171], v[236:239], v[188:191]
    ds_read_b128 v[236:239], v9 offset:45056
    s_waitcnt lgkmcnt(14)
    s_nop 0
    v_mfma_f32_16x16x32_bf16 v[192:195], v[156:159], v[240:243], v[192:195]
    ds_read_b64_tr_b16 v[252:253], v3 offset:256
    v_mfma_f32_16x16x32_bf16 v[196:199], v[160:163], v[240:243], v[196:199]
    ds_read_b64_tr_b16 v[254:255], v3 offset:2304
    v_mfma_f32_16x16x32_bf16 v[200:203], v[164:167], v[240:243], v[200:203]
    v_mfma_f32_16x16x32_bf16 v[204:207], v[168:171], v[240:243], v[204:207]
    ds_read_b128 v[240:243], v9 offset:46080
    s_waitcnt lgkmcnt(1)
    v_mov_b32 v141, 9
    ds_write_b32 v140, v141
    ds_read_b32 v144, v143
    v_mfma_f32_16x16x32_bf16 v[16:19], v[172:175], v[208:211], v[16:19]
    s_add_u32 s44, s38, 3
    s_nop 0
    v_mfma_f32_16x16x32_bf16 v[20:23], v[244:247], v[208:211], v[20:23]
    s_and_b32 s44, s44, 3
    s_and_b32 s43, s38, 12
    v_mfma_f32_16x16x32_bf16 v[24:27], v[248:251], v[208:211], v[24:27]
    s_add_u32 s44, s44, s43
    s_lshl_b32 s44, s44, 3
    v_mfma_f32_16x16x32_bf16 v[28:31], v[252:255], v[208:211], v[28:31]
    s_waitcnt lgkmcnt(0)
L_fs9:
    v_readfirstlane_b32 s42, v144
    s_nop 0
    s_cmp_ge_u32 s42, 9
    s_cbranch_scc1 L_fs9k
    s_nop 0
    ds_read_b32 v144, v143
    s_waitcnt lgkmcnt(0)
    s_branch L_fs9
L_fs9k:
    ds_read_b128 v[208:211], v9 offset:0
    v_mfma_f32_16x16x32_bf16 v[32:35], v[172:175], v[212:215], v[32:35]
    s_lshl_b32 s43, s44, 15
    s_add_u32 s43, s43, 0
    v_mfma_f32_16x16x32_bf16 v[36:39], v[244:247], v[212:215], v[36:39]
    s_add_u32 m0, s58, 0
    s_nop 0
    v_mfma_f32_16x16x32_bf16 v[40:43], v[248:251], v[212:215], v[40:43]
    buffer_load_dwordx4 v4, s[24:27], s43 offen offset:0 lds
    buffer_load_dwordx4 v5, s[24:27], s43 offen offset:1024 lds
    v_mfma_f32_16x16x32_bf16 v[44:47], v[252:255], v[212:215], v[44:47]
    ds_read_b128 v[212:215], v9 offset:1024
    v_mfma_f32_16x16x32_bf16 v[48:51], v[172:175], v[216:219], v[48:51]
    buffer_load_dwordx4 v6, s[24:27], s43 offen offset:2048 lds
    buffer_load_dwordx4 v7, s[24:27], s43 offen offset:3072 lds
    v_mfma_f32_16x16x32_bf16 v[52:55], v[244:247], v[216:219], v[52:55]
    s_waitcnt vmcnt(17)
    s_nop 0
    ds_read_b64_tr_b16 v[156:157], v2 offset:4096
    v_mfma_f32_16x16x32_bf16 v[56:59], v[248:251], v[216:219], v[56:59]
    ds_read_b64_tr_b16 v[158:159], v2 offset:6144
    v_mfma_f32_16x16x32_bf16 v[60:63], v[252:255], v[216:219], v[60:63]
    ds_read_b128 v[216:219], v9 offset:2048
    v_mfma_f32_16x16x32_bf16 v[64:67], v[172:175], v[220:223], v[64:67]
    ds_read_b64_tr_b16 v[160:161], v3 offset:4096
    ds_read_b64_tr_b16 v[162:163], v3 offset:6144
    v_mfma_f32_16x16x32_bf16 v[68:71], v[244:247], v[220:223], v[68:71]
    ds_read_b64_tr_b16 v[164:165], v2 offset:4352
    ds_read_b64_tr_b16 v[166:167], v2 offset:6400
    v_mfma_f32_16x16x32_bf16 v[72:75], v[248:251], v[220:223], v[72:75]
    ds_read_b64_tr_b16 v[168:169], v3 offset:4352
    ds_read_b64_tr_b16 v[170:171], v3 offset:6400
    v_mfma_f32_16x16x32_bf16 v[76:79], v[252:255], v[220:223], v[76:79]
    ds_read_b128 v[220:223], v9 offset:3072
    v_mfma_f32_16x16x32_bf16 v[80:83], v[172:175], v[224:227], v[80:83]
    s_add_u32 s44, s38, 3
    s_and_b32 s44, s44, 3
    v_mfma_f32_16x16x32_bf16 v[84:87], v[244:247], v[224:227], v[84:87]
    s_and_b32 s43, s38, 12
    s_nop 0
    v_mfma_f32_16x16x32_bf16 v[88:91], v[248:251], v[224:227], v[88:91]
    s_add_u32 s44, s44, s43
    s_lshl_b32 s44, s44, 3
    v_mfma_f32_16x16x32_bf16 v[92:95], v[252:255], v[224:227], v[92:95]
    ds_read_b128 v[224:227], v9 offset:4096
    v_mfma_f32_16x16x32_bf16 v[96:99], v[172:175], v[228:231], v[96:99]
    s_and_b32 s43, s36, 1
    s_add_u32 s44, s44, s43
    v_mfma_f32_16x16x32_bf16 v[100:103], v[244:247], v[228:231], v[100:103]
    s_add_u32 s44, s44, 2
    s_nop 0
    s_mul_i32 s44, s44, 9216
    v_mfma_f32_16x16x32_bf16 v[104:107], v[248:251], v[228:231], v[104:107]
    s_mul_i32 s63, s43, 9216
    v_mfma_f32_16x16x32_bf16 v[108:111], v[252:255], v[228:231], v[108:111]
    ds_read_b128 v[228:231], v9 offset:5120
    v_mfma_f32_16x16x32_bf16 v[112:115], v[172:175], v[232:235], v[112:115]
    s_add_u32 m0, s63, 98304
    s_add_u32 s43, s44, 0
    s_nop 0
    v_mfma_f32_16x16x32_bf16 v[116:119], v[244:247], v[232:235], v[116:119]
    buffer_load_dwordx4 v8, s[16:19], s43 offen offset:0 sc1 lds
    buffer_load_dwordx4 v8, s[16:19], s43 offen offset:1024 sc1 lds
    v_mfma_f32_16x16x32_bf16 v[120:123], v[248:251], v[232:235], v[120:123]
    buffer_load_dwordx4 v8, s[16:19], s43 offen offset:2048 sc1 lds
    buffer_load_dwordx4 v8, s[16:19], s43 offen offset:3072 sc1 lds
    v_mfma_f32_16x16x32_bf16 v[124:127], v[252:255], v[232:235], v[124:127]
    ds_read_b128 v[232:235], v9 offset:6144
    v_mfma_f32_16x16x32_bf16 v[176:179], v[172:175], v[236:239], v[176:179]
    s_add_u32 m0, s63, 102400
    v_mfma_f32_16x16x32_bf16 v[180:183], v[244:247], v[236:239], v[180:183]
    s_add_u32 s43, s44, 4096
    buffer_load_dwordx4 v8, s[16:19], s43 offen offset:0 sc1 lds
    v_mfma_f32_16x16x32_bf16 v[184:187], v[248:251], v[236:239], v[184:187]
    buffer_load_dwordx4 v8, s[16:19], s43 offen offset:1024 sc1 lds
    buffer_load_dwordx4 v8, s[16:19], s43 offen offset:2048 sc1 lds
    v_mfma_f32_16x16x32_bf16 v[188:191], v[252:255], v[236:239], v[188:191]
    ds_read_b128 v[236:239], v9 offset:7168
    v_mfma_f32_16x16x32_bf16 v[192:195], v[172:175], v[240:243], v[192:195]
    buffer_load_dwordx4 v8, s[16:19], s43 offen offset:3072 sc1 lds
    s_add_u32 m0, s63, 106496
    v_mfma_f32_16x16x32_bf16 v[196:199], v[244:247], v[240:243], v[196:199]
    s_add_u32 s43, s44, 8192
    buffer_load_dwordx4 v8, s[16:19], s43 offen offset:0 sc1 lds
    v_mfma_f32_16x16x32_bf16 v[200:203], v[248:251], v[240:243], v[200:203]
    v_mfma_f32_16x16x32_bf16 v[204:207], v[252:255], v[240:243], v[204:207]
    ds_read_b128 v[240:243], v9 offset:8192
    s_waitcnt lgkmcnt(3)
    s_nop 0
    v_mfma_f32_16x16x32_bf16 v[16:19], v[156:159], v[208:211], v[16:19]
    v_mfma_f32_16x16x32_bf16 v[20:23], v[160:163], v[208:211], v[20:23]
    s_add_u32 s44, s38, 3
    s_nop 0
    v_mfma_f32_16x16x32_bf16 v[24:27], v[164:167], v[208:211], v[24:27]
    s_and_b32 s44, s44, 3
    s_nop 0
    v_mfma_f32_16x16x32_bf16 v[28:31], v[168:171], v[208:211], v[28:31]
    ds_read_b128 v[208:211], v9 offset:9216
    v_mfma_f32_16x16x32_bf16 v[32:35], v[156:159], v[212:215], v[32:35]
    s_and_b32 s43, s38, 12
    s_nop 0
    v_mfma_f32_16x16x32_bf16 v[36:39], v[160:163], v[212:215], v[36:39]
    s_add_u32 s44, s44, s43
    s_nop 0
    v_mfma_f32_16x16x32_bf16 v[40:43], v[164:167], v[212:215], v[40:43]
    v_mfma_f32_16x16x32_bf16 v[44:47], v[168:171], v[212:215], v[44:47]
    ds_read_b128 v[212:215], v9 offset:10240
    v_mfma_f32_16x16x32_bf16 v[48:51], v[156:159], v[216:219], v[48:51]
    s_lshl_b32 s44, s44, 3
    s_nop 0
    v_mfma_f32_16x16x32_bf16 v[52:55], v[160:163], v[216:219], v[52:55]
    s_lshl_b32 s43, s44, 15
    s_nop 0
    v_mfma_f32_16x16x32_bf16 v[56:59], v[164:167], v[216:219], v[56:59]
    s_add_u32 s43, s43, 32768
    v_mfma_f32_16x16x32_bf16 v[60:63], v[168:171], v[216:219], v[60:63]
    ds_read_b128 v[216:219], v9 offset:11264
    v_mfma_f32_16x16x32_bf16 v[64:67], v[156:159], v[220:223], v[64:67]
    s_add_u32 m0, s58, 4096
    v_mfma_f32_16x16x32_bf16 v[68:71], v[160:163], v[220:223], v[68:71]
    v_mfma_f32_16x16x32_bf16 v[72:75], v[164:167], v[220:223], v[72:75]
    buffer_load_dwordx4 v4, s[24:27], s43 offen offset:0 lds
    v_mfma_f32_16x16x32_bf16 v[76:79], v[168:171], v[220:223], v[76:79]
    ds_read_b128 v[220:223], v9 offset:12288
    v_mfma_f32_16x16x32_bf16 v[80:83], v[156:159], v[224:227], v[80:83]
    buffer_load_dwordx4 v5, s[24:27], s43 offen offset:1024 lds
    v_mfma_f32_16x16x32_bf16 v[84:87], v[160:163], v[224:227], v[84:87]
    buffer_load_dwordx4 v6, s[24:27], s43 offen offset:2048 lds
    v_mfma_f32_16x16x32_bf16 v[88:91], v[164:167], v[224:227], v[88:91]
    buffer_load_dwordx4 v7, s[24:27], s43 offen offset:3072 lds
    v_mfma_f32_16x16x32_bf16 v[92:95], v[168:171], v[224:227], v[92:95]
    ds_read_b128 v[224:227], v9 offset:13312
    v_mfma_f32_16x16x32_bf16 v[96:99], v[156:159], v[228:231], v[96:99]
    v_mfma_f32_16x16x32_bf16 v[100:103], v[160:163], v[228:231], v[100:103]
    s_waitcnt vmcnt(17)
    s_nop 0
    v_mfma_f32_16x16x32_bf16 v[104:107], v[164:167], v[228:231], v[104:107]
    ds_read_b64_tr_b16 v[172:173], v2 offset:8192
    v_mfma_f32_16x16x32_bf16 v[108:111], v[168:171], v[228:231], v[108:111]
    ds_read_b128 v[228:231], v9 offset:14336
    s_waitcnt lgkmcnt(9)
    s_nop 0
    v_mfma_f32_16x16x32_bf16 v[112:115], v[156:159], v[232:235], v[112:115]
    ds_read_b64_tr_b16 v[174:175], v2 offset:10240
    v_mfma_f32_16x16x32_bf16 v[116:119], v[160:163], v[232:235], v[116:119]
    ds_read_b64_tr_b16 v[244:245], v3 offset:8192
    v_mfma_f32_16x16x32_bf16 v[120:123], v[164:167], v[232:235], v[120:123]
    v_mfma_f32_16x16x32_bf16 v[124:127], v[168:171], v[232:235], v[124:127]
    ds_read_b128 v[232:235], v9 offset:15360
    s_waitcnt lgkmcnt(11)
    s_nop 0
    v_mfma_f32_16x16x32_bf16 v[176:179], v[156:159], v[236:239], v[176:179]
    ds_read_b64_tr_b16 v[246:247], v3 offset:10240
    v_mfma_f32_16x16x32_bf16 v[180:183], v[160:163], v[236:239], v[180:183]
    ds_read_b64_tr_b16 v[248:249], v2 offset:8448
    v_mfma_f32_16x16x32_bf16 v[184:187], v[164:167], v[236:239], v[184:187]
    ds_read_b64_tr_b16 v[250:251], v2 offset:10496
    v_mfma_f32_16x16x32_bf16 v[188:191], v[168:171], v[236:239], v[188:191]
    ds_read_b128 v[236:239], v9 offset:16384
    s_waitcnt lgkmcnt(14)
    s_nop 0
    v_mfma_f32_16x16x32_bf16 v[192:195], v[156:159], v[240:243], v[192:195]
    ds_read_b64_tr_b16 v[252:253], v3 offset:8448
    v_mfma_f32_16x16x32_bf16 v[196:199], v[160:163], v[240:243], v[196:199]
    ds_read_b64_tr_b16 v[254:255], v3 offset:10496
    v_mfma_f32_16x16x32_bf16 v[200:203], v[164:167], v[240:243], v[200:203]
    v_mfma_f32_16x16x32_bf16 v[204:207], v[168:171], v[240:243], v[204:207]
    ds_read_b128 v[240:243], v9 offset:17408
    s_waitcnt lgkmcnt(1)
    v_mov_b32 v141, 11
    ds_write_b32 v140, v141
    ds_read_b32 v144, v143
    v_mfma_f32_16x16x32_bf16 v[16:19], v[172:175], v[208:211], v[16:19]
    v_mfma_f32_16x16x32_bf16 v[20:23], v[244:247], v[208:211], v[20:23]
    s_add_u32 s44, s38, 3
    s_nop 0
    v_mfma_f32_16x16x32_bf16 v[24:27], v[248:251], v[208:211], v[24:27]
    s_and_b32 s44, s44, 3
    s_nop 0
    v_mfma_f32_16x16x32_bf16 v[28:31], v[252:255], v[208:211], v[28:31]
    s_waitcnt lgkmcnt(0)
L_fs11:
    v_readfirstlane_b32 s42, v144
    s_nop 0
    s_cmp_ge_u32 s42, 11
    s_cbranch_scc1 L_fs11k
    s_nop 0
    ds_read_b32 v144, v143
    s_waitcnt lgkmcnt(0)
    s_branch L_fs11
L_fs11k:
    ds_read_b128 v[208:211], v9 offset:47104
    v_mfma_f32_16x16x32_bf16 v[32:35], v[172:175], v[212:215], v[32:35]
    s_and_b32 s43, s38, 12
    s_nop 0
    v_mfma_f32_16x16x32_bf16 v[36:39], v[244:247], v[212:215], v[36:39]
    s_add_u32 s44, s44, s43
    s_nop 0
    v_mfma_f32_16x16x32_bf16 v[40:43], v[248:251], v[212:215], v[40:43]
    v_mfma_f32_16x16x32_bf16 v[44:47], v[252:255], v[212:215], v[44:47]
    ds_read_b128 v[212:215], v9 offset:48128
    v_mfma_f32_16x16x32_bf16 v[48:51], v[172:175], v[216:219], v[48:51]
    s_lshl_b32 s44, s44, 3
    s_nop 0
    v_mfma_f32_16x16x32_bf16 v[52:55], v[244:247], v[216:219], v[52:55]
    s_lshl_b32 s43, s44, 15
    s_nop 0
    v_mfma_f32_16x16x32_bf16 v[56:59], v[248:251], v[216:219], v[56:59]
    s_add_u32 s43, s43, 65536
    v_mfma_f32_16x16x32_bf16 v[60:63], v[252:255], v[216:219], v[60:63]
    ds_read_b128 v[216:219], v9 offset:49152
    v_mfma_f32_16x16x32_bf16 v[64:67], v[172:175], v[220:223], v[64:67]
    s_add_u32 m0, s58, 8192
    v_mfma_f32_16x16x32_bf16 v[68:71], v[244:247], v[220:223], v[68:71]
    v_mfma_f32_16x16x32_bf16 v[72:75], v[248:251], v[220:223], v[72:75]
    buffer_load_dwordx4 v4, s[24:27], s43 offen offset:0 lds
    v_mfma_f32_16x16x32_bf16 v[76:79], v[252:255], v[220:223], v[76:79]
    ds_read_b128 v[220:223], v9 offset:50176
    v_mfma_f32_16x16x32_bf16 v[80:83], v[172:175], v[224:227], v[80:83]
    buffer_load_dwordx4 v5, s[24:27], s43 offen offset:1024 lds
    v_mfma_f32_16x16x32_bf16 v[84:87], v[244:247], v[224:227], v[84:87]
    buffer_load_dwordx4 v6, s[24:27], s43 offen offset:2048 lds
    v_mfma_f32_16x16x32_bf16 v[88:91], v[248:251], v[224:227], v[88:91]
    buffer_load_dwordx4 v7, s[24:27], s43 offen offset:3072 lds
    v_mfma_f32_16x16x32_bf16 v[92:95], v[252:255], v[224:227], v[92:95]
    ds_read_b128 v[224:227], v9 offset:51200
    v_mfma_f32_16x16x32_bf16 v[96:99], v[172:175], v[228:231], v[96:99]
    v_mfma_f32_16x16x32_bf16 v[100:103], v[244:247], v[228:231], v[100:103]
    s_waitcnt vmcnt(17)
    s_nop 0
    v_mfma_f32_16x16x32_bf16 v[104:107], v[248:251], v[228:231], v[104:107]
    ds_read_b64_tr_b16 v[156:157], v2 offset:0
    v_mfma_f32_16x16x32_bf16 v[108:111], v[252:255], v[228:231], v[108:111]
    ds_read_b128 v[228:231], v9 offset:52224
    v_mfma_f32_16x16x32_bf16 v[112:115], v[172:175], v[232:235], v[112:115]
    ds_read_b64_tr_b16 v[158:159], v2 offset:2048
    v_mfma_f32_16x16x32_bf16 v[116:119], v[244:247], v[232:235], v[116:119]
    ds_read_b64_tr_b16 v[160:161], v3 offset:0
    v_mfma_f32_16x16x32_bf16 v[120:123], v[248:251], v[232:235], v[120:123]
    v_mfma_f32_16x16x32_bf16 v[124:127], v[252:255], v[232:235], v[124:127]
    ds_read_b128 v[232:235], v9 offset:53248
    v_mfma_f32_16x16x32_bf16 v[176:179], v[172:175], v[236:239], v[176:179]
    ds_read_b64_tr_b16 v[162:163], v3 offset:2048
    v_mfma_f32_16x16x32_bf16 v[180:183], v[244:247], v[236:239], v[180:183]
    ds_read_b64_tr_b16 v[164:165], v2 offset:256
    v_mfma_f32_16x16x32_bf16 v[184:187], v[248:251], v[236:239], v[184:187]
    ds_read_b64_tr_b16 v[166:167], v2 offset:2304
    v_mfma_f32_16x16x32_bf16 v[188:191], v[252:255], v[236:239], v[188:191]
    ds_read_b128 v[236:239], v9 offset:54272
    v_mfma_f32_16x16x32_bf16 v[192:195], v[172:175], v[240:243], v[192:195]
    ds_read_b64_tr_b16 v[168:169], v3 offset:256
    v_mfma_f32_16x16x32_bf16 v[196:199], v[244:247], v[240:243], v[196:199]
    ds_read_b64_tr_b16 v[170:171], v3 offset:2304
    v_mfma_f32_16x16x32_bf16 v[200:203], v[248:251], v[240:243], v[200:203]
    v_mfma_f32_16x16x32_bf16 v[204:207], v[252:255], v[240:243], v[204:207]
    ds_read_b128 v[240:243], v9 offset:55296
    s_waitcnt lgkmcnt(1)
    s_nop 0
    v_mfma_f32_16x16x32_bf16 v[16:19], v[156:159], v[208:211], v[16:19]
    v_mfma_f32_16x16x32_bf16 v[20:23], v[160:163], v[208:211], v[20:23]
    s_add_u32 s44, s38, 3
    s_nop 0
    v_mfma_f32_16x16x32_bf16 v[24:27], v[164:167], v[208:211], v[24:27]
    s_and_b32 s44, s44, 3
    s_nop 0
    v_mfma_f32_16x16x32_bf16 v[28:31], v[168:171], v[208:211], v[28:31]
    ds_read_b128 v[208:211], v9 offset:56320
    v_mfma_f32_16x16x32_bf16 v[32:35], v[156:159], v[212:215], v[32:35]
    s_and_b32 s43, s38, 12
    s_nop 0
    v_mfma_f32_16x16x32_bf16 v[36:39], v[160:163], v[212:215], v[36:39]
    s_add_u32 s44, s44, s43
    s_nop 0
    v_mfma_f32_16x16x32_bf16 v[40:43], v[164:167], v[212:215], v[40:43]
    v_mfma_f32_16x16x32_bf16 v[44:47], v[168:171], v[212:215], v[44:47]
    ds_read_b128 v[212:215], v9 offset:57344
    v_mfma_f32_16x16x32_bf16 v[48:51], v[156:159], v[216:219], v[48:51]
    s_lshl_b32 s44, s44, 3
    s_nop 0
    v_mfma_f32_16x16x32_bf16 v[52:55], v[160:163], v[216:219], v[52:55]
    s_lshl_b32 s43, s44, 15
    s_nop 0
    v_mfma_f32_16x16x32_bf16 v[56:59], v[164:167], v[216:219], v[56:59]
    s_add_u32 s43, s43, 98304
    v_mfma_f32_16x16x32_bf16 v[60:63], v[168:171], v[216:219], v[60:63]
    ds_read_b128 v[216:219], v9 offset:58368
    v_mfma_f32_16x16x32_bf16 v[64:67], v[156:159], v[220:223], v[64:67]
    s_add_u32 m0, s58, 0
    s_nop 0
    v_mfma_f32_16x16x32_bf16 v[68:71], v[160:163], v[220:223], v[68:71]
    v_mfma_f32_16x16x32_bf16 v[72:75], v[164:167], v[220:223], v[72:75]
    buffer_load_dwordx4 v4, s[24:27], s43 offen offset:0 lds
    v_mfma_f32_16x16x32_bf16 v[76:79], v[168:171], v[220:223], v[76:79]
    ds_read_b128 v[220:223], v9 offset:59392
    v_mfma_f32_16x16x32_bf16 v[80:83], v[156:159], v[224:227], v[80:83]
    buffer_load_dwordx4 v5, s[24:27], s43 offen offset:1024 lds
    v_mfma_f32_16x16x32_bf16 v[84:87], v[160:163], v[224:227], v[84:87]
    buffer_load_dwordx4 v6, s[24:27], s43 offen offset:2048 lds
    v_mfma_f32_16x16x32_bf16 v[88:91], v[164:167], v[224:227], v[88:91]
    buffer_load_dwordx4 v7, s[24:27], s43 offen offset:3072 lds
    v_mfma_f32_16x16x32_bf16 v[92:95], v[168:171], v[224:227], v[92:95]
    ds_read_b128 v[224:227], v9 offset:60416
    v_mfma_f32_16x16x32_bf16 v[96:99], v[156:159], v[228:231], v[96:99]
    v_mfma_f32_16x16x32_bf16 v[100:103], v[160:163], v[228:231], v[100:103]
    s_waitcnt vmcnt(8)
    s_nop 0
    v_mfma_f32_16x16x32_bf16 v[104:107], v[164:167], v[228:231], v[104:107]
    ds_read_b64_tr_b16 v[172:173], v2 offset:4096
    v_mfma_f32_16x16x32_bf16 v[108:111], v[168:171], v[228:231], v[108:111]
    ds_read_b128 v[228:231], v9 offset:61440
    v_mfma_f32_16x16x32_bf16 v[112:115], v[156:159], v[232:235], v[112:115]
    ds_read_b64_tr_b16 v[174:175], v2 offset:6144
    v_mfma_f32_16x16x32_bf16 v[116:119], v[160:163], v[232:235], v[116:119]
    ds_read_b64_tr_b16 v[244:245], v3 offset:4096
    v_mfma_f32_16x16x32_bf16 v[120:123], v[164:167], v[232:235], v[120:123]
    v_mfma_f32_16x16x32_bf16 v[124:127], v[168:171], v[232:235], v[124:127]
    ds_read_b128 v[232:235], v9 offset:62464
    v_mfma_f32_16x16x32_bf16 v[176:179], v[156:159], v[236:239], v[176:179]
    ds_read_b64_tr_b16 v[246:247], v3 offset:6144
    v_mfma_f32_16x16x32_bf16 v[180:183], v[160:163], v[236:239], v[180:183]
    ds_read_b64_tr_b16 v[248:249], v2 offset:4352
    v_mfma_f32_16x16x32_bf16 v[184:187], v[164:167], v[236:239], v[184:187]
    ds_read_b64_tr_b16 v[250:251], v2 offset:6400
    v_mfma_f32_16x16x32_bf16 v[188:191], v[168:171], v[236:239], v[188:191]
    ds_read_b128 v[236:239], v9 offset:63488
    s_waitcnt lgkmcnt(14)
    s_nop 0
    v_mfma_f32_16x16x32_bf16 v[192:195], v[156:159], v[240:243], v[192:195]
    ds_read_b64_tr_b16 v[252:253], v3 offset:4352
    v_mfma_f32_16x16x32_bf16 v[196:199], v[160:163], v[240:243], v[196:199]
    ds_read_b64_tr_b16 v[254:255], v3 offset:6400
    v_mfma_f32_16x16x32_bf16 v[200:203], v[164:167], v[240:243], v[200:203]
    v_mfma_f32_16x16x32_bf16 v[204:207], v[168:171], v[240:243], v[204:207]
    ds_read_b128 v[240:243], v9 offset:64512
    s_waitcnt lgkmcnt(1)
    v_mov_b32 v141, 13
    ds_write_b32 v140, v141
    ds_read_b32 v144, v143
    v_mfma_f32_16x16x32_bf16 v[16:19], v[172:175], v[208:211], v[16:19]
    v_mfma_f32_16x16x32_bf16 v[20:23], v[244:247], v[208:211], v[20:23]
    v_mfma_f32_16x16x32_bf16 v[24:27], v[248:251], v[208:211], v[24:27]
    s_waitcnt vmcnt(4)
    s_nop 0
    v_mfma_f32_16x16x32_bf16 v[28:31], v[252:255], v[208:211], v[28:31]
    s_waitcnt lgkmcnt(0)
L_fs13:
    v_readfirstlane_b32 s42, v144
    s_nop 0
    s_cmp_ge_u32 s42, 13
    s_cbranch_scc1 L_fs13k
    s_nop 0
    ds_read_b32 v144, v143
    s_waitcnt lgkmcnt(0)
    s_branch L_fs13
L_fs13k:
    ds_read_b128 v[208:211], v9 offset:28672
    v_mfma_f32_16x16x32_bf16 v[32:35], v[172:175], v[212:215], v[32:35]
    v_mfma_f32_16x16x32_bf16 v[36:39], v[244:247], v[212:215], v[36:39]
    v_mfma_f32_16x16x32_bf16 v[40:43], v[248:251], v[212:215], v[40:43]
    ds_read_b64_tr_b16 v[156:157], v2 offset:8192
    v_mfma_f32_16x16x32_bf16 v[44:47], v[252:255], v[212:215], v[44:47]
    ds_read_b128 v[212:215], v9 offset:29696
    v_mfma_f32_16x16x32_bf16 v[48:51], v[172:175], v[216:219], v[48:51]
    v_mfma_f32_16x16x32_bf16 v[52:55], v[244:247], v[216:219], v[52:55]
    v_mfma_f32_16x16x32_bf16 v[56:59], v[248:251], v[216:219], v[56:59]
    ds_read_b64_tr_b16 v[158:159], v2 offset:10240
    v_mfma_f32_16x16x32_bf16 v[60:63], v[252:255], v[216:219], v[60:63]
    ds_read_b128 v[216:219], v9 offset:30720
    v_mfma_f32_16x16x32_bf16 v[64:67], v[172:175], v[220:223], v[64:67]
    v_mfma_f32_16x16x32_bf16 v[68:71], v[244:247], v[220:223], v[68:71]
    v_mfma_f32_16x16x32_bf16 v[72:75], v[248:251], v[220:223], v[72:75]
    ds_read_b64_tr_b16 v[160:161], v3 offset:8192
    v_mfma_f32_16x16x32_bf16 v[76:79], v[252:255], v[220:223], v[76:79]
    ds_read_b128 v[220:223], v9 offset:31744
    v_mfma_f32_16x16x32_bf16 v[80:83], v[172:175], v[224:227], v[80:83]
    v_mfma_f32_16x16x32_bf16 v[84:87], v[244:247], v[224:227], v[84:87]
    v_mfma_f32_16x16x32_bf16 v[88:91], v[248:251], v[224:227], v[88:91]
    ds_read_b64_tr_b16 v[162:163], v3 offset:10240
    v_mfma_f32_16x16x32_bf16 v[92:95], v[252:255], v[224:227], v[92:95]
    ds_read_b128 v[224:227], v9 offset:32768
    v_mfma_f32_16x16x32_bf16 v[96:99], v[172:175], v[228:231], v[96:99]
    v_mfma_f32_16x16x32_bf16 v[100:103], v[244:247], v[228:231], v[100:103]
    v_mfma_f32_16x16x32_bf16 v[104:107], v[248:251], v[228:231], v[104:107]
    ds_read_b64_tr_b16 v[164:165], v2 offset:8448
    v_mfma_f32_16x16x32_bf16 v[108:111], v[252:255], v[228:231], v[108:111]
    ds_read_b128 v[228:231], v9 offset:33792
    v_mfma_f32_16x16x32_bf16 v[112:115], v[172:175], v[232:235], v[112:115]
    v_mfma_f32_16x16x32_bf16 v[116:119], v[244:247], v[232:235], v[116:119]
    v_mfma_f32_16x16x32_bf16 v[120:123], v[248:251], v[232:235], v[120:123]
    ds_read_b64_tr_b16 v[166:167], v2 offset:10496
    v_mfma_f32_16x16x32_bf16 v[124:127], v[252:255], v[232:235], v[124:127]
    ds_read_b128 v[232:235], v9 offset:34816
    v_mfma_f32_16x16x32_bf16 v[176:179], v[172:175], v[236:239], v[176:179]
    v_mfma_f32_16x16x32_bf16 v[180:183], v[244:247], v[236:239], v[180:183]
    v_mfma_f32_16x16x32_bf16 v[184:187], v[248:251], v[236:239], v[184:187]
    ds_read_b64_tr_b16 v[168:169], v3 offset:8448
    v_mfma_f32_16x16x32_bf16 v[188:191], v[252:255], v[236:239], v[188:191]
    ds_read_b128 v[236:239], v9 offset:35840
    v_mfma_f32_16x16x32_bf16 v[192:195], v[172:175], v[240:243], v[192:195]
    v_mfma_f32_16x16x32_bf16 v[196:199], v[244:247], v[240:243], v[196:199]
    ds_read_b64_tr_b16 v[170:171], v3 offset:10496
    v_mfma_f32_16x16x32_bf16 v[200:203], v[248:251], v[240:243], v[200:203]
    v_mfma_f32_16x16x32_bf16 v[204:207], v[252:255], v[240:243], v[204:207]
    ds_read_b128 v[240:243], v9 offset:36864
    s_waitcnt lgkmcnt(1)
    s_nop 0
    v_mfma_f32_16x16x32_bf16 v[16:19], v[156:159], v[208:211], v[16:19]
    v_mfma_f32_16x16x32_bf16 v[20:23], v[160:163], v[208:211], v[20:23]
    v_mfma_f32_16x16x32_bf16 v[24:27], v[164:167], v[208:211], v[24:27]
    s_waitcnt vmcnt(0)
    s_nop 0
    v_mfma_f32_16x16x32_bf16 v[28:31], v[168:171], v[208:211], v[28:31]
    ds_read_b128 v[208:211], v9 offset:37888
    v_mfma_f32_16x16x32_bf16 v[32:35], v[156:159], v[212:215], v[32:35]
    v_mfma_f32_16x16x32_bf16 v[36:39], v[160:163], v[212:215], v[36:39]
    v_mfma_f32_16x16x32_bf16 v[40:43], v[164:167], v[212:215], v[40:43]
    ds_read_b64_tr_b16 v[172:173], v2 offset:0
    v_mfma_f32_16x16x32_bf16 v[44:47], v[168:171], v[212:215], v[44:47]
    ds_read_b128 v[212:215], v9 offset:38912
    v_mfma_f32_16x16x32_bf16 v[48:51], v[156:159], v[216:219], v[48:51]
    v_mfma_f32_16x16x32_bf16 v[52:55], v[160:163], v[216:219], v[52:55]
    v_mfma_f32_16x16x32_bf16 v[56:59], v[164:167], v[216:219], v[56:59]
    ds_read_b64_tr_b16 v[174:175], v2 offset:2048
    v_mfma_f32_16x16x32_bf16 v[60:63], v[168:171], v[216:219], v[60:63]
    ds_read_b128 v[216:219], v9 offset:39936
    v_mfma_f32_16x16x32_bf16 v[64:67], v[156:159], v[220:223], v[64:67]
    v_mfma_f32_16x16x32_bf16 v[68:71], v[160:163], v[220:223], v[68:71]
    v_mfma_f32_16x16x32_bf16 v[72:75], v[164:167], v[220:223], v[72:75]
    ds_read_b64_tr_b16 v[244:245], v3 offset:0
    v_mfma_f32_16x16x32_bf16 v[76:79], v[168:171], v[220:223], v[76:79]
    ds_read_b128 v[220:223], v9 offset:40960
    v_mfma_f32_16x16x32_bf16 v[80:83], v[156:159], v[224:227], v[80:83]
    v_mfma_f32_16x16x32_bf16 v[84:87], v[160:163], v[224:227], v[84:87]
    v_mfma_f32_16x16x32_bf16 v[88:91], v[164:167], v[224:227], v[88:91]
    ds_read_b64_tr_b16 v[246:247], v3 offset:2048
    v_mfma_f32_16x16x32_bf16 v[92:95], v[168:171], v[224:227], v[92:95]
    ds_read_b128 v[224:227], v9 offset:41984
    v_mfma_f32_16x16x32_bf16 v[96:99], v[156:159], v[228:231], v[96:99]
    v_mfma_f32_16x16x32_bf16 v[100:103], v[160:163], v[228:231], v[100:103]
    v_mfma_f32_16x16x32_bf16 v[104:107], v[164:167], v[228:231], v[104:107]
    ds_read_b64_tr_b16 v[248:249], v2 offset:256
    v_mfma_f32_16x16x32_bf16 v[108:111], v[168:171], v[228:231], v[108:111]
    ds_read_b128 v[228:231], v9 offset:43008
    v_mfma_f32_16x16x32_bf16 v[112:115], v[156:159], v[232:235], v[112:115]
    v_mfma_f32_16x16x32_bf16 v[116:119], v[160:163], v[232:235], v[116:119]
    v_mfma_f32_16x16x32_bf16 v[120:123], v[164:167], v[232:235], v[120:123]
    ds_read_b64_tr_b16 v[250:251], v2 offset:2304
    v_mfma_f32_16x16x32_bf16 v[124:127], v[168:171], v[232:235], v[124:127]
    ds_read_b128 v[232:235], v9 offset:44032
    v_mfma_f32_16x16x32_bf16 v[176:179], v[156:159], v[236:239], v[176:179]
    v_mfma_f32_16x16x32_bf16 v[180:183], v[160:163], v[236:239], v[180:183]
    v_mfma_f32_16x16x32_bf16 v[184:187], v[164:167], v[236:239], v[184:187]
    ds_read_b64_tr_b16 v[252:253], v3 offset:256
    v_mfma_f32_16x16x32_bf16 v[188:191], v[168:171], v[236:239], v[188:191]
    ds_read_b128 v[236:239], v9 offset:45056
    s_waitcnt lgkmcnt(14)
    s_nop 0
    v_mfma_f32_16x16x32_bf16 v[192:195], v[156:159], v[240:243], v[192:195]
    v_mfma_f32_16x16x32_bf16 v[196:199], v[160:163], v[240:243], v[196:199]
    ds_read_b64_tr_b16 v[254:255], v3 offset:2304
    v_mfma_f32_16x16x32_bf16 v[200:203], v[164:167], v[240:243], v[200:203]
    v_mfma_f32_16x16x32_bf16 v[204:207], v[168:171], v[240:243], v[204:207]
    ds_read_b128 v[240:243], v9 offset:46080
    s_waitcnt lgkmcnt(1)
    v_mov_b32 v141, 15
    ds_write_b32 v140, v141
    ds_read_b32 v144, v143
    v_mfma_f32_16x16x32_bf16 v[16:19], v[172:175], v[208:211], v[16:19]
    v_mfma_f32_16x16x32_bf16 v[20:23], v[244:247], v[208:211], v[20:23]
    v_mfma_f32_16x16x32_bf16 v[24:27], v[248:251], v[208:211], v[24:27]
    v_mfma_f32_16x16x32_bf16 v[28:31], v[252:255], v[208:211], v[28:31]
    s_waitcnt lgkmcnt(0)
L_fs15:
    v_readfirstlane_b32 s42, v144
    s_nop 0
    s_cmp_ge_u32 s42, 15
    s_cbranch_scc1 L_fs15k
    s_nop 0
    ds_read_b32 v144, v143
    s_waitcnt lgkmcnt(0)
    s_branch L_fs15
L_fs15k:
    v_mfma_f32_16x16x32_bf16 v[32:35], v[172:175], v[212:215], v[32:35]
    v_mfma_f32_16x16x32_bf16 v[36:39], v[244:247], v[212:215], v[36:39]
    v_mfma_f32_16x16x32_bf16 v[40:43], v[248:251], v[212:215], v[40:43]
    v_mfma_f32_16x16x32_bf16 v[44:47], v[252:255], v[212:215], v[44:47]
    v_mfma_f32_16x16x32_bf16 v[48:51], v[172:175], v[216:219], v[48:51]
    v_mfma_f32_16x16x32_bf16 v[52:55], v[244:247], v[216:219], v[52:55]
    v_mfma_f32_16x16x32_bf16 v[56:59], v[248:251], v[216:219], v[56:59]
    v_mfma_f32_16x16x32_bf16 v[60:63], v[252:255], v[216:219], v[60:63]
    v_mfma_f32_16x16x32_bf16 v[64:67], v[172:175], v[220:223], v[64:67]
    v_mfma_f32_16x16x32_bf16 v[68:71], v[244:247], v[220:223], v[68:71]
    v_mfma_f32_16x16x32_bf16 v[72:75], v[248:251], v[220:223], v[72:75]
    v_mfma_f32_16x16x32_bf16 v[76:79], v[252:255], v[220:223], v[76:79]
    v_mfma_f32_16x16x32_bf16 v[80:83], v[172:175], v[224:227], v[80:83]
    v_mfma_f32_16x16x32_bf16 v[84:87], v[244:247], v[224:227], v[84:87]
    v_mfma_f32_16x16x32_bf16 v[88:91], v[248:251], v[224:227], v[88:91]
    v_mfma_f32_16x16x32_bf16 v[92:95], v[252:255], v[224:227], v[92:95]
    v_mfma_f32_16x16x32_bf16 v[96:99], v[172:175], v[228:231], v[96:99]
    v_mfma_f32_16x16x32_bf16 v[100:103], v[244:247], v[228:231], v[100:103]
    v_mfma_f32_16x16x32_bf16 v[104:107], v[248:251], v[228:231], v[104:107]
    v_mfma_f32_16x16x32_bf16 v[108:111], v[252:255], v[228:231], v[108:111]
    v_mfma_f32_16x16x32_bf16 v[112:115], v[172:175], v[232:235], v[112:115]
    v_mfma_f32_16x16x32_bf16 v[116:119], v[244:247], v[232:235], v[116:119]
    v_mfma_f32_16x16x32_bf16 v[120:123], v[248:251], v[232:235], v[120:123]
    v_mfma_f32_16x16x32_bf16 v[124:127], v[252:255], v[232:235], v[124:127]
    v_mfma_f32_16x16x32_bf16 v[176:179], v[172:175], v[236:239], v[176:179]
    v_mfma_f32_16x16x32_bf16 v[180:183], v[244:247], v[236:239], v[180:183]
    v_mfma_f32_16x16x32_bf16 v[184:187], v[248:251], v[236:239], v[184:187]
    v_mfma_f32_16x16x32_bf16 v[188:191], v[252:255], v[236:239], v[188:191]
    v_mfma_f32_16x16x32_bf16 v[192:195], v[172:175], v[240:243], v[192:195]
    v_mfma_f32_16x16x32_bf16 v[196:199], v[244:247], v[240:243], v[196:199]
    v_mfma_f32_16x16x32_bf16 v[200:203], v[248:251], v[240:243], v[200:203]
    v_mfma_f32_16x16x32_bf16 v[204:207], v[252:255], v[240:243], v[204:207]
    s_and_b32 s42, s36, 1
    s_lshl_b32 s42, s42, 14
    s_lshl_b32 s45, s42, 1
    s_nop 0
    s_sub_u32 s45, s45, 16384
    s_add_u32 s42, s42, 98304
    s_sub_u32 s43, s42, s49
    s_mov_b32 s49, s42
    v_add_u32 v2, s43, v2
    v_add_u32 v3, s43, v3
    v_add_u32 v8, 4096, v1
    v_add_u32 v9, 8192, v1
.p2align 3
L_p2:
    buffer_load_dword v10, v11, s[4:7], 0 offen sc1
    s_and_b32 s42, s83, 1
    s_lshl_b32 s42, s42, 1
    s_add_u32 s62, s42, 1
    s_add_u32 s44, s38, s62
    s_and_b32 s44, s44, 3
    s_and_b32 s43, s38, 12
    s_add_u32 s44, s44, s43
    s_add_u32 s53, s44, 16
    s_lshl_b32 s44, s44, 3
    s_add_u32 s44, s44, 4
    s_mul_i32 s46, s44, 9216
    s_lshl_b32 s48, s44, 15
    s_add_u32 m0, s49, 0
    s_add_u32 s43, s48, 0
    s_nop 0
    buffer_load_dwordx4 v4, s[24:27], s43 offen offset:0 lds
    buffer_load_dwordx4 v5, s[24:27], s43 offen offset:1024 lds
    buffer_load_dwordx4 v6, s[24:27], s43 offen offset:2048 lds
    buffer_load_dwordx4 v7, s[24:27], s43 offen offset:3072 lds
    s_add_u32 m0, s49, 4096
    s_add_u32 s43, s48, 32768
    buffer_load_dwordx4 v4, s[24:27], s43 offen offset:0 lds
    buffer_load_dwordx4 v5, s[24:27], s43 offen offset:1024 lds
    buffer_load_dwordx4 v6, s[24:27], s43 offen offset:2048 lds
    buffer_load_dwordx4 v7, s[24:27], s43 offen offset:3072 lds
    s_add_u32 m0, s49, 8192
    s_add_u32 s43, s48, 65536
    buffer_load_dwordx4 v4, s[24:27], s43 offen offset:0 lds
    buffer_load_dwordx4 v5, s[24:27], s43 offen offset:1024 lds
    buffer_load_dwordx4 v6, s[24:27], s43 offen offset:2048 lds
    buffer_load_dwordx4 v7, s[24:27], s43 offen offset:3072 lds
    s_add_u32 m0, s49, 12288
    s_add_u32 s43, s48, 98304
    buffer_load_dwordx4 v4, s[24:27], s43 offen offset:0 lds
    buffer_load_dwordx4 v5, s[24:27], s43 offen offset:1024 lds
    buffer_load_dwordx4 v6, s[24:27], s43 offen offset:2048 lds
    buffer_load_dwordx4 v7, s[24:27], s43 offen offset:3072 lds
    s_add_u32 s62, s62, 1
    s_add_u32 s63, s49, s45
    s_add_u32 s44, s38, s62
    s_and_b32 s44, s44, 3
    s_and_b32 s43, s38, 12
    s_add_u32 s44, s44, s43
    s_add_u32 s58, s44, 16
    s_lshl_b32 s44, s44, 3
    s_add_u32 s44, s44, 4
    s_nop 0
    s_mul_i32 s47, s44, 9216
    s_lshl_b32 s48, s44, 15
    s_add_u32 m0, s63, 0
    s_add_u32 s43, s48, 0
    s_nop 0
    buffer_load_dwordx4 v4, s[24:27], s43 offen offset:0 lds
    buffer_load_dwordx4 v5, s[24:27], s43 offen offset:1024 lds
    buffer_load_dwordx4 v6, s[24:27], s43 offen offset:2048 lds
    buffer_load_dwordx4 v7, s[24:27], s43 offen offset:3072 lds
    s_add_u32 m0, s63, 4096
    s_add_u32 s43, s48, 32768
    buffer_load_dwordx4 v4, s[24:27], s43 offen offset:0 lds
    buffer_load_dwordx4 v5, s[24:27], s43 offen offset:1024 lds
    buffer_load_dwordx4 v6, s[24:27], s43 offen offset:2048 lds
    buffer_load_dwordx4 v7, s[24:27], s43 offen offset:3072 lds
    s_add_u32 m0, s63, 8192
    s_add_u32 s43, s48, 65536
    buffer_load_dwordx4 v4, s[24:27], s43 offen offset:0 lds
    buffer_load_dwordx4 v5, s[24:27], s43 offen offset:1024 lds
    buffer_load_dwordx4 v6, s[24:27], s43 offen offset:2048 lds
    buffer_load_dwordx4 v7, s[24:27], s43 offen offset:3072 lds
    s_add_u32 m0, s63, 12288
    s_add_u32 s43, s48, 98304
    buffer_load_dwordx4 v4, s[24:27], s43 offen offset:0 lds
    buffer_load_dwordx4 v5, s[24:27], s43 offen offset:1024 lds
    buffer_load_dwordx4 v6, s[24:27], s43 offen offset:2048 lds
    buffer_load_dwordx4 v7, s[24:27], s43 offen offset:3072 lds
    s_waitcnt vmcnt(32)
    s_mov_b32 s52, 2
L_p2_chk:
    v_or_b32_e64 v10, v15, v10
    v_cmp_eq_u32 vcc, s85, v10
    s_nop 1
    s_mov_b64 s[60:61], vcc
    s_bitcmp1_b32 s60, s53
    s_cbranch_scc1 L_p2_go
    s_bitcmp1_b32 s60, s58
    s_cbranch_scc1 L_p2_swap
    s_sleep 4
L_p2_poll:
    buffer_load_dword v10, v11, s[4:7], 0 offen sc1
    s_waitcnt vmcnt(0)
    s_branch L_p2_chk
L_p2_swap:
    s_mov_b32 s42, s53
    s_mov_b32 s53, s58
    s_mov_b32 s58, s42
    s_mov_b32 s42, s46
    s_mov_b32 s46, s47
    s_mov_b32 s47, s42
    v_add_u32_e64 v2, s45, v2
    v_add_u32 v3, s45, v3
    s_add_u32 s49, s49, s45
    s_sub_u32 s45, 0, s45
L_p2_go:
    s_add_u32 s44, s46, 0
    buffer_load_dwordx4 v[208:211], v1, s[16:19], s44 offen offset:0 sc1
    buffer_load_dwordx4 v[212:215], v1, s[16:19], s44 offen offset:1024 sc1
    buffer_load_dwordx4 v[216:219], v1, s[16:19], s44 offen offset:2048 sc1
    buffer_load_dwordx4 v[220:223], v1, s[16:19], s44 offen offset:3072 sc1
    buffer_load_dwordx4 v[224:227], v8, s[16:19], s44 offen offset:0 sc1
    buffer_load_dwordx4 v[228:231], v8, s[16:19], s44 offen offset:1024 sc1
    buffer_load_dwordx4 v[232:235], v8, s[16:19], s44 offen offset:2048 sc1
    buffer_load_dwordx4 v[236:239], v8, s[16:19], s44 offen offset:3072 sc1
    buffer_load_dwordx4 v[240:243], v9, s[16:19], s44 offen offset:0 sc1
    s_add_u32 s44, s46, 9216
    buffer_load_dwordx4 v[128:131], v1, s[16:19], s44 offen offset:0 sc1
    buffer_load_dwordx4 v[132:135], v1, s[16:19], s44 offen offset:1024 sc1
    buffer_load_dwordx4 v[136:139], v1, s[16:19], s44 offen offset:2048 sc1
    buffer_load_dwordx4 v[140:143], v1, s[16:19], s44 offen offset:3072 sc1
    buffer_load_dwordx4 v[144:147], v8, s[16:19], s44 offen offset:0 sc1
    buffer_load_dwordx4 v[148:151], v8, s[16:19], s44 offen offset:1024 sc1
    buffer_load_dwordx4 v[152:155], v8, s[16:19], s44 offen offset:2048 sc1
    buffer_load_dwordx4 v[156:159], v8, s[16:19], s44 offen offset:3072 sc1
    buffer_load_dwordx4 v[160:163], v9, s[16:19], s44 offen offset:0 sc1
    buffer_load_dword v10, v11, s[4:7], 0 offen sc1
    s_waitcnt vmcnt(19)
    s_nop 0
    ds_read_b64_tr_b16 v[164:165], v2 offset:0
    ds_read_b64_tr_b16 v[166:167], v2 offset:2048
    ds_read_b64_tr_b16 v[168:169], v3 offset:0
    ds_read_b64_tr_b16 v[170:171], v3 offset:2048
    s_waitcnt vmcnt(10) lgkmcnt(0)
    s_nop 0
    ds_read_b64_tr_b16 v[172:173], v2 offset:256
    ds_read_b64_tr_b16 v[174:175], v2 offset:2304
    ds_read_b64_tr_b16 v[244:245], v3 offset:256
    ds_read_b64_tr_b16 v[246:247], v3 offset:2304
    s_add_u32 s44, s46, 18432
    v_mfma_f32_16x16x32_bf16 v[16:19], v[164:167], v[208:211], v[16:19]
    v_mfma_f32_16x16x32_bf16 v[20:23], v[168:171], v[208:211], v[20:23]
    v_mfma_f32_16x16x32_bf16 v[32:35], v[164:167], v[212:215], v[32:35]
    v_mfma_f32_16x16x32_bf16 v[36:39], v[168:171], v[212:215], v[36:39]
    v_mfma_f32_16x16x32_bf16 v[48:51], v[164:167], v[216:219], v[48:51]
    v_mfma_f32_16x16x32_bf16 v[52:55], v[168:171], v[216:219], v[52:55]
    v_mfma_f32_16x16x32_bf16 v[64:67], v[164:167], v[220:223], v[64:67]
    v_mfma_f32_16x16x32_bf16 v[68:71], v[168:171], v[220:223], v[68:71]
    v_mfma_f32_16x16x32_bf16 v[80:83], v[164:167], v[224:227], v[80:83]
    v_mfma_f32_16x16x32_bf16 v[84:87], v[168:171], v[224:227], v[84:87]
    v_mfma_f32_16x16x32_bf16 v[96:99], v[164:167], v[228:231], v[96:99]
    v_mfma_f32_16x16x32_bf16 v[100:103], v[168:171], v[228:231], v[100:103]
    v_mfma_f32_16x16x32_bf16 v[112:115], v[164:167], v[232:235], v[112:115]
    v_mfma_f32_16x16x32_bf16 v[116:119], v[168:171], v[232:235], v[116:119]
    v_mfma_f32_16x16x32_bf16 v[176:179], v[164:167], v[236:239], v[176:179]
    v_mfma_f32_16x16x32_bf16 v[180:183], v[168:171], v[236:239], v[180:183]
    v_mfma_f32_16x16x32_bf16 v[192:195], v[164:167], v[240:243], v[192:195]
    v_mfma_f32_16x16x32_bf16 v[196:199], v[168:171], v[240:243], v[196:199]
    s_waitcnt lgkmcnt(0)
    s_nop 0
    ds_read_b64_tr_b16 v[164:165], v2 offset:4096
    ds_read_b64_tr_b16 v[166:167], v2 offset:6144
    ds_read_b64_tr_b16 v[168:169], v3 offset:4096
    ds_read_b64_tr_b16 v[170:171], v3 offset:6144
    v_mfma_f32_16x16x32_bf16 v[24:27], v[172:175], v[208:211], v[24:27]
    v_mfma_f32_16x16x32_bf16 v[28:31], v[244:247], v[208:211], v[28:31]
    buffer_load_dwordx4 v[208:211], v1, s[16:19], s44 offen offset:0 sc1
    v_mfma_f32_16x16x32_bf16 v[40:43], v[172:175], v[212:215], v[40:43]
    v_mfma_f32_16x16x32_bf16 v[44:47], v[244:247], v[212:215], v[44:47]
    buffer_load_dwordx4 v[212:215], v1, s[16:19], s44 offen offset:1024 sc1
    v_mfma_f32_16x16x32_bf16 v[56:59], v[172:175], v[216:219], v[56:59]
    v_mfma_f32_16x16x32_bf16 v[60:63], v[244:247], v[216:219], v[60:63]
    buffer_load_dwordx4 v[216:219], v1, s[16:19], s44 offen offset:2048 sc1
    v_mfma_f32_16x16x32_bf16 v[72:75], v[172:175], v[220:223], v[72:75]
    v_mfma_f32_16x16x32_bf16 v[76:79], v[244:247], v[220:223], v[76:79]
    buffer_load_dwordx4 v[220:223], v1, s[16:19], s44 offen offset:3072 sc1
    v_mfma_f32_16x16x32_bf16 v[88:91], v[172:175], v[224:227], v[88:91]
    v_mfma_f32_16x16x32_bf16 v[92:95], v[244:247], v[224:227], v[92:95]
    buffer_load_dwordx4 v[224:227], v8, s[16:19], s44 offen offset:0 sc1
    v_mfma_f32_16x16x32_bf16 v[104:107], v[172:175], v[228:231], v[104:107]
    v_mfma_f32_16x16x32_bf16 v[108:111], v[244:247], v[228:231], v[108:111]
    buffer_load_dwordx4 v[228:231], v8, s[16:19], s44 offen offset:1024 sc1
    v_mfma_f32_16x16x32_bf16 v[120:123], v[172:175], v[232:235], v[120:123]
    v_mfma_f32_16x16x32_bf16 v[124:127], v[244:247], v[232:235], v[124:127]
    buffer_load_dwordx4 v[232:235], v8, s[16:19], s44 offen offset:2048 sc1
    v_mfma_f32_16x16x32_bf16 v[184:187], v[172:175], v[236:239], v[184:187]
    v_mfma_f32_16x16x32_bf16 v[188:191], v[244:247], v[236:239], v[188:191]
    buffer_load_dwordx4 v[236:239], v8, s[16:19], s44 offen offset:3072 sc1
    v_mfma_f32_16x16x32_bf16 v[200:203], v[172:175], v[240:243], v[200:203]
    v_mfma_f32_16x16x32_bf16 v[204:207], v[244:247], v[240:243], v[204:207]
    buffer_load_dwordx4 v[240:243], v9, s[16:19], s44 offen offset:0 sc1
    s_waitcnt vmcnt(9) lgkmcnt(0)
    s_nop 0
    ds_read_b64_tr_b16 v[172:173], v2 offset:4352
    ds_read_b64_tr_b16 v[174:175], v2 offset:6400
    ds_read_b64_tr_b16 v[244:245], v3 offset:4352
    ds_read_b64_tr_b16 v[246:247], v3 offset:6400
    s_add_u32 s44, s46, 27648
    v_mfma_f32_16x16x32_bf16 v[16:19], v[164:167], v[128:131], v[16:19]
    v_mfma_f32_16x16x32_bf16 v[20:23], v[168:171], v[128:131], v[20:23]
    v_mfma_f32_16x16x32_bf16 v[32:35], v[164:167], v[132:135], v[32:35]
    v_mfma_f32_16x16x32_bf16 v[36:39], v[168:171], v[132:135], v[36:39]
    v_mfma_f32_16x16x32_bf16 v[48:51], v[164:167], v[136:139], v[48:51]
    v_mfma_f32_16x16x32_bf16 v[52:55], v[168:171], v[136:139], v[52:55]
    v_mfma_f32_16x16x32_bf16 v[64:67], v[164:167], v[140:143], v[64:67]
    v_mfma_f32_16x16x32_bf16 v[68:71], v[168:171], v[140:143], v[68:71]
    v_mfma_f32_16x16x32_bf16 v[80:83], v[164:167], v[144:147], v[80:83]
    v_mfma_f32_16x16x32_bf16 v[84:87], v[168:171], v[144:147], v[84:87]
    v_mfma_f32_16x16x32_bf16 v[96:99], v[164:167], v[148:151], v[96:99]
    v_mfma_f32_16x16x32_bf16 v[100:103], v[168:171], v[148:151], v[100:103]
    v_mfma_f32_16x16x32_bf16 v[112:115], v[164:167], v[152:155], v[112:115]
    v_mfma_f32_16x16x32_bf16 v[116:119], v[168:171], v[152:155], v[116:119]
    v_mfma_f32_16x16x32_bf16 v[176:179], v[164:167], v[156:159], v[176:179]
    v_mfma_f32_16x16x32_bf16 v[180:183], v[168:171], v[156:159], v[180:183]
    v_mfma_f32_16x16x32_bf16 v[192:195], v[164:167], v[160:163], v[192:195]
    v_mfma_f32_16x16x32_bf16 v[196:199], v[168:171], v[160:163], v[196:199]
    s_waitcnt lgkmcnt(0)
    s_nop 0
    ds_read_b64_tr_b16 v[164:165], v2 offset:8192
    ds_read_b64_tr_b16 v[166:167], v2 offset:10240
    ds_read_b64_tr_b16 v[168:169], v3 offset:8192
    ds_read_b64_tr_b16 v[170:171], v3 offset:10240
    v_mfma_f32_16x16x32_bf16 v[24:27], v[172:175], v[128:131], v[24:27]
    v_mfma_f32_16x16x32_bf16 v[28:31], v[244:247], v[128:131], v[28:31]
    buffer_load_dwordx4 v[128:131], v1, s[16:19], s44 offen offset:0 sc1
    v_mfma_f32_16x16x32_bf16 v[40:43], v[172:175], v[132:135], v[40:43]
    v_mfma_f32_16x16x32_bf16 v[44:47], v[244:247], v[132:135], v[44:47]
    buffer_load_dwordx4 v[132:135], v1, s[16:19], s44 offen offset:1024 sc1
    v_mfma_f32_16x16x32_bf16 v[56:59], v[172:175], v[136:139], v[56:59]
    v_mfma_f32_16x16x32_bf16 v[60:63], v[244:247], v[136:139], v[60:63]
    buffer_load_dwordx4 v[136:139], v1, s[16:19], s44 offen offset:2048 sc1
    v_mfma_f32_16x16x32_bf16 v[72:75], v[172:175], v[140:143], v[72:75]
    v_mfma_f32_16x16x32_bf16 v[76:79], v[244:247], v[140:143], v[76:79]
    buffer_load_dwordx4 v[140:143], v1, s[16:19], s44 offen offset:3072 sc1
    v_mfma_f32_16x16x32_bf16 v[88:91], v[172:175], v[144:147], v[88:91]
    v_mfma_f32_16x16x32_bf16 v[92:95], v[244:247], v[144:147], v[92:95]
    buffer_load_dwordx4 v[144:147], v8, s[16:19], s44 offen offset:0 sc1
    v_mfma_f32_16x16x32_bf16 v[104:107], v[172:175], v[148:151], v[104:107]
    v_mfma_f32_16x16x32_bf16 v[108:111], v[244:247], v[148:151], v[108:111]
    buffer_load_dwordx4 v[148:151], v8, s[16:19], s44 offen offset:1024 sc1
    v_mfma_f32_16x16x32_bf16 v[120:123], v[172:175], v[152:155], v[120:123]
    v_mfma_f32_16x16x32_bf16 v[124:127], v[244:247], v[152:155], v[124:127]
    buffer_load_dwordx4 v[152:155], v8, s[16:19], s44 offen offset:2048 sc1
    v_mfma_f32_16x16x32_bf16 v[184:187], v[172:175], v[156:159], v[184:187]
    v_mfma_f32_16x16x32_bf16 v[188:191], v[244:247], v[156:159], v[188:191]
    buffer_load_dwordx4 v[156:159], v8, s[16:19], s44 offen offset:3072 sc1
    v_mfma_f32_16x16x32_bf16 v[200:203], v[172:175], v[160:163], v[200:203]
    v_mfma_f32_16x16x32_bf16 v[204:207], v[244:247], v[160:163], v[204:207]
    buffer_load_dwordx4 v[160:163], v9, s[16:19], s44 offen offset:0 sc1
    s_cmp_eq_u32 s52, 1
    s_cbranch_scc1 L_p2_last
    v_or_b32_e64 v10, v15, v10
    v_cmp_eq_u32 vcc, s85, v10
    s_nop 1
    s_mov_b64 s[60:61], vcc
    s_bitcmp1_b32 s60, s58
    s_cbranch_scc0 L_p2_last
    s_waitcnt vmcnt(9) lgkmcnt(0)
    ds_read_b64_tr_b16 v[172:173], v2 offset:8448
    ds_read_b64_tr_b16 v[174:175], v2 offset:10496
    ds_read_b64_tr_b16 v[244:245], v3 offset:8448
    ds_read_b64_tr_b16 v[246:247], v3 offset:10496
    s_add_u32 s44, s47, 0
    s_nop 0
    v_mfma_f32_16x16x32_bf16 v[16:19], v[164:167], v[208:211], v[16:19]
    v_mfma_f32_16x16x32_bf16 v[20:23], v[168:171], v[208:211], v[20:23]
    v_mfma_f32_16x16x32_bf16 v[32:35], v[164:167], v[212:215], v[32:35]
    v_mfma_f32_16x16x32_bf16 v[36:39], v[168:171], v[212:215], v[36:39]
    v_mfma_f32_16x16x32_bf16 v[48:51], v[164:167], v[216:219], v[48:51]
    v_mfma_f32_16x16x32_bf16 v[52:55], v[168:171], v[216:219], v[52:55]
    v_mfma_f32_16x16x32_bf16 v[64:67], v[164:167], v[220:223], v[64:67]
    v_mfma_f32_16x16x32_bf16 v[68:71], v[168:171], v[220:223], v[68:71]
    v_mfma_f32_16x16x32_bf16 v[80:83], v[164:167], v[224:227], v[80:83]
    v_mfma_f32_16x16x32_bf16 v[84:87], v[168:171], v[224:227], v[84:87]
    v_mfma_f32_16x16x32_bf16 v[96:99], v[164:167], v[228:231], v[96:99]
    v_mfma_f32_16x16x32_bf16 v[100:103], v[168:171], v[228:231], v[100:103]
    v_mfma_f32_16x16x32_bf16 v[112:115], v[164:167], v[232:235], v[112:115]
    v_mfma_f32_16x16x32_bf16 v[116:119], v[168:171], v[232:235], v[116:119]
    v_mfma_f32_16x16x32_bf16 v[176:179], v[164:167], v[236:239], v[176:179]
    v_mfma_f32_16x16x32_bf16 v[180:183], v[168:171], v[236:239], v[180:183]
    v_mfma_f32_16x16x32_bf16 v[192:195], v[164:167], v[240:243], v[192:195]
    v_mfma_f32_16x16x32_bf16 v[196:199], v[168:171], v[240:243], v[196:199]
    s_waitcnt lgkmcnt(0)
    s_nop 0
    ds_read_b64_tr_b16 v[164:165], v2 offset:12288
    ds_read_b64_tr_b16 v[166:167], v2 offset:14336
    ds_read_b64_tr_b16 v[168:169], v3 offset:12288
    ds_read_b64_tr_b16 v[170:171], v3 offset:14336
    v_mfma_f32_16x16x32_bf16 v[24:27], v[172:175], v[208:211], v[24:27]
    v_mfma_f32_16x16x32_bf16 v[28:31], v[244:247], v[208:211], v[28:31]
    buffer_load_dwordx4 v[208:211], v1, s[16:19], s44 offen offset:0 sc1
    v_mfma_f32_16x16x32_bf16 v[40:43], v[172:175], v[212:215], v[40:43]
    v_mfma_f32_16x16x32_bf16 v[44:47], v[244:247], v[212:215], v[44:47]
    buffer_load_dwordx4 v[212:215], v1, s[16:19], s44 offen offset:1024 sc1
    v_mfma_f32_16x16x32_bf16 v[56:59], v[172:175], v[216:219], v[56:59]
    v_mfma_f32_16x16x32_bf16 v[60:63], v[244:247], v[216:219], v[60:63]
    buffer_load_dwordx4 v[216:219], v1, s[16:19], s44 offen offset:2048 sc1
    v_mfma_f32_16x16x32_bf16 v[72:75], v[172:175], v[220:223], v[72:75]
    v_mfma_f32_16x16x32_bf16 v[76:79], v[244:247], v[220:223], v[76:79]
    buffer_load_dwordx4 v[220:223], v1, s[16:19], s44 offen offset:3072 sc1
    v_mfma_f32_16x16x32_bf16 v[88:91], v[172:175], v[224:227], v[88:91]
    v_mfma_f32_16x16x32_bf16 v[92:95], v[244:247], v[224:227], v[92:95]
    buffer_load_dwordx4 v[224:227], v8, s[16:19], s44 offen offset:0 sc1
    v_mfma_f32_16x16x32_bf16 v[104:107], v[172:175], v[228:231], v[104:107]
    v_mfma_f32_16x16x32_bf16 v[108:111], v[244:247], v[228:231], v[108:111]
    buffer_load_dwordx4 v[228:231], v8, s[16:19], s44 offen offset:1024 sc1
    v_mfma_f32_16x16x32_bf16 v[120:123], v[172:175], v[232:235], v[120:123]
    v_mfma_f32_16x16x32_bf16 v[124:127], v[244:247], v[232:235], v[124:127]
    buffer_load_dwordx4 v[232:235], v8, s[16:19], s44 offen offset:2048 sc1
    v_mfma_f32_16x16x32_bf16 v[184:187], v[172:175], v[236:239], v[184:187]
    v_mfma_f32_16x16x32_bf16 v[188:191], v[244:247], v[236:239], v[188:191]
    buffer_load_dwordx4 v[236:239], v8, s[16:19], s44 offen offset:3072 sc1
    v_mfma_f32_16x16x32_bf16 v[200:203], v[172:175], v[240:243], v[200:203]
    v_mfma_f32_16x16x32_bf16 v[204:207], v[244:247], v[240:243], v[204:207]
    buffer_load_dwordx4 v[240:243], v9, s[16:19], s44 offen offset:0 sc1
    s_waitcnt vmcnt(9) lgkmcnt(0)
    s_nop 0
    ds_read_b64_tr_b16 v[172:173], v2 offset:12544
    ds_read_b64_tr_b16 v[174:175], v2 offset:14592
    ds_read_b64_tr_b16 v[244:245], v3 offset:12544
    ds_read_b64_tr_b16 v[246:247], v3 offset:14592
    s_add_u32 s44, s47, 9216
    v_mfma_f32_16x16x32_bf16 v[16:19], v[164:167], v[128:131], v[16:19]
    v_mfma_f32_16x16x32_bf16 v[20:23], v[168:171], v[128:131], v[20:23]
    v_mfma_f32_16x16x32_bf16 v[32:35], v[164:167], v[132:135], v[32:35]
    v_mfma_f32_16x16x32_bf16 v[36:39], v[168:171], v[132:135], v[36:39]
    v_mfma_f32_16x16x32_bf16 v[48:51], v[164:167], v[136:139], v[48:51]
    v_mfma_f32_16x16x32_bf16 v[52:55], v[168:171], v[136:139], v[52:55]
    v_mfma_f32_16x16x32_bf16 v[64:67], v[164:167], v[140:143], v[64:67]
    v_mfma_f32_16x16x32_bf16 v[68:71], v[168:171], v[140:143], v[68:71]
    v_mfma_f32_16x16x32_bf16 v[80:83], v[164:167], v[144:147], v[80:83]
    v_mfma_f32_16x16x32_bf16 v[84:87], v[168:171], v[144:147], v[84:87]
    v_mfma_f32_16x16x32_bf16 v[96:99], v[164:167], v[148:151], v[96:99]
    v_mfma_f32_16x16x32_bf16 v[100:103], v[168:171], v[148:151], v[100:103]
    v_mfma_f32_16x16x32_bf16 v[112:115], v[164:167], v[152:155], v[112:115]
    v_mfma_f32_16x16x32_bf16 v[116:119], v[168:171], v[152:155], v[116:119]
    v_mfma_f32_16x16x32_bf16 v[176:179], v[164:167], v[156:159], v[176:179]
    v_mfma_f32_16x16x32_bf16 v[180:183], v[168:171], v[156:159], v[180:183]
    v_mfma_f32_16x16x32_bf16 v[192:195], v[164:167], v[160:163], v[192:195]
    v_mfma_f32_16x16x32_bf16 v[196:199], v[168:171], v[160:163], v[196:199]
    s_waitcnt lgkmcnt(0)
    v_add_u32 v2, s45, v2
    v_add_u32_e64 v3, s45, v3
    s_add_u32 s49, s49, s45
    s_sub_u32 s45, 0, s45
    ds_read_b64_tr_b16 v[164:165], v2 offset:0
    ds_read_b64_tr_b16 v[166:167], v2 offset:2048
    ds_read_b64_tr_b16 v[168:169], v3 offset:0
    ds_read_b64_tr_b16 v[170:171], v3 offset:2048
    v_mfma_f32_16x16x32_bf16 v[24:27], v[172:175], v[128:131], v[24:27]
    v_mfma_f32_16x16x32_bf16 v[28:31], v[244:247], v[128:131], v[28:31]
    buffer_load_dwordx4 v[128:131], v1, s[16:19], s44 offen offset:0 sc1
    v_mfma_f32_16x16x32_bf16 v[40:43], v[172:175], v[132:135], v[40:43]
    v_mfma_f32_16x16x32_bf16 v[44:47], v[244:247], v[132:135], v[44:47]
    buffer_load_dwordx4 v[132:135], v1, s[16:19], s44 offen offset:1024 sc1
    v_mfma_f32_16x16x32_bf16 v[56:59], v[172:175], v[136:139], v[56:59]
    v_mfma_f32_16x16x32_bf16 v[60:63], v[244:247], v[136:139], v[60:63]
    buffer_load_dwordx4 v[136:139], v1, s[16:19], s44 offen offset:2048 sc1
    v_mfma_f32_16x16x32_bf16 v[72:75], v[172:175], v[140:143], v[72:75]
    v_mfma_f32_16x16x32_bf16 v[76:79], v[244:247], v[140:143], v[76:79]
    buffer_load_dwordx4 v[140:143], v1, s[16:19], s44 offen offset:3072 sc1
    v_mfma_f32_16x16x32_bf16 v[88:91], v[172:175], v[144:147], v[88:91]
    v_mfma_f32_16x16x32_bf16 v[92:95], v[244:247], v[144:147], v[92:95]
    buffer_load_dwordx4 v[144:147], v8, s[16:19], s44 offen offset:0 sc1
    v_mfma_f32_16x16x32_bf16 v[104:107], v[172:175], v[148:151], v[104:107]
    v_mfma_f32_16x16x32_bf16 v[108:111], v[244:247], v[148:151], v[108:111]
    buffer_load_dwordx4 v[148:151], v8, s[16:19], s44 offen offset:1024 sc1
    v_mfma_f32_16x16x32_bf16 v[120:123], v[172:175], v[152:155], v[120:123]
    v_mfma_f32_16x16x32_bf16 v[124:127], v[244:247], v[152:155], v[124:127]
    buffer_load_dwordx4 v[152:155], v8, s[16:19], s44 offen offset:2048 sc1
    v_mfma_f32_16x16x32_bf16 v[184:187], v[172:175], v[156:159], v[184:187]
    v_mfma_f32_16x16x32_bf16 v[188:191], v[244:247], v[156:159], v[188:191]
    buffer_load_dwordx4 v[156:159], v8, s[16:19], s44 offen offset:3072 sc1
    v_mfma_f32_16x16x32_bf16 v[200:203], v[172:175], v[160:163], v[200:203]
    v_mfma_f32_16x16x32_bf16 v[204:207], v[244:247], v[160:163], v[204:207]
    buffer_load_dwordx4 v[160:163], v9, s[16:19], s44 offen offset:0 sc1
    s_mov_b32 s46, s47
    s_mov_b32 s52, 1
    s_waitcnt vmcnt(9) lgkmcnt(0)
    s_nop 0
    ds_read_b64_tr_b16 v[172:173], v2 offset:256
    ds_read_b64_tr_b16 v[174:175], v2 offset:2304
    ds_read_b64_tr_b16 v[244:245], v3 offset:256
    ds_read_b64_tr_b16 v[246:247], v3 offset:2304
    s_add_u32 s44, s46, 18432
    v_mfma_f32_16x16x32_bf16 v[16:19], v[164:167], v[208:211], v[16:19]
    v_mfma_f32_16x16x32_bf16 v[20:23], v[168:171], v[208:211], v[20:23]
    v_mfma_f32_16x16x32_bf16 v[32:35], v[164:167], v[212:215], v[32:35]
    v_mfma_f32_16x16x32_bf16 v[36:39], v[168:171], v[212:215], v[36:39]
    v_mfma_f32_16x16x32_bf16 v[48:51], v[164:167], v[216:219], v[48:51]
    v_mfma_f32_16x16x32_bf16 v[52:55], v[168:171], v[216:219], v[52:55]
    v_mfma_f32_16x16x32_bf16 v[64:67], v[164:167], v[220:223], v[64:67]
    v_mfma_f32_16x16x32_bf16 v[68:71], v[168:171], v[220:223], v[68:71]
    v_mfma_f32_16x16x32_bf16 v[80:83], v[164:167], v[224:227], v[80:83]
    v_mfma_f32_16x16x32_bf16 v[84:87], v[168:171], v[224:227], v[84:87]
    v_mfma_f32_16x16x32_bf16 v[96:99], v[164:167], v[228:231], v[96:99]
    v_mfma_f32_16x16x32_bf16 v[100:103], v[168:171], v[228:231], v[100:103]
    v_mfma_f32_16x16x32_bf16 v[112:115], v[164:167], v[232:235], v[112:115]
    v_mfma_f32_16x16x32_bf16 v[116:119], v[168:171], v[232:235], v[116:119]
    v_mfma_f32_16x16x32_bf16 v[176:179], v[164:167], v[236:239], v[176:179]
    v_mfma_f32_16x16x32_bf16 v[180:183], v[168:171], v[236:239], v[180:183]
    v_mfma_f32_16x16x32_bf16 v[192:195], v[164:167], v[240:243], v[192:195]
    v_mfma_f32_16x16x32_bf16 v[196:199], v[168:171], v[240:243], v[196:199]
    s_waitcnt lgkmcnt(0)
    s_nop 0
    ds_read_b64_tr_b16 v[164:165], v2 offset:4096
    ds_read_b64_tr_b16 v[166:167], v2 offset:6144
    ds_read_b64_tr_b16 v[168:169], v3 offset:4096
    ds_read_b64_tr_b16 v[170:171], v3 offset:6144
    v_mfma_f32_16x16x32_bf16 v[24:27], v[172:175], v[208:211], v[24:27]
    v_mfma_f32_16x16x32_bf16 v[28:31], v[244:247], v[208:211], v[28:31]
    buffer_load_dwordx4 v[208:211], v1, s[16:19], s44 offen offset:0 sc1
    v_mfma_f32_16x16x32_bf16 v[40:43], v[172:175], v[212:215], v[40:43]
    v_mfma_f32_16x16x32_bf16 v[44:47], v[244:247], v[212:215], v[44:47]
    buffer_load_dwordx4 v[212:215], v1, s[16:19], s44 offen offset:1024 sc1
    v_mfma_f32_16x16x32_bf16 v[56:59], v[172:175], v[216:219], v[56:59]
    v_mfma_f32_16x16x32_bf16 v[60:63], v[244:247], v[216:219], v[60:63]
    buffer_load_dwordx4 v[216:219], v1, s[16:19], s44 offen offset:2048 sc1
    v_mfma_f32_16x16x32_bf16 v[72:75], v[172:175], v[220:223], v[72:75]
    v_mfma_f32_16x16x32_bf16 v[76:79], v[244:247], v[220:223], v[76:79]
    buffer_load_dwordx4 v[220:223], v1, s[16:19], s44 offen offset:3072 sc1
    v_mfma_f32_16x16x32_bf16 v[88:91], v[172:175], v[224:227], v[88:91]
    v_mfma_f32_16x16x32_bf16 v[92:95], v[244:247], v[224:227], v[92:95]
    buffer_load_dwordx4 v[224:227], v8, s[16:19], s44 offen offset:0 sc1
    v_mfma_f32_16x16x32_bf16 v[104:107], v[172:175], v[228:231], v[104:107]
    v_mfma_f32_16x16x32_bf16 v[108:111], v[244:247], v[228:231], v[108:111]
    buffer_load_dwordx4 v[228:231], v8, s[16:19], s44 offen offset:1024 sc1
    v_mfma_f32_16x16x32_bf16 v[120:123], v[172:175], v[232:235], v[120:123]
    v_mfma_f32_16x16x32_bf16 v[124:127], v[244:247], v[232:235], v[124:127]
    buffer_load_dwordx4 v[232:235], v8, s[16:19], s44 offen offset:2048 sc1
    v_mfma_f32_16x16x32_bf16 v[184:187], v[172:175], v[236:239], v[184:187]
    v_mfma_f32_16x16x32_bf16 v[188:191], v[244:247], v[236:239], v[188:191]
    buffer_load_dwordx4 v[236:239], v8, s[16:19], s44 offen offset:3072 sc1
    v_mfma_f32_16x16x32_bf16 v[200:203], v[172:175], v[240:243], v[200:203]
    v_mfma_f32_16x16x32_bf16 v[204:207], v[244:247], v[240:243], v[204:207]
    buffer_load_dwordx4 v[240:243], v9, s[16:19], s44 offen offset:0 sc1
    s_waitcnt vmcnt(9) lgkmcnt(0)
    s_nop 0
    ds_read_b64_tr_b16 v[172:173], v2 offset:4352
    ds_read_b64_tr_b16 v[174:175], v2 offset:6400
    ds_read_b64_tr_b16 v[244:245], v3 offset:4352
    ds_read_b64_tr_b16 v[246:247], v3 offset:6400
    s_add_u32 s44, s46, 27648
    v_mfma_f32_16x16x32_bf16 v[16:19], v[164:167], v[128:131], v[16:19]
    v_mfma_f32_16x16x32_bf16 v[20:23], v[168:171], v[128:131], v[20:23]
    v_mfma_f32_16x16x32_bf16 v[32:35], v[164:167], v[132:135], v[32:35]
    v_mfma_f32_16x16x32_bf16 v[36:39], v[168:171], v[132:135], v[36:39]
    v_mfma_f32_16x16x32_bf16 v[48:51], v[164:167], v[136:139], v[48:51]
    v_mfma_f32_16x16x32_bf16 v[52:55], v[168:171], v[136:139], v[52:55]
    v_mfma_f32_16x16x32_bf16 v[64:67], v[164:167], v[140:143], v[64:67]
    v_mfma_f32_16x16x32_bf16 v[68:71], v[168:171], v[140:143], v[68:71]
    v_mfma_f32_16x16x32_bf16 v[80:83], v[164:167], v[144:147], v[80:83]
    v_mfma_f32_16x16x32_bf16 v[84:87], v[168:171], v[144:147], v[84:87]
    v_mfma_f32_16x16x32_bf16 v[96:99], v[164:167], v[148:151], v[96:99]
    v_mfma_f32_16x16x32_bf16 v[100:103], v[168:171], v[148:151], v[100:103]
    v_mfma_f32_16x16x32_bf16 v[112:115], v[164:167], v[152:155], v[112:115]
    v_mfma_f32_16x16x32_bf16 v[116:119], v[168:171], v[152:155], v[116:119]
    v_mfma_f32_16x16x32_bf16 v[176:179], v[164:167], v[156:159], v[176:179]
    v_mfma_f32_16x16x32_bf16 v[180:183], v[168:171], v[156:159], v[180:183]
    v_mfma_f32_16x16x32_bf16 v[192:195], v[164:167], v[160:163], v[192:195]
    v_mfma_f32_16x16x32_bf16 v[196:199], v[168:171], v[160:163], v[196:199]
    s_waitcnt lgkmcnt(0)
    s_nop 0
    ds_read_b64_tr_b16 v[164:165], v2 offset:8192
    ds_read_b64_tr_b16 v[166:167], v2 offset:10240
    ds_read_b64_tr_b16 v[168:169], v3 offset:8192
    ds_read_b64_tr_b16 v[170:171], v3 offset:10240
    v_mfma_f32_16x16x32_bf16 v[24:27], v[172:175], v[128:131], v[24:27]
    v_mfma_f32_16x16x32_bf16 v[28:31], v[244:247], v[128:131], v[28:31]
    buffer_load_dwordx4 v[128:131], v1, s[16:19], s44 offen offset:0 sc1
    v_mfma_f32_16x16x32_bf16 v[40:43], v[172:175], v[132:135], v[40:43]
    v_mfma_f32_16x16x32_bf16 v[44:47], v[244:247], v[132:135], v[44:47]
    buffer_load_dwordx4 v[132:135], v1, s[16:19], s44 offen offset:1024 sc1
    v_mfma_f32_16x16x32_bf16 v[56:59], v[172:175], v[136:139], v[56:59]
    v_mfma_f32_16x16x32_bf16 v[60:63], v[244:247], v[136:139], v[60:63]
    buffer_load_dwordx4 v[136:139], v1, s[16:19], s44 offen offset:2048 sc1
    v_mfma_f32_16x16x32_bf16 v[72:75], v[172:175], v[140:143], v[72:75]
    v_mfma_f32_16x16x32_bf16 v[76:79], v[244:247], v[140:143], v[76:79]
    buffer_load_dwordx4 v[140:143], v1, s[16:19], s44 offen offset:3072 sc1
    v_mfma_f32_16x16x32_bf16 v[88:91], v[172:175], v[144:147], v[88:91]
    v_mfma_f32_16x16x32_bf16 v[92:95], v[244:247], v[144:147], v[92:95]
    buffer_load_dwordx4 v[144:147], v8, s[16:19], s44 offen offset:0 sc1
    v_mfma_f32_16x16x32_bf16 v[104:107], v[172:175], v[148:151], v[104:107]
    v_mfma_f32_16x16x32_bf16 v[108:111], v[244:247], v[148:151], v[108:111]
    buffer_load_dwordx4 v[148:151], v8, s[16:19], s44 offen offset:1024 sc1
    v_mfma_f32_16x16x32_bf16 v[120:123], v[172:175], v[152:155], v[120:123]
    v_mfma_f32_16x16x32_bf16 v[124:127], v[244:247], v[152:155], v[124:127]
    buffer_load_dwordx4 v[152:155], v8, s[16:19], s44 offen offset:2048 sc1
    v_mfma_f32_16x16x32_bf16 v[184:187], v[172:175], v[156:159], v[184:187]
    v_mfma_f32_16x16x32_bf16 v[188:191], v[244:247], v[156:159], v[188:191]
    buffer_load_dwordx4 v[156:159], v8, s[16:19], s44 offen offset:3072 sc1
    v_mfma_f32_16x16x32_bf16 v[200:203], v[172:175], v[160:163], v[200:203]
    v_mfma_f32_16x16x32_bf16 v[204:207], v[244:247], v[160:163], v[204:207]
    buffer_load_dwordx4 v[160:163], v9, s[16:19], s44 offen offset:0 sc1
L_p2_last:
    s_waitcnt vmcnt(9) lgkmcnt(0)
    s_nop 0
    ds_read_b64_tr_b16 v[172:173], v2 offset:8448
    ds_read_b64_tr_b16 v[174:175], v2 offset:10496
    ds_read_b64_tr_b16 v[244:245], v3 offset:8448
    ds_read_b64_tr_b16 v[246:247], v3 offset:10496
    v_mfma_f32_16x16x32_bf16 v[16:19], v[164:167], v[208:211], v[16:19]
    v_mfma_f32_16x16x32_bf16 v[20:23], v[168:171], v[208:211], v[20:23]
    v_mfma_f32_16x16x32_bf16 v[32:35], v[164:167], v[212:215], v[32:35]
    v_mfma_f32_16x16x32_bf16 v[36:39], v[168:171], v[212:215], v[36:39]
    v_mfma_f32_16x16x32_bf16 v[48:51], v[164:167], v[216:219], v[48:51]
    v_mfma_f32_16x16x32_bf16 v[52:55], v[168:171], v[216:219], v[52:55]
    v_mfma_f32_16x16x32_bf16 v[64:67], v[164:167], v[220:223], v[64:67]
    v_mfma_f32_16x16x32_bf16 v[68:71], v[168:171], v[220:223], v[68:71]
    v_mfma_f32_16x16x32_bf16 v[80:83], v[164:167], v[224:227], v[80:83]
    v_mfma_f32_16x16x32_bf16 v[84:87], v[168:171], v[224:227], v[84:87]
    v_mfma_f32_16x16x32_bf16 v[96:99], v[164:167], v[228:231], v[96:99]
    v_mfma_f32_16x16x32_bf16 v[100:103], v[168:171], v[228:231], v[100:103]
    v_mfma_f32_16x16x32_bf16 v[112:115], v[164:167], v[232:235], v[112:115]
    v_mfma_f32_16x16x32_bf16 v[116:119], v[168:171], v[232:235], v[116:119]
    v_mfma_f32_16x16x32_bf16 v[176:179], v[164:167], v[236:239], v[176:179]
    v_mfma_f32_16x16x32_bf16 v[180:183], v[168:171], v[236:239], v[180:183]
    v_mfma_f32_16x16x32_bf16 v[192:195], v[164:167], v[240:243], v[192:195]
    v_mfma_f32_16x16x32_bf16 v[196:199], v[168:171], v[240:243], v[196:199]
    s_waitcnt lgkmcnt(0)
    s_nop 0
    ds_read_b64_tr_b16 v[164:165], v2 offset:12288
    ds_read_b64_tr_b16 v[166:167], v2 offset:14336
    ds_read_b64_tr_b16 v[168:169], v3 offset:12288
    ds_read_b64_tr_b16 v[170:171], v3 offset:14336
    v_mfma_f32_16x16x32_bf16 v[24:27], v[172:175], v[208:211], v[24:27]
    v_mfma_f32_16x16x32_bf16 v[28:31], v[244:247], v[208:211], v[28:31]
    v_mfma_f32_16x16x32_bf16 v[40:43], v[172:175], v[212:215], v[40:43]
    v_mfma_f32_16x16x32_bf16 v[44:47], v[244:247], v[212:215], v[44:47]
    v_mfma_f32_16x16x32_bf16 v[56:59], v[172:175], v[216:219], v[56:59]
    v_mfma_f32_16x16x32_bf16 v[60:63], v[244:247], v[216:219], v[60:63]
    v_mfma_f32_16x16x32_bf16 v[72:75], v[172:175], v[220:223], v[72:75]
    v_mfma_f32_16x16x32_bf16 v[76:79], v[244:247], v[220:223], v[76:79]
    v_mfma_f32_16x16x32_bf16 v[88:91], v[172:175], v[224:227], v[88:91]
    v_mfma_f32_16x16x32_bf16 v[92:95], v[244:247], v[224:227], v[92:95]
    v_mfma_f32_16x16x32_bf16 v[104:107], v[172:175], v[228:231], v[104:107]
    v_mfma_f32_16x16x32_bf16 v[108:111], v[244:247], v[228:231], v[108:111]
    v_mfma_f32_16x16x32_bf16 v[120:123], v[172:175], v[232:235], v[120:123]
    v_mfma_f32_16x16x32_bf16 v[124:127], v[244:247], v[232:235], v[124:127]
    v_mfma_f32_16x16x32_bf16 v[184:187], v[172:175], v[236:239], v[184:187]
    v_mfma_f32_16x16x32_bf16 v[188:191], v[244:247], v[236:239], v[188:191]
    v_mfma_f32_16x16x32_bf16 v[200:203], v[172:175], v[240:243], v[200:203]
    v_mfma_f32_16x16x32_bf16 v[204:207], v[244:247], v[240:243], v[204:207]
    s_waitcnt vmcnt(0) lgkmcnt(0)
    s_nop 0
    ds_read_b64_tr_b16 v[172:173], v2 offset:12544
    ds_read_b64_tr_b16 v[174:175], v2 offset:14592
    ds_read_b64_tr_b16 v[244:245], v3 offset:12544
    ds_read_b64_tr_b16 v[246:247], v3 offset:14592
    v_mfma_f32_16x16x32_bf16 v[16:19], v[164:167], v[128:131], v[16:19]
    v_mfma_f32_16x16x32_bf16 v[20:23], v[168:171], v[128:131], v[20:23]
    v_mfma_f32_16x16x32_bf16 v[32:35], v[164:167], v[132:135], v[32:35]
    v_mfma_f32_16x16x32_bf16 v[36:39], v[168:171], v[132:135], v[36:39]
    v_mfma_f32_16x16x32_bf16 v[48:51], v[164:167], v[136:139], v[48:51]
    v_mfma_f32_16x16x32_bf16 v[52:55], v[168:171], v[136:139], v[52:55]
    v_mfma_f32_16x16x32_bf16 v[64:67], v[164:167], v[140:143], v[64:67]
    v_mfma_f32_16x16x32_bf16 v[68:71], v[168:171], v[140:143], v[68:71]
    v_mfma_f32_16x16x32_bf16 v[80:83], v[164:167], v[144:147], v[80:83]
    v_mfma_f32_16x16x32_bf16 v[84:87], v[168:171], v[144:147], v[84:87]
    v_mfma_f32_16x16x32_bf16 v[96:99], v[164:167], v[148:151], v[96:99]
    v_mfma_f32_16x16x32_bf16 v[100:103], v[168:171], v[148:151], v[100:103]
    v_mfma_f32_16x16x32_bf16 v[112:115], v[164:167], v[152:155], v[112:115]
    v_mfma_f32_16x16x32_bf16 v[116:119], v[168:171], v[152:155], v[116:119]
    v_mfma_f32_16x16x32_bf16 v[176:179], v[164:167], v[156:159], v[176:179]
    v_mfma_f32_16x16x32_bf16 v[180:183], v[168:171], v[156:159], v[180:183]
    v_mfma_f32_16x16x32_bf16 v[192:195], v[164:167], v[160:163], v[192:195]
    v_mfma_f32_16x16x32_bf16 v[196:199], v[168:171], v[160:163], v[196:199]
    s_waitcnt lgkmcnt(0)
    v_add_u32 v2, s45, v2
    v_add_u32_e64 v3, s45, v3
    s_add_u32 s49, s49, s45
    s_sub_u32 s45, 0, s45
    v_mfma_f32_16x16x32_bf16 v[24:27], v[172:175], v[128:131], v[24:27]
    v_mfma_f32_16x16x32_bf16 v[28:31], v[244:247], v[128:131], v[28:31]
    v_mfma_f32_16x16x32_bf16 v[40:43], v[172:175], v[132:135], v[40:43]
    v_mfma_f32_16x16x32_bf16 v[44:47], v[244:247], v[132:135], v[44:47]
    v_mfma_f32_16x16x32_bf16 v[56:59], v[172:175], v[136:139], v[56:59]
    v_mfma_f32_16x16x32_bf16 v[60:63], v[244:247], v[136:139], v[60:63]
    v_mfma_f32_16x16x32_bf16 v[72:75], v[172:175], v[140:143], v[72:75]
    v_mfma_f32_16x16x32_bf16 v[76:79], v[244:247], v[140:143], v[76:79]
    v_mfma_f32_16x16x32_bf16 v[88:91], v[172:175], v[144:147], v[88:91]
    v_mfma_f32_16x16x32_bf16 v[92:95], v[244:247], v[144:147], v[92:95]
    v_mfma_f32_16x16x32_bf16 v[104:107], v[172:175], v[148:151], v[104:107]
    v_mfma_f32_16x16x32_bf16 v[108:111], v[244:247], v[148:151], v[108:111]
    v_mfma_f32_16x16x32_bf16 v[120:123], v[172:175], v[152:155], v[120:123]
    v_mfma_f32_16x16x32_bf16 v[124:127], v[244:247], v[152:155], v[124:127]
    v_mfma_f32_16x16x32_bf16 v[184:187], v[172:175], v[156:159], v[184:187]
    v_mfma_f32_16x16x32_bf16 v[188:191], v[244:247], v[156:159], v[188:191]
    v_mfma_f32_16x16x32_bf16 v[200:203], v[172:175], v[160:163], v[200:203]
    v_mfma_f32_16x16x32_bf16 v[204:207], v[244:247], v[160:163], v[204:207]
    s_mov_b32 s46, s47
    s_mov_b32 s53, s58
    s_sub_u32 s52, s52, 1
    s_cmp_lg_u32 s52, 0
    s_cbranch_scc1 L_p2_poll
    s_add_u32 s42, s49, s45
    s_min_u32 s43, s42, s49
    s_max_u32 s44, s42, s49
    v_add_u32 v8, s43, v1
    v_add_u32 v9, s44, v1
    ds_write_b128 v8, v[24:27] offset:0
    ds_write_b128 v8, v[28:31] offset:1024
    ds_write_b128 v8, v[40:43] offset:2048
    ds_write_b128 v8, v[44:47] offset:3072
    ds_write_b128 v8, v[56:59] offset:4096
    ds_write_b128 v8, v[60:63] offset:5120
    ds_write_b128 v8, v[72:75] offset:6144
    ds_write_b128 v8, v[76:79] offset:7168
    ds_write_b128 v8, v[88:91] offset:8192
    ds_write_b128 v8, v[92:95] offset:9216
    ds_write_b128 v8, v[104:107] offset:10240
    ds_write_b128 v8, v[108:111] offset:11264
    ds_write_b128 v8, v[120:123] offset:12288
    ds_write_b128 v8, v[124:127] offset:13312
    ds_write_b128 v8, v[184:187] offset:14336
    ds_write_b128 v8, v[188:191] offset:15360
    ds_write_b128 v9, v[200:203] offset:0
    ds_write_b128 v9, v[204:207] offset:1024
    s_mov_b32 s42, 0
    s_cmp_eq_u32 s83, 1
    s_cselect_b32 s42, 81920, s42
    s_cmp_eq_u32 s83, 2
    s_nop 0
    s_cselect_b32 s42, 16384, s42
    s_cmp_eq_u32 s83, 3
    s_nop 0
    s_cselect_b32 s42, 114688, s42
    s_and_b32 s43, s83, 1
    s_nop 0
    s_lshr_b32 s43, 32768, s43
    s_add_u32 s43, s43, s42
    v_add_u32 v8, s42, v1
    v_add_u32 v9, s43, v1
    s_lshl_b32 s42, s37, 2
    s_and_b32 s43, s38, 3
    s_add_u32 s42, s42, s43
    s_lshl_b32 s42, s42, 2
    s_add_u32 s42, s42, s83
    s_mul_i32 s42, s42, 36864
    s_add_u32 s42, s42, 0x2800000
    s_add_u32 s90, s100, s42
    s_addc_u32 s91, s101, 0
    s_mov_b32 s8, s90
    s_mov_b32 s9, s91
    s_mov_b32 s10, 36864
    s_mov_b32 s11, 0x20000
    s_waitcnt lgkmcnt(0)
    s_barrier
    ds_read_b128 v[24:27], v8 offset:0
    ds_read_b128 v[28:31], v8 offset:1024
    ds_read_b128 v[40:43], v8 offset:2048
    ds_read_b128 v[44:47], v8 offset:3072
    ds_read_b128 v[56:59], v8 offset:4096
    ds_read_b128 v[60:63], v8 offset:5120
    ds_read_b128 v[72:75], v8 offset:6144
    ds_read_b128 v[76:79], v8 offset:7168
    ds_read_b128 v[88:91], v8 offset:8192
    ds_read_b128 v[92:95], v8 offset:9216
    ds_read_b128 v[104:107], v8 offset:10240
    ds_read_b128 v[108:111], v8 offset:11264
    ds_read_b128 v[120:123], v8 offset:12288
    ds_read_b128 v[124:127], v8 offset:13312
    ds_read_b128 v[184:187], v8 offset:14336
    ds_read_b128 v[188:191], v8 offset:15360
    ds_read_b128 v[200:203], v9 offset:0
    ds_read_b128 v[204:207], v9 offset:1024
    v_add_u32 v8, 4096, v1
    v_add_u32 v9, 8192, v1
    s_lshr_b32 s62, s38, 2
    s_cmp_eq_u32 s62, s83
    s_cbranch_scc1 L_fin
    s_nop 0
    s_mul_i32 s44, s62, 9216
    s_waitcnt lgkmcnt(14)
    s_nop 0
    v_pk_add_f32 v[16:17], v[16:17], v[24:25]
    v_pk_add_f32 v[18:19], v[18:19], v[26:27]
    v_pk_add_f32 v[20:21], v[20:21], v[28:29]
    v_pk_add_f32 v[22:23], v[22:23], v[30:31]
    v_cvt_pk_bf16_f32 v16, v16, v17
    v_cvt_pk_bf16_f32 v17, v18, v19
    v_cvt_pk_bf16_f32 v18, v20, v21
    v_cvt_pk_bf16_f32 v19, v22, v23
    buffer_store_dwordx4 v[16:19], v1, s[8:11], s44 offen offset:0 sc1
    v_pk_add_f32 v[32:33], v[32:33], v[40:41]
    v_pk_add_f32 v[34:35], v[34:35], v[42:43]
    v_pk_add_f32 v[36:37], v[36:37], v[44:45]
    v_pk_add_f32 v[38:39], v[38:39], v[46:47]
    v_cvt_pk_bf16_f32 v32, v32, v33
    v_cvt_pk_bf16_f32 v33, v34, v35
    v_cvt_pk_bf16_f32 v34, v36, v37
    v_cvt_pk_bf16_f32 v35, v38, v39
    buffer_store_dwordx4 v[32:35], v1, s[8:11], s44 offen offset:1024 sc1
    s_waitcnt lgkmcnt(13)
    s_nop 0
    v_pk_add_f32 v[48:49], v[48:49], v[56:57]
    v_pk_add_f32 v[50:51], v[50:51], v[58:59]
    s_waitcnt lgkmcnt(12)
    s_nop 0
    v_pk_add_f32 v[52:53], v[52:53], v[60:61]
    v_pk_add_f32 v[54:55], v[54:55], v[62:63]
    v_cvt_pk_bf16_f32 v48, v48, v49
    v_cvt_pk_bf16_f32 v49, v50, v51
    v_cvt_pk_bf16_f32 v50, v52, v53
    v_cvt_pk_bf16_f32 v51, v54, v55
    buffer_store_dwordx4 v[48:51], v1, s[8:11], s44 offen offset:2048 sc1
    s_waitcnt lgkmcnt(11)
    s_nop 0
    v_pk_add_f32 v[64:65], v[64:65], v[72:73]
    v_pk_add_f32 v[66:67], v[66:67], v[74:75]
    s_waitcnt lgkmcnt(10)
    s_nop 0
    v_pk_add_f32 v[68:69], v[68:69], v[76:77]
    v_pk_add_f32 v[70:71], v[70:71], v[78:79]
    v_cvt_pk_bf16_f32 v64, v64, v65
    v_cvt_pk_bf16_f32 v65, v66, v67
    v_cvt_pk_bf16_f32 v66, v68, v69
    v_cvt_pk_bf16_f32 v67, v70, v71
    buffer_store_dwordx4 v[64:67], v1, s[8:11], s44 offen offset:3072 sc1
    s_waitcnt lgkmcnt(9)
    s_nop 0
    v_pk_add_f32 v[80:81], v[80:81], v[88:89]
    v_pk_add_f32 v[82:83], v[82:83], v[90:91]
    s_waitcnt lgkmcnt(8)
    s_nop 0
    v_pk_add_f32 v[84:85], v[84:85], v[92:93]
    v_pk_add_f32 v[86:87], v[86:87], v[94:95]
    v_cvt_pk_bf16_f32 v80, v80, v81
    v_cvt_pk_bf16_f32 v81, v82, v83
    v_cvt_pk_bf16_f32 v82, v84, v85
    v_cvt_pk_bf16_f32 v83, v86, v87
    buffer_store_dwordx4 v[80:83], v8, s[8:11], s44 offen offset:0 sc1
    s_waitcnt lgkmcnt(7)
    s_nop 0
    v_pk_add_f32 v[96:97], v[96:97], v[104:105]
    v_pk_add_f32 v[98:99], v[98:99], v[106:107]
    s_waitcnt lgkmcnt(6)
    s_nop 0
    v_pk_add_f32 v[100:101], v[100:101], v[108:109]
    v_pk_add_f32 v[102:103], v[102:103], v[110:111]
    v_cvt_pk_bf16_f32 v96, v96, v97
    v_cvt_pk_bf16_f32 v97, v98, v99
    v_cvt_pk_bf16_f32 v98, v100, v101
    v_cvt_pk_bf16_f32 v99, v102, v103
    buffer_store_dwordx4 v[96:99], v8, s[8:11], s44 offen offset:1024 sc1
    s_waitcnt lgkmcnt(5)
    s_nop 0
    v_pk_add_f32 v[112:113], v[112:113], v[120:121]
    v_pk_add_f32 v[114:115], v[114:115], v[122:123]
    s_waitcnt lgkmcnt(4)
    s_nop 0
    v_pk_add_f32 v[116:117], v[116:117], v[124:125]
    v_pk_add_f32 v[118:119], v[118:119], v[126:127]
    v_cvt_pk_bf16_f32 v112, v112, v113
    v_cvt_pk_bf16_f32 v113, v114, v115
    v_cvt_pk_bf16_f32 v114, v116, v117
    v_cvt_pk_bf16_f32 v115, v118, v119
    buffer_store_dwordx4 v[112:115], v8, s[8:11], s44 offen offset:2048 sc1
    s_waitcnt lgkmcnt(3)
    s_nop 0
    v_pk_add_f32 v[176:177], v[176:177], v[184:185]
    v_pk_add_f32 v[178:179], v[178:179], v[186:187]
    s_waitcnt lgkmcnt(2)
    s_nop 0
    v_pk_add_f32 v[180:181], v[180:181], v[188:189]
    v_pk_add_f32 v[182:183], v[182:183], v[190:191]
    v_cvt_pk_bf16_f32 v176, v176, v177
    v_cvt_pk_bf16_f32 v177, v178, v179
    v_cvt_pk_bf16_f32 v178, v180, v181
    v_cvt_pk_bf16_f32 v179, v182, v183
    buffer_store_dwordx4 v[176:179], v8, s[8:11], s44 offen offset:3072 sc1
    s_waitcnt lgkmcnt(1)
    s_nop 0
    v_pk_add_f32 v[192:193], v[192:193], v[200:201]
    v_pk_add_f32 v[194:195], v[194:195], v[202:203]
    s_waitcnt lgkmcnt(0)
    s_nop 0
    v_pk_add_f32 v[196:197], v[196:197], v[204:205]
    v_pk_add_f32 v[198:199], v[198:199], v[206:207]
    v_cvt_pk_bf16_f32 v192, v192, v193
    v_cvt_pk_bf16_f32 v193, v194, v195
    v_cvt_pk_bf16_f32 v194, v196, v197
    v_cvt_pk_bf16_f32 v195, v198, v199
    buffer_store_dwordx4 v[192:195], v9, s[8:11], s44 offen offset:0 sc1
    s_waitcnt vmcnt(0)
    s_mov_b64 exec, 1
    v_mov_b32 v252, 163712
    v_mov_b32_e64 v251, 1
    ds_add_rtn_u32 v250, v252, v251 offset:28
    ds_read_b32 v251, v252 offset:8
    s_waitcnt lgkmcnt(0)
    v_readfirstlane_b32 s42, v250
    s_nop 0
    s_cmp_lg_u32 s42, 2
    s_cbranch_scc1 L_pub_z
    s_nop 0
    v_or_b32 v251, 0x60000000, v251
    s_lshl_b32 s43, s38, 7
    v_mov_b32 v250, s43
    buffer_store_dword v251, v250, s[4:7], 0 offen sc1
L_pub_z:
    s_mov_b64 exec, -1
    s_endpgm
L_fin:
    s_waitcnt lgkmcnt(14)
    s_nop 0
    v_pk_add_f32 v[16:17], v[16:17], v[24:25]
    v_pk_add_f32 v[18:19], v[18:19], v[26:27]
    v_pk_add_f32 v[20:21], v[20:21], v[28:29]
    v_pk_add_f32 v[22:23], v[22:23], v[30:31]
    v_pk_add_f32 v[32:33], v[32:33], v[40:41]
    v_pk_add_f32 v[34:35], v[34:35], v[42:43]
    v_pk_add_f32 v[36:37], v[36:37], v[44:45]
    v_pk_add_f32 v[38:39], v[38:39], v[46:47]
    s_waitcnt lgkmcnt(13)
    s_nop 0
    v_pk_add_f32 v[48:49], v[48:49], v[56:57]
    v_pk_add_f32 v[50:51], v[50:51], v[58:59]
    s_waitcnt lgkmcnt(12)
    s_nop 0
    v_pk_add_f32 v[52:53], v[52:53], v[60:61]
    v_pk_add_f32 v[54:55], v[54:55], v[62:63]
    s_waitcnt lgkmcnt(11)
    s_nop 0
    v_pk_add_f32 v[64:65], v[64:65], v[72:73]
    v_pk_add_f32 v[66:67], v[66:67], v[74:75]
    s_waitcnt lgkmcnt(10)
    s_nop 0
    v_pk_add_f32 v[68:69], v[68:69], v[76:77]
    v_pk_add_f32 v[70:71], v[70:71], v[78:79]
    s_waitcnt lgkmcnt(9)
    s_nop 0
    v_pk_add_f32 v[80:81], v[80:81], v[88:89]
    v_pk_add_f32 v[82:83], v[82:83], v[90:91]
    s_waitcnt lgkmcnt(8)
    s_nop 0
    v_pk_add_f32 v[84:85], v[84:85], v[92:93]
    v_pk_add_f32 v[86:87], v[86:87], v[94:95]
    s_waitcnt lgkmcnt(7)
    s_nop 0
    v_pk_add_f32 v[96:97], v[96:97], v[104:105]
    v_pk_add_f32 v[98:99], v[98:99], v[106:107]
    s_waitcnt lgkmcnt(6)
    s_nop 0
    v_pk_add_f32 v[100:101], v[100:101], v[108:109]
    v_pk_add_f32 v[102:103], v[102:103], v[110:111]
    s_waitcnt lgkmcnt(5)
    s_nop 0
    v_pk_add_f32 v[112:113], v[112:113], v[120:121]
    v_pk_add_f32 v[114:115], v[114:115], v[122:123]
    s_waitcnt lgkmcnt(4)
    s_nop 0
    v_pk_add_f32 v[116:117], v[116:117], v[124:125]
    v_pk_add_f32 v[118:119], v[118:119], v[126:127]
    s_waitcnt lgkmcnt(3)
    s_nop 0
    v_pk_add_f32 v[176:177], v[176:177], v[184:185]
    v_pk_add_f32 v[178:179], v[178:179], v[186:187]
    s_waitcnt lgkmcnt(2)
    s_nop 0
    v_pk_add_f32 v[180:181], v[180:181], v[188:189]
    v_pk_add_f32 v[182:183], v[182:183], v[190:191]
    s_waitcnt lgkmcnt(1)
    s_nop 0
    v_pk_add_f32 v[192:193], v[192:193], v[200:201]
    v_pk_add_f32 v[194:195], v[194:195], v[202:203]
    s_waitcnt lgkmcnt(0)
    s_nop 0
    v_pk_add_f32 v[196:197], v[196:197], v[204:205]
    v_pk_add_f32 v[198:199], v[198:199], v[206:207]
    v_and_b32 v12, 63, v0
    v_lshrrev_b32 v13, 4, v12
    v_and_b32_e64 v14, 15, v12
    v_bfe_u32 v15, v12, 2, 2
    v_and_b32 v244, 1, v14
    v_lshlrev_b32 v244, 4, v244
    v_mov_b32 v245, 0x3f80
    v_lshlrev_b32 v245, v244, v245
    v_cmp_eq_u32 vcc, v15, v13
    v_mov_b32 v244, 0
    s_nop 0
    v_cndmask_b32 v245, 0, v245, vcc
    v_and_b32 v246, 2, v14
    v_cmp_eq_u32 vcc, 0, v246
    v_mov_b32 v248, 0
    v_mov_b32 v249, 0
    v_cndmask_b32 v246, 0, v245, vcc
    v_cndmask_b32 v247, v245, v244, vcc
    v_mov_b32 v245, 0
    v_lshlrev_b32_e64 v11, 7, v14
    v_and_b32 v5, 3, v14
    s_and_b32 s42, s38, 3
    v_mov_b32 v6, 0x10000
    v_cmp_eq_u32 vcc, s42, v5
    s_nop 1
    v_cndmask_b32 v11, v6, v11, vcc
    v_lshrrev_b32 v4, 1, v13
    v_and_b32_e64 v5, 1, v13
    v_lshl_or_b32 v4, v5, 1, v4
    v_lshlrev_b32_e64 v4, 4, v4
    v_lshl_add_u32 v4, v14, 11, v4
    s_mul_i32 s82, s40, 294912
    s_lshl_b32 s42, s39, 10
    s_add_u32 s82, s82, s42
    s_and_b32 s43, s38, 3
    s_lshl_b32 s42, s43, 8
    s_add_u32 s82, s82, s42
    s_lshl_b32 s42, s62, 6
    s_add_u32 s82, s82, s42
    v_mov_b32 v15, 3
    v_lshrrev_b32 v15, v13, v15
    v_lshlrev_b32 v15, 29, v15
    s_lshl_b32 s52, 0x1111, s43
    s_lshl_b32 s42, 1, s38
    s_andn2_b32 s52, s52, s42
    buffer_load_dword v10, v11, s[4:7], 0 offen sc1
    s_waitcnt vmcnt(0)
L_fin_chk:
    v_or_b32 v10, v15, v10
    v_cmp_eq_u32 vcc, s85, v10
    s_nop 1
    s_mov_b64 s[60:61], vcc
    s_andn2_b32 s42, s52, s61
    s_cbranch_scc0 L_fin_go
    s_sleep 4
    buffer_load_dword v10, v11, s[4:7], 0 offen sc1
    s_waitcnt vmcnt(0)
    s_branch L_fin_chk
L_fin_go:
    s_add_u32 s46, s62, 1
    s_and_b32 s46, s46, 3
    s_mul_i32 s46, s46, 9216
    s_add_u32 s47, s62, 2
    s_and_b32 s47, s47, 3
    s_mul_i32 s47, s47, 9216
    s_add_u32 s48, s62, 3
    s_and_b32 s48, s48, 3
    s_mul_i32 s48, s48, 9216
    buffer_load_dwordx4 v[24:27], v1, s[8:11], s46 offen offset:0 sc1
    buffer_load_dwordx4 v[28:31], v1, s[8:11], s47 offen offset:0 sc1
    buffer_load_dwordx4 v[128:131], v1, s[8:11], s48 offen offset:0 sc1
    buffer_load_dwordx4 v[40:43], v1, s[8:11], s46 offen offset:1024 sc1
    buffer_load_dwordx4 v[44:47], v1, s[8:11], s47 offen offset:1024 sc1
    buffer_load_dwordx4 v[132:135], v1, s[8:11], s48 offen offset:1024 sc1
    buffer_load_dwordx4 v[56:59], v1, s[8:11], s46 offen offset:2048 sc1
    buffer_load_dwordx4 v[60:63], v1, s[8:11], s47 offen offset:2048 sc1
    buffer_load_dwordx4 v[136:139], v1, s[8:11], s48 offen offset:2048 sc1
    buffer_load_dwordx4 v[72:75], v1, s[8:11], s46 offen offset:3072 sc1
    buffer_load_dwordx4 v[76:79], v1, s[8:11], s47 offen offset:3072 sc1
    buffer_load_dwordx4 v[140:143], v1, s[8:11], s48 offen offset:3072 sc1
    buffer_load_dwordx4 v[88:91], v8, s[8:11], s46 offen offset:0 sc1
    buffer_load_dwordx4 v[92:95], v8, s[8:11], s47 offen offset:0 sc1
    buffer_load_dwordx4 v[144:147], v8, s[8:11], s48 offen offset:0 sc1
    buffer_load_dwordx4 v[104:107], v8, s[8:11], s46 offen offset:1024 sc1
    buffer_load_dwordx4 v[108:111], v8, s[8:11], s47 offen offset:1024 sc1
    buffer_load_dwordx4 v[148:151], v8, s[8:11], s48 offen offset:1024 sc1
    buffer_load_dwordx4 v[120:123], v8, s[8:11], s46 offen offset:2048 sc1
    buffer_load_dwordx4 v[124:127], v8, s[8:11], s47 offen offset:2048 sc1
    buffer_load_dwordx4 v[152:155], v8, s[8:11], s48 offen offset:2048 sc1
    buffer_load_dwordx4 v[184:187], v8, s[8:11], s46 offen offset:3072 sc1
    buffer_load_dwordx4 v[188:191], v8, s[8:11], s47 offen offset:3072 sc1
    buffer_load_dwordx4 v[156:159], v8, s[8:11], s48 offen offset:3072 sc1
    buffer_load_dwordx4 v[200:203], v9, s[8:11], s46 offen offset:0 sc1
    buffer_load_dwordx4 v[204:207], v9, s[8:11], s47 offen offset:0 sc1
    buffer_load_dwordx4 v[160:163], v9, s[8:11], s48 offen offset:0 sc1
    s_waitcnt vmcnt(26)
    s_nop 0
    v_mfma_f32_16x16x32_bf16 v[16:19], v[246:249], v[24:27], v[16:19]
    v_mfma_f32_16x16x32_bf16 v[20:23], v[244:247], v[24:27], v[20:23]
    s_waitcnt vmcnt(25)
    s_nop 0
    v_mfma_f32_16x16x32_bf16 v[16:19], v[246:249], v[28:31], v[16:19]
    v_mfma_f32_16x16x32_bf16 v[20:23], v[244:247], v[28:31], v[20:23]
    s_waitcnt vmcnt(24)
    s_nop 0
    v_mfma_f32_16x16x32_bf16 v[16:19], v[246:249], v[128:131], v[16:19]
    v_mfma_f32_16x16x32_bf16 v[20:23], v[244:247], v[128:131], v[20:23]
    s_waitcnt vmcnt(23)
    s_nop 0
    v_mfma_f32_16x16x32_bf16 v[32:35], v[246:249], v[40:43], v[32:35]
    v_mfma_f32_16x16x32_bf16 v[36:39], v[244:247], v[40:43], v[36:39]
    s_waitcnt vmcnt(22)
    s_nop 0
    v_mfma_f32_16x16x32_bf16 v[32:35], v[246:249], v[44:47], v[32:35]
    v_mfma_f32_16x16x32_bf16 v[36:39], v[244:247], v[44:47], v[36:39]
    s_waitcnt vmcnt(21)
    s_nop 0
    v_mfma_f32_16x16x32_bf16 v[32:35], v[246:249], v[132:135], v[32:35]
    v_mfma_f32_16x16x32_bf16 v[36:39], v[244:247], v[132:135], v[36:39]
    v_cvt_pk_bf16_f32 v16, v16, v17
    v_cvt_pk_bf16_f32 v17, v18, v19
    v_cvt_pk_bf16_f32 v18, v20, v21
    v_cvt_pk_bf16_f32 v19, v22, v23
    s_nop 0
    v_permlane16_swap_b32 v16, v18
    v_permlane16_swap_b32 v17, v19
    s_add_u32 s42, s82, 0
    buffer_store_dwordx4 v[16:19], v4, s[28:31], s42 offen
    s_waitcnt vmcnt(21)
    s_nop 0
    v_mfma_f32_16x16x32_bf16 v[48:51], v[246:249], v[56:59], v[48:51]
    v_mfma_f32_16x16x32_bf16 v[52:55], v[244:247], v[56:59], v[52:55]
    s_waitcnt vmcnt(20)
    s_nop 0
    v_mfma_f32_16x16x32_bf16 v[48:51], v[246:249], v[60:63], v[48:51]
    v_mfma_f32_16x16x32_bf16 v[52:55], v[244:247], v[60:63], v[52:55]
    s_waitcnt vmcnt(19)
    s_nop 0
    v_mfma_f32_16x16x32_bf16 v[48:51], v[246:249], v[136:139], v[48:51]
    v_mfma_f32_16x16x32_bf16 v[52:55], v[244:247], v[136:139], v[52:55]
    v_cvt_pk_bf16_f32 v32, v32, v33
    v_cvt_pk_bf16_f32 v33, v34, v35
    v_cvt_pk_bf16_f32 v34, v36, v37
    v_cvt_pk_bf16_f32 v35, v38, v39
    s_nop 0
    v_permlane16_swap_b32 v32, v34
    v_permlane16_swap_b32 v33, v35
    s_nop 0
    s_add_u32 s42, s82, 32768
    buffer_store_dwordx4 v[32:35], v4, s[28:31], s42 offen
    s_waitcnt vmcnt(19)
    s_nop 0
    v_mfma_f32_16x16x32_bf16 v[64:67], v[246:249], v[72:75], v[64:67]
    v_mfma_f32_16x16x32_bf16 v[68:71], v[244:247], v[72:75], v[68:71]
    s_waitcnt vmcnt(18)
    s_nop 0
    v_mfma_f32_16x16x32_bf16 v[64:67], v[246:249], v[76:79], v[64:67]
    v_mfma_f32_16x16x32_bf16 v[68:71], v[244:247], v[76:79], v[68:71]
    s_waitcnt vmcnt(17)
    s_nop 0
    v_mfma_f32_16x16x32_bf16 v[64:67], v[246:249], v[140:143], v[64:67]
    v_mfma_f32_16x16x32_bf16 v[68:71], v[244:247], v[140:143], v[68:71]
    v_cvt_pk_bf16_f32 v48, v48, v49
    v_cvt_pk_bf16_f32 v49, v50, v51
    v_cvt_pk_bf16_f32 v50, v52, v53
    v_cvt_pk_bf16_f32 v51, v54, v55
    s_nop 0
    v_permlane16_swap_b32 v48, v50
    v_permlane16_swap_b32 v49, v51
    s_nop 0
    s_add_u32 s42, s82, 65536
    buffer_store_dwordx4 v[48:51], v4, s[28:31], s42 offen
    s_waitcnt vmcnt(17)
    s_nop 0
    v_mfma_f32_16x16x32_bf16 v[80:83], v[246:249], v[88:91], v[80:83]
    v_mfma_f32_16x16x32_bf16 v[84:87], v[244:247], v[88:91], v[84:87]
    s_waitcnt vmcnt(16)
    s_nop 0
    v_mfma_f32_16x16x32_bf16 v[80:83], v[246:249], v[92:95], v[80:83]
    v_mfma_f32_16x16x32_bf16 v[84:87], v[244:247], v[92:95], v[84:87]
    s_waitcnt vmcnt(15)
    s_nop 0
    v_mfma_f32_16x16x32_bf16 v[80:83], v[246:249], v[144:147], v[80:83]
    v_mfma_f32_16x16x32_bf16 v[84:87], v[244:247], v[144:147], v[84:87]
    v_cvt_pk_bf16_f32 v64, v64, v65
    v_cvt_pk_bf16_f32 v65, v66, v67
    v_cvt_pk_bf16_f32 v66, v68, v69
    v_cvt_pk_bf16_f32 v67, v70, v71
    s_nop 0
    v_permlane16_swap_b32 v64, v66
    v_permlane16_swap_b32 v65, v67
    s_nop 0
    s_add_u32 s42, s82, 98304
    buffer_store_dwordx4 v[64:67], v4, s[28:31], s42 offen
    s_waitcnt vmcnt(15)
    s_nop 0
    v_mfma_f32_16x16x32_bf16 v[96:99], v[246:249], v[104:107], v[96:99]
    v_mfma_f32_16x16x32_bf16 v[100:103], v[244:247], v[104:107], v[100:103]
    s_waitcnt vmcnt(14)
    s_nop 0
    v_mfma_f32_16x16x32_bf16 v[96:99], v[246:249], v[108:111], v[96:99]
    v_mfma_f32_16x16x32_bf16 v[100:103], v[244:247], v[108:111], v[100:103]
    s_waitcnt vmcnt(13)
    s_nop 0
    v_mfma_f32_16x16x32_bf16 v[96:99], v[246:249], v[148:151], v[96:99]
    v_mfma_f32_16x16x32_bf16 v[100:103], v[244:247], v[148:151], v[100:103]
    v_cvt_pk_bf16_f32 v80, v80, v81
    v_cvt_pk_bf16_f32 v81, v82, v83
    v_cvt_pk_bf16_f32 v82, v84, v85
    v_cvt_pk_bf16_f32 v83, v86, v87
    s_nop 0
    v_permlane16_swap_b32 v80, v82
    v_permlane16_swap_b32 v81, v83
    s_nop 0
    s_add_u32 s42, s82, 131072
    buffer_store_dwordx4 v[80:83], v4, s[28:31], s42 offen
    s_waitcnt vmcnt(13)
    s_nop 0
    v_mfma_f32_16x16x32_bf16 v[112:115], v[246:249], v[120:123], v[112:115]
    v_mfma_f32_16x16x32_bf16 v[116:119], v[244:247], v[120:123], v[116:119]
    s_waitcnt vmcnt(12)
    s_nop 0
    v_mfma_f32_16x16x32_bf16 v[112:115], v[246:249], v[124:127], v[112:115]
    v_mfma_f32_16x16x32_bf16 v[116:119], v[244:247], v[124:127], v[116:119]
    s_waitcnt vmcnt(11)
    s_nop 0
    v_mfma_f32_16x16x32_bf16 v[112:115], v[246:249], v[152:155], v[112:115]
    v_mfma_f32_16x16x32_bf16 v[116:119], v[244:247], v[152:155], v[116:119]
    v_cvt_pk_bf16_f32 v96, v96, v97
    v_cvt_pk_bf16_f32 v97, v98, v99
    v_cvt_pk_bf16_f32 v98, v100, v101
    v_cvt_pk_bf16_f32 v99, v102, v103
    s_nop 0
    v_permlane16_swap_b32 v96, v98
    v_permlane16_swap_b32 v97, v99
    s_nop 0
    s_add_u32 s42, s82, 163840
    buffer_store_dwordx4 v[96:99], v4, s[28:31], s42 offen
    s_waitcnt vmcnt(11)
    s_nop 0
    v_mfma_f32_16x16x32_bf16 v[176:179], v[246:249], v[184:187], v[176:179]
    v_mfma_f32_16x16x32_bf16 v[180:183], v[244:247], v[184:187], v[180:183]
    s_waitcnt vmcnt(10)
    s_nop 0
    v_mfma_f32_16x16x32_bf16 v[176:179], v[246:249], v[188:191], v[176:179]
    v_mfma_f32_16x16x32_bf16 v[180:183], v[244:247], v[188:191], v[180:183]
    s_waitcnt vmcnt(9)
    s_nop 0
    v_mfma_f32_16x16x32_bf16 v[176:179], v[246:249], v[156:159], v[176:179]
    v_mfma_f32_16x16x32_bf16 v[180:183], v[244:247], v[156:159], v[180:183]
    v_cvt_pk_bf16_f32 v112, v112, v113
    v_cvt_pk_bf16_f32 v113, v114, v115
    v_cvt_pk_bf16_f32 v114, v116, v117
    v_cvt_pk_bf16_f32 v115, v118, v119
    s_nop 0
    v_permlane16_swap_b32 v112, v114
    v_permlane16_swap_b32 v113, v115
    s_nop 0
    s_add_u32 s42, s82, 196608
    buffer_store_dwordx4 v[112:115], v4, s[28:31], s42 offen
    s_waitcnt vmcnt(9)
    s_nop 0
    v_mfma_f32_16x16x32_bf16 v[192:195], v[246:249], v[200:203], v[192:195]
    v_mfma_f32_16x16x32_bf16 v[196:199], v[244:247], v[200:203], v[196:199]
    s_waitcnt vmcnt(8)
    s_nop 0
    v_mfma_f32_16x16x32_bf16 v[192:195], v[246:249], v[204:207], v[192:195]
    v_mfma_f32_16x16x32_bf16 v[196:199], v[244:247], v[204:207], v[196:199]
    s_waitcnt vmcnt(7)
    s_nop 0
    v_mfma_f32_16x16x32_bf16 v[192:195], v[246:249], v[160:163], v[192:195]
    v_mfma_f32_16x16x32_bf16 v[196:199], v[244:247], v[160:163], v[196:199]
    v_cvt_pk_bf16_f32 v176, v176, v177
    v_cvt_pk_bf16_f32 v177, v178, v179
    v_cvt_pk_bf16_f32 v178, v180, v181
    v_cvt_pk_bf16_f32 v179, v182, v183
    s_nop 0
    v_permlane16_swap_b32 v176, v178
    v_permlane16_swap_b32 v177, v179
    s_nop 0
    s_add_u32 s42, s82, 229376
    buffer_store_dwordx4 v[176:179], v4, s[28:31], s42 offen
    v_cvt_pk_bf16_f32 v192, v192, v193
    v_cvt_pk_bf16_f32 v193, v194, v195
    v_cvt_pk_bf16_f32 v194, v196, v197
    v_cvt_pk_bf16_f32 v195, v198, v199
    s_nop 0
    v_permlane16_swap_b32 v192, v194
    v_permlane16_swap_b32 v193, v195
    s_nop 0
    s_add_u32 s42, s82, 262144
    buffer_store_dwordx4 v[192:195], v4, s[28:31], s42 offen
    s_endpgm
L_end:
    s_endpgm

.section .rodata,"a"
.p2align 6
.amdhsa_kernel concat_heads__mha_block_cached__gqa_block_cached__near_ridge_kernel
  .amdhsa_next_free_vgpr 256
  .amdhsa_next_free_sgpr 102
  .amdhsa_accum_offset 256
  .amdhsa_group_segment_fixed_size 0
  .amdhsa_kernarg_size 104
  .amdhsa_user_sgpr_count 2
  .amdhsa_user_sgpr_kernarg_segment_ptr 1
  .amdhsa_system_sgpr_workgroup_id_x 1
.end_amdhsa_kernel
```
